```python
import torch

def _softmax(x, axis=-1):
    return torch.softmax(x, dim=axis)

def _gelu(x):
    return torch.nn.functional.gelu(x, approximate='tanh')

def _silu(x):
    return torch.nn.functional.silu(x)

def _sigmoid(x):
    return torch.sigmoid(x)

def _layernorm(x, axis=-1, eps=1e-05):
    m = x.mean(dim=axis, keepdim=True)
    v = x.var(dim=axis, keepdim=True, unbiased=False)
    return (x - m) / torch.sqrt(v + eps)

def _scatter_add(tgt, idx, src, axis=0):
    return tgt.clone().index_add_(axis, idx, src)

def _segment_sum(src, seg, n):
    out = torch.zeros((n,) + src.shape[1:], dtype=src.dtype)
    return out.index_add_(0, seg, src)

def _pad(x, pw):
    flat = tuple((v for pair in reversed(pw) for v in pair))
    return torch.nn.functional.pad(x, flat)
kernel_name = 'sequential_preLN__linear_kernel_hedgehog__mixer_gmlp__prompt'

def setup_inputs():

    _w = lambda a: (lambda t: t.to(torch.bfloat16) if t.is_floating_point() else t)(torch.as_tensor(a))

    def _A_setup():
        B, S, D, H = (1, 2048, 512, 32)
        Dh = D // H
        return {'x': _w((lambda *s: torch.randn(*s, dtype=torch.bfloat16) * 0.05)(B, S, D)), 'wqkv': _w((lambda *s: torch.randn(*s, dtype=torch.bfloat16) * 0.2)(D, 3 * D)), 'w_phi': _w((lambda *s: torch.randn(*s, dtype=torch.bfloat16) * 0.2)(H, Dh, Dh) * Dh ** (-0.5)), 'wo': _w((lambda *s: torch.randn(*s, dtype=torch.bfloat16) * 0.05)(D, D))}
    _A_in = _A_setup()

    def _B_setup():
        B, S, D, F = (1, 2048, 512, 1792)
        Fh = F // 2
        return {'x': _w((lambda *s: torch.randn(*s, dtype=torch.bfloat16) * 0.05)(B, S, D)), 'w_in': _w((lambda *s: torch.randn(*s, dtype=torch.bfloat16) * 0.2)(D, 2 * Fh)), 'w_sp': _w(0.01 * (lambda *s: torch.randn(*s, dtype=torch.bfloat16) * 0.2)(S, S)), 'b_sp': _w(1.0 + 0.01 * (lambda *s: torch.randn(*s, dtype=torch.bfloat16) * 0.05)(S)), 'w_out': _w((lambda *s: torch.randn(*s, dtype=torch.bfloat16) * 0.05)(Fh, D))}
    _B_in = _B_setup()
    return {'A_x': _A_in['x'], 'A_wqkv': _A_in['wqkv'], 'A_w_phi': _A_in['w_phi'], 'A_wo': _A_in['wo'], 'B_x': _B_in['x'], 'B_w_in': _B_in['w_in'], 'B_w_sp': _B_in['w_sp'], 'B_b_sp': _B_in['b_sp'], 'B_w_out': _B_in['w_out']}

def reference(A_x, A_wqkv, A_w_phi, A_wo, B_x, B_w_in, B_w_sp, B_b_sp, B_w_out):

    def _A_ref(x, wqkv, w_phi, wo):
        B, S, D = x.shape
        H = 32
        Dh = D // H
        qkv = (lambda x, *d: x.permute(*d))((x @ wqkv).reshape(B, S, 3, H, Dh), 2, 0, 3, 1, 4)
        q, k, v = (qkv[0], qkv[1], qkv[2])
        pq = torch.einsum('bhsd,hdf->bhsf', q, w_phi)
        pk = torch.einsum('bhsd,hdf->bhsf', k, w_phi)
        phi_q = torch.concatenate([_softmax(pq, axis=-1), _softmax(-pq, axis=-1)], axis=-1)
        phi_k = torch.concatenate([_softmax(pk, axis=-1), _softmax(-pk, axis=-1)], axis=-1)
        kv = torch.einsum('bhsf,bhsd->bhfd', phi_k, v)
        z = torch.einsum('bhsf->bhf', phi_k)
        num = torch.einsum('bhqf,bhfd->bhqd', phi_q, kv)
        den = torch.einsum('bhqf,bhf->bhq', phi_q, z)[..., None] + 1e-06
        o = num / den
        return (lambda x, *d: x.permute(*d))(o, 0, 2, 1, 3).reshape(B, S, D) @ wo

    def _B_ref(x, w_in, w_sp, b_sp, w_out):
        B, S, D = x.shape
        F = w_in.shape[-1]
        Fh = F // 2
        z = _gelu(torch.einsum('bsd,df->bsf', x, w_in))
        z1 = z[..., :Fh].clone()
        z2 = _layernorm(z[..., Fh:], axis=-1)
        g = torch.einsum('ts,bsf->btf', w_sp, z2) + b_sp[None, :, None]
        return torch.einsum('bsf,fd->bsd', z1 * g, w_out)
    x = A_x
    h = x + _A_ref(_layernorm(x, axis=-1), A_wqkv, A_w_phi, A_wo)
    h2 = h + _B_ref(_layernorm(h, axis=-1), B_w_in, B_w_sp, B_b_sp, B_w_out)
    return h2
```

```asm
; @launch grid=(256,1,1) block=(256,1,1) lds=163840
.amdgcn_target "amdgcn-amd-amdhsa--gfx950"
.text
.globl sequential_preLN__linear_kernel_hedgehog__mixer_gmlp__prompt_kernel
.p2align 8
.type sequential_preLN__linear_kernel_hedgehog__mixer_gmlp__prompt_kernel,@function
sequential_preLN__linear_kernel_hedgehog__mixer_gmlp__prompt_kernel:
    s_load_dwordx16 s[64:79], s[0:1], 0
    s_load_dwordx8 s[80:87], s[0:1], 64
    s_cmp_ge_u32 s2, 256
    s_cbranch_scc1 L_end
    s_getpc_b64 s[60:61]
    s_lshr_b32 s58, s2, 3
    v_and_b32 v1, 15, v0
    v_lshl_add_u32 v1, s58, 4, v1
    v_lshlrev_b32 v1, 7, v1
    v_min_u32 v1, L_codeend-sequential_preLN__linear_kernel_hedgehog__mixer_gmlp__prompt_kernel-64, v1
    global_load_dword v2, v1, s[60:61] sc1
    v_lshrrev_b32 v1, 6, v0
    v_and_b32 v0, 63, v0
    v_readfirstlane_b32 s44, v1
    v_lshlrev_b32 v36, 4, v0
    s_and_b32 s45, s2, 7
    s_lshr_b32 s46, s2, 6
    s_and_b32 s47, s58, 7
    s_and_b32 s48, s58, 15
    s_lshl2_add_u32 s96, s58, s44
    s_lshl2_add_u32 s49, s45, s46
    s_add_u32 s63, s45, s47
    s_and_b32 s63, s63, 7
    s_lshl_b32 s60, s63, 7
    s_lshl_b32 s59, s44, 11
    s_lshl_b32 s62, s44, 12
    s_lshr_b32 s51, s44, 1
    s_and_b32 s52, s44, 1
    s_mov_b32 s6, 2097152
    s_mov_b32 s7, 0x20000
    s_mov_b32 s10, 1572864
    s_mov_b32 s11, 0x20000
    v_lshrrev_b32 v37, 4, v0
    v_xor_b32 v37, v37, v0
    v_and_b32 v37, 7, v37
    s_lshl_b32 s88, s49, 16
    s_lshl_b32 s91, s44, 14
    s_add_u32 s88, s88, s91
    v_lshl_add_u32 v48, v37, 4, s88
    v_lshrrev_b32 v1, 3, v0
    v_lshl_add_u32 v48, v1, 10, v48
    v_xor_b32 v49, 64, v48
    v_add_u32 v49, 7168, v49
    v_lshrrev_b32 v38, 2, v0
    v_and_b32 v38, 4, v38
    v_and_b32 v1, 7, v0
    v_xor_b32 v38, v38, v1
    v_lshrrev_b32 v1, 3, v0
    v_mul_u32_u24 v37, 3072, v1
    v_lshl_add_u32 v37, v38, 4, v37
    s_lshl_b32 s88, s47, 7
    s_mul_i32 s91, s52, 24576
    s_add_u32 s88, s88, s91
    s_lshl_b32 s91, s51, 10
    s_add_u32 s88, s88, s91
    s_mul_i32 s91, s63, 196608
    s_add_u32 s88, s88, s91
    s_add_u32 s88, s88, 1024
    s_lshl_b32 s89, s51, 5
    v_xor_b32 v51, s89, v37
    v_add_u32 v51, s88, v51
    s_mov_b32 s92, 48128
    s_mov_b32 s93, 96256
    s_mov_b32 s94, 144384
    s_add_u32 m0, s59, 81920
    s_waitcnt lgkmcnt(0)
    s_mov_b64 s[4:5], s[64:65]
    s_mov_b64 s[8:9], s[66:67]
    buffer_load_dwordx4 v48, s[4:7], s60 offen offset:0 lds
    s_load_dword s53, s[86:87], 0
    s_mov_b64 s[16:17], s[70:71]
    s_mov_b32 s18, 524288
    s_mov_b32 s19, 0x20000
    s_mov_b64 s[40:41], s[86:87]
    s_mov_b32 s42, 34603008
    s_mov_b32 s43, 0x20000
    s_mov_b64 s[12:13], s[68:69]
    s_mov_b32 s14, 16384
    s_mov_b32 s15, 0x20000
    buffer_load_dwordx4 v49, s[4:7], s60 offen offset:1024 lds
    s_mov_b64 s[20:21], s[74:75]
    s_mov_b32 s22, 1835008
    s_mov_b32 s23, 0x20000
    s_mov_b64 s[24:25], s[76:77]
    s_mov_b32 s26, 8388608
    s_mov_b32 s27, 0x20000
    s_mov_b64 s[28:29], s[78:79]
    s_mov_b32 s30, 4096
    s_mov_b32 s31, 0x20000
    s_mov_b64 s[32:33], s[80:81]
    s_add_u32 s60, s60, 128
    s_and_b32 s60, s60, 0x3ff
    s_add_u32 m0, s59, 90112
    s_nop 0
    buffer_load_dwordx4 v48, s[4:7], s60 offen offset:0 lds
    s_mov_b32 s34, 917504
    s_mov_b32 s35, 0x20000
    s_mov_b64 s[36:37], s[82:83]
    s_mov_b32 s38, 2097152
    s_mov_b32 s39, 0x20000
    s_cmp_lt_u32 s48, 14
    s_cselect_b32 s22, s22, 0
    s_lshr_b32 s50, s49, 1
    s_lshl2_add_u32 s95, s50, s44
    s_and_b32 s99, s48, 1
    s_add_u32 s90, s63, s51
    buffer_load_dwordx4 v49, s[4:7], s60 offen offset:1024 lds
    s_and_b32 s90, s90, 7
    s_lshr_b32 s85, s90, 1
    s_lshr_b32 s86, s45, 1
    s_add_u32 s87, s86, 0
    s_and_b32 s87, s87, 3
    s_and_b32 s89, 0, 2
    s_xor_b32 s86, s86, s89
    s_mov_b32 s55, 0x00003f80
    s_mov_b32 s56, 0x3f800000
    s_mov_b32 s57, 0x3f803f80
    s_add_u32 m0, s62, 0
    s_nop 0
    buffer_load_dwordx4 v51, s[8:11], 0 offen offset:0 lds
    v_mov_b32 v39, 2146435072
    s_lshl_b32 s88, s47, 7
    s_mul_i32 s91, s52, 24576
    s_add_u32 s88, s88, s91
    s_mul_i32 s91, s90, 196608
    s_add_u32 s88, s88, s91
    v_add_u32 v50, s88, v37
    s_add_u32 s89, s86, 3
    s_and_b32 s89, s89, 3
    s_lshl_b32 s88, s48, 7
    buffer_load_dwordx4 v51, s[8:11], s92 offen offset:1024 lds
    s_mul_i32 s91, s44, 114688
    s_add_u32 s88, s88, s91
    s_mul_i32 s91, s89, 458752
    s_add_u32 s88, s88, s91
    v_lshl_add_u32 v41, v38, 4, s88
    v_lshrrev_b32 v1, 3, v0
    v_mul_u32_u24 v1, 3584, v1
    v_add_u32 v41, v41, v1
    v_lshrrev_b32 v1, 5, v0
    v_lshlrev_b32 v37, 1, v1
    buffer_load_dwordx4 v51, s[8:11], s93 offen offset:2048 lds
    v_xor_b32 v38, v37, v38
    s_lshl_b32 s88, s63, 7
    s_lshl_b32 s91, s44, 15
    s_add_u32 s88, s88, s91
    s_lshl_b32 s91, s87, 17
    s_add_u32 s88, s88, s91
    v_lshl_add_u32 v40, v38, 4, s88
    v_bfe_u32 v1, v0, 3, 2
    v_lshl_add_u32 v40, v1, 10, v40
    v_lshrrev_b32 v1, 5, v0
    buffer_load_dwordx4 v51, s[8:11], s94 offen offset:3072 lds
    v_lshl_add_u32 v40, v1, 13, v40
    v_mov_b32 v52, -1
    v_mov_b32 v53, -1
    v_mov_b32 v54, -1
    v_mov_b32 v55, -1
    s_mul_i32 s88, s47, 36864
    s_mul_i32 s91, s44, 9216
    s_add_u32 s88, s88, s91
    s_add_u32 s88, s88, 524288
    s_lshl_b32 s90, s88, 0
    v_min_u32 v46, 13, v0
    v_lshlrev_b32 v46, 10, v46
    s_mul_i32 s97, s46, 7
    s_cmp_lt_u32 s47, 3
    s_addc_u32 s97, s97, s47
    s_lshl2_add_u32 s97, s97, s44
    s_mul_i32 s97, s97, 14336
    s_sub_u32 s97, s97, 57344
    s_cmp_lg_u32 s47, 3
    s_cselect_b32 s97, s97, 2146435072
    buffer_load_dword v2, v46, s[8:11], s97 offen offset:384
    s_lshl_b32 s91, s49, 8
    s_add_u32 s90, s90, s91
    v_lshl_add_u32 v56, v0, 3, s90
    s_add_u32 s89, s88, 7936
    s_lshl_b32 s91, s45, 7
    s_add_u32 s89, s89, s91
    s_lshl4_add_u32 s89, s46, s89
    v_lshl_add_u32 v37, v0, 3, s89
    v_cmp_le_u32 vcc, 32, v0
    s_lshl_b32 s88, s49, 16
    s_lshl_b32 s97, s47, 11
    s_lshl_b32 s98, s52, 10
    s_add_u32 s97, s97, s98
    s_add_u32 m0, s98, 148992
    s_nop 0
    buffer_load_dwordx4 v36, s[12:15], s97 offen lds
    s_lshl_b32 s91, s50, 17
    s_add_u32 s88, s88, s91
    s_lshl_b32 s91, s51, 15
    s_add_u32 s88, s88, s91
    s_lshl_b32 s91, s47, 11
    s_add_u32 s88, s88, s91
    s_lshl_b32 s91, s52, 10
    s_add_u32 s88, s88, s91
    s_add_u32 s88, s88, 4194304
    v_cndmask_b32 v56, v56, v37, vcc
    s_add_u32 s60, s60, 128
    s_and_b32 s60, s60, 0x3ff
    s_add_u32 m0, s59, 98304
    s_nop 0
    buffer_load_dwordx4 v48, s[4:7], s60 offen offset:0 lds
    v_cmp_gt_u32 vcc, 34, v0
    v_lshl_add_u32 v57, v0, 3, s88
    v_add_u32 v58, s88, v36
    v_cndmask_b32 v56, v39, v56, vcc
    v_cndmask_b32 v57, v39, v57, vcc
    v_add_u32 v59, 2146435072, v58
    s_add_u32 s89, s89, 128
    s_cmp_eq_u32 s46, 0
    s_cselect_b32 s89, s89, 2146435072
    v_cmp_le_u32 vcc, 8, v0
    v_add_u32 v37, s89, v36
    s_sub_u32 s90, s90, 256
    v_cndmask_b32 v59, v59, v37, vcc
    v_cmp_le_u32 vcc, 16, v0
    v_add_u32 v37, s90, v36
    s_lshl_b32 s88, s95, 12
    s_lshl_b32 s91, s48, 8
    s_add_u32 s88, s88, s91
    s_add_u32 s88, s88, 262144
    v_cndmask_b32 v59, v59, v37, vcc
    v_cmp_le_u32 vcc, 32, v0
    s_sub_u32 s89, s88, 512
    v_add_u32 v37, s89, v36
    v_cndmask_b32 v59, v59, v37, vcc
    v_cmp_le_u32 vcc, 48, v0
    s_lshl_b32 s89, s49, 12
    s_lshl_b32 s91, s51, 11
    s_add_u32 s89, s89, s91
    s_lshl_b32 s91, s47, 8
    s_add_u32 s89, s89, s91
    s_lshl_b32 s91, s52, 7
    s_add_u32 s89, s89, s91
    s_add_u32 s89, s89, 130304
    v_add_u32 v37, s89, v36
    v_cndmask_b32 v59, v59, v37, vcc
    v_cmp_gt_u32 vcc, 56, v0
    s_nop 1
    v_cndmask_b32 v59, v39, v59, vcc
    s_mul_i32 s89, s99, 248
    s_sub_u32 s88, s88, s89
    v_and_b32 v1, 31, v0
    v_lshl_add_u32 v42, v1, 4, s88
    v_lshrrev_b32 v1, 5, v0
    v_lshl_add_u32 v42, v1, 2, v42
    s_lshl_b32 s88, s44, 7
    s_add_u32 s88, s88, 148480
    v_and_b32 v1, 15, v0
    v_lshl_add_u32 v70, v1, 3, s88
    v_lshrrev_b32 v1, 5, v0
    v_lshl_add_u32 v70, v1, 2, v70
    v_mov_b32 v74, 0
    v_mov_b32 v76, 0
    v_bfe_u32 v37, v0, 1, 3
    v_lshrrev_b32 v38, 4, v0
    v_xor_b32 v38, v38, v37
    s_add_u32 s88, s59, 81920
    v_lshl_add_u32 v68, v38, 4, s88
    v_and_b32 v1, 15, v0
    v_lshl_add_u32 v68, v1, 7, v68
    v_xor_b32 v69, 64, v68
    v_lshrrev_b32 v38, 5, v0
    v_xor_b32 v38, v38, v37
    v_lshl_add_u32 v252, v38, 4, s88
    v_and_b32 v1, 15, v0
    v_lshl_add_u32 v252, v1, 7, v252
    v_bfe_u32 v1, v0, 4, 1
    v_lshl_add_u32 v252, v1, 3, v252
    v_xor_b32 v253, 32, v252
    v_xor_b32 v254, 64, v252
    v_xor_b32 v255, 96, v252
    s_lshl_b32 s88, s51, 12
    s_add_u32 s88, s88, 81920
    v_lshl_add_u32 v60, v38, 4, s88
    v_and_b32 v1, 31, v0
    v_lshl_add_u32 v60, v1, 7, v60
    v_xor_b32 v61, 0x20, v60
    v_xor_b32 v62, 0x40, v60
    v_xor_b32 v63, 0x60, v60
    v_xor_b32 v64, 0x1000, v60
    v_xor_b32 v65, 0x1020, v60
    v_xor_b32 v66, 0x1040, v60
    v_xor_b32 v67, 0x1060, v60
    v_lshrrev_b32 v37, 3, v0
    v_xor_b32 v37, v37, v0
    v_and_b32 v37, 4, v37
    v_lshlrev_b32 v37, 2, v37
    v_bfe_u32 v1, v0, 1, 1
    v_lshl_add_u32 v37, v1, 0, v37
    v_bfe_u32 v1, v0, 3, 2
    v_lshl_add_u32 v37, v1, 1, v37
    v_and_b32 v1, 1, v0
    v_lshlrev_b32 v38, 4, v1
    v_lshlrev_b32 v38, v38, s55
    v_cmp_eq_u32 vcc, 0, v37
    v_cmp_eq_u32 s[88:89], 1, v37
    s_nop 0
    v_cndmask_b32 v6, 0, v38, vcc
    v_cndmask_b32 v7, 0, v38, s[88:89]
    v_cmp_eq_u32 vcc, 2, v37
    v_cmp_eq_u32 s[88:89], 3, v37
    s_nop 0
    v_cndmask_b32 v8, 0, v38, vcc
    v_cndmask_b32 v9, 0, v38, s[88:89]
    v_cmp_eq_u32 vcc, 4, v37
    v_cmp_eq_u32 s[88:89], 5, v37
    s_nop 0
    v_cndmask_b32 v10, 0, v38, vcc
    v_cndmask_b32 v11, 0, v38, s[88:89]
    v_cmp_eq_u32 vcc, 6, v37
    v_cmp_eq_u32 s[88:89], 7, v37
    s_nop 0
    v_cndmask_b32 v12, 0, v38, vcc
    v_cndmask_b32 v13, 0, v38, s[88:89]
    v_bfe_u32 v37, v0, 2, 2
    v_lshrrev_b32 v38, 4, v0
    v_cmp_eq_u32 vcc, v37, v38
    v_mov_b32 v38, s57
    v_lshlrev_b32 v37, 7, v37
    v_bfe_u32 v1, v0, 3, 1
    v_lshl_add_u32 v37, v1, 6, v37
    v_bfe_u32 v1, v0, 4, 1
    v_lshl_add_u32 v37, v1, 5, v37
    v_cndmask_b32 v14, 0, v38, vcc
    v_cndmask_b32 v15, 0, v38, vcc
    v_cndmask_b32 v16, 0, v38, vcc
    v_cndmask_b32 v17, 0, v38, vcc
    v_and_b32 v1, 1, v0
    v_lshl_add_u32 v38, v1, 4, v37
    v_bfe_u32 v1, v0, 1, 1
    v_lshl_add_u32 v38, v1, 3, v38
    v_lshrrev_b32 v1, 5, v0
    v_lshl_add_u32 v78, v1, 12, v38
    v_lshl_add_u32 v43, v1, 9, v38
    s_lshl_b32 s88, s44, 5
    v_bfe_u32 v1, v0, 4, 1
    v_lshl_add_u32 v73, v1, 13, v78
    v_xor_b32 v73, s88, v73
    s_lshl_b32 s88, s52, 6
    v_xor_b32 v78, s88, v78
    s_lshl_b32 s88, s51, 8
    s_add_u32 s88, s88, 148480
    v_and_b32 v1, 31, v0
    v_lshl_add_u32 v71, v1, 3, s88
    v_xor_b32 v72, 256, v71
    v_and_b32 v1, 3, v0
    v_lshl_add_u32 v26, v1, 3, v37
    v_bfe_u32 v1, v0, 4, 1
    v_lshl_add_u32 v26, v1, 9, v26
    v_lshrrev_b32 v1, 5, v0
    v_lshl_add_u32 v26, v1, 11, v26
    v_add_u32 v26, 65536, v26
    v_xor_b32 v27, 32, v26
    v_xor_b32 v28, 64, v26
    v_xor_b32 v29, 0x60, v26
    v_and_b32 v1, 15, v0
    v_lshlrev_b32 v38, 3, v1
    v_lshrrev_b32 v1, 5, v0
    v_lshl_add_u32 v38, v1, 8, v38
    s_lshl_b32 s88, s44, 9
    s_add_u32 s88, s88, 148992
    v_add_u32 v79, s88, v38
    s_lshl_b32 s88, s52, 10
    s_add_u32 s88, s88, 148992
    v_lshl_add_u32 v80, v38, 0, s88
    v_bfe_u32 v1, v0, 4, 1
    v_lshl_add_u32 v80, v1, 9, v80
    s_waitcnt lgkmcnt(0)
    s_cmp_lg_u32 s44, 0
    s_cbranch_scc1 L_nc1
    s_call_b64 s[0:1], L_pad1
L_nc1:
    s_cmp_lg_u32 s44, 1
    s_cbranch_scc1 L_nc2
    s_call_b64 s[0:1], L_pad2
L_nc2:
    s_cmp_lg_u32 s44, 2
    s_cbranch_scc1 L_nc4
    s_call_b64 s[0:1], L_pad4
L_nc4:
    s_cmp_lg_u32 s44, 3
    s_cbranch_scc1 L_nc5
    s_call_b64 s[0:1], L_pad5
L_nc5:
    s_branch L_page0
    .p2align 12
L_pad0:
    s_setpc_b64 s[0:1]
    s_nop 0
L_page0:
    buffer_load_dwordx4 v49, s[4:7], s60 offen offset:1024 lds
    s_add_u32 s60, s60, 128
    s_and_b32 s60, s60, 0x3ff
    s_add_u32 m0, s59, 106496
    s_nop 0
    buffer_load_dwordx4 v48, s[4:7], s60 offen offset:0 lds
    buffer_load_dwordx4 v49, s[4:7], s60 offen offset:1024 lds
    s_mov_b32 s97, 0x30000
    s_cmp_eq_u32 s63, 7
    s_cselect_b32 s97, 0xffeb0000, s97
    v_add_u32 v51, s97, v51
    s_add_u32 m0, s62, 16384
    s_nop 0
    buffer_load_dwordx4 v51, s[8:11], 0 offen offset:0 lds
    buffer_load_dwordx4 v51, s[8:11], s92 offen offset:1024 lds
    s_waitcnt vmcnt(8)
    s_barrier
    ds_read_b64 v[18:19], v252
    ds_read_b64 v[20:21], v253
    ds_read_b64 v[22:23], v254
    ds_read_b64 v[24:25], v255
    ds_read_b64_tr_b16 v[156:157], v73 offset:0
    ds_read_b64_tr_b16 v[158:159], v73 offset:512
    ds_read_b128 a[0:3], v60 offset:0
    ds_read_b128 a[128:131], v64 offset:0
    ds_read_b64_tr_b16 v[160:161], v73 offset:1024
    ds_read_b64_tr_b16 v[162:163], v73 offset:1536
    ds_read_b128 a[4:7], v61 offset:0
    ds_read_b128 a[132:135], v65 offset:0
    s_waitcnt lgkmcnt(4)
    v_mfma_f32_32x32x16_bf16 v[200:215], v[156:159], a[0:3], 0
    ds_read_b64_tr_b16 v[164:165], v73 offset:2048
    ds_read_b64_tr_b16 v[166:167], v73 offset:2560
    ds_read_b128 a[8:11], v62 offset:0
    buffer_load_dwordx4 v51, s[8:11], s93 offen offset:2048 lds
    s_add_u32 s53, s53, 1
    s_getreg_b32 s88, hwreg(HW_REG_XCC_ID)
    v_mfma_f32_16x16x32_bf16 v[120:123], v[14:17], v[156:159], 0
    ds_read_b128 a[136:139], v66 offset:0
    s_and_b32 s88, s88, 7
    v_mfma_f32_32x32x16_bf16 v[216:231], v[156:159], a[128:131], 0
    ds_read_b128 a[12:15], v63 offset:0
    ds_read_b128 a[140:143], v67 offset:0
    buffer_load_dwordx4 v51, s[8:11], s94 offen offset:3072 lds
    s_xor_b32 s54, s53, 0x5bd1e995
    s_andn2_b32 s54, s54, 7
    s_waitcnt lgkmcnt(6)
    v_mfma_f32_32x32x16_bf16 v[200:215], v[160:163], a[4:7], v[200:215]
    ds_read_b64_tr_b16 v[156:157], v73 offset:3072
    ds_read_b64_tr_b16 v[158:159], v73 offset:3584
    ds_read_b128 a[16:19], v60 offset:8192
    s_add_u32 s60, s60, 128
    s_and_b32 s60, s60, 0x3ff
    s_add_u32 m0, s59, 114688
    v_mfma_f32_16x16x32_bf16 v[120:123], v[14:17], v[160:163], v[120:123]
    ds_read_b128 a[144:147], v64 offset:8192
    s_or_b32 s54, s54, s88
    v_mfma_f32_32x32x16_bf16 v[216:231], v[160:163], a[132:135], v[216:231]
    ds_read_b128 a[20:23], v61 offset:8192
    ds_read_b128 a[148:151], v65 offset:8192
    buffer_load_dwordx4 v48, s[4:7], s60 offen offset:0 lds
    s_lshl_b32 s88, s47, 10
    s_lshl_b32 s91, s45, 7
    s_waitcnt lgkmcnt(8)
    v_mfma_f32_32x32x16_bf16 v[200:215], v[164:167], a[8:11], v[200:215]
    s_cmp_lg_u32 s44, 0
    s_cbranch_scc1 L_nc6
    s_call_b64 s[0:1], L_pad6
L_nc6:
    s_cmp_lg_u32 s44, 1
    s_cbranch_scc1 L_nc7
    s_call_b64 s[0:1], L_pad7
L_nc7:
    buffer_load_dwordx4 v49, s[4:7], s60 offen offset:1024 lds
    s_add_u32 s60, s60, 128
    s_and_b32 s60, s60, 0x3ff
    s_add_u32 m0, s59, 122880
    s_nop 0
    buffer_load_dwordx4 v48, s[4:7], s60 offen offset:0 lds
    buffer_load_dwordx4 v49, s[4:7], s60 offen offset:1024 lds
    s_mov_b32 s97, 0x30000
    s_cmp_eq_u32 s63, 6
    s_cselect_b32 s97, 0xffeb0000, s97
    v_add_u32 v51, s97, v51
    s_add_u32 m0, s62, 32768
    s_nop 0
    buffer_load_dwordx4 v51, s[8:11], 0 offen offset:0 lds
    buffer_load_dwordx4 v51, s[8:11], s92 offen offset:1024 lds
    buffer_load_dwordx4 v51, s[8:11], s93 offen offset:2048 lds
    buffer_load_dwordx4 v51, s[8:11], s94 offen offset:3072 lds
    s_waitcnt vmcnt(8)
    s_barrier
    ds_read_b64_tr_b16 v[160:161], v73 offset:16384
    ds_read_b64_tr_b16 v[162:163], v73 offset:16896
    ds_read_b128 a[24:27], v62 offset:8192
    s_add_u32 s60, s60, 128
    s_and_b32 s60, s60, 0x3ff
    s_add_u32 m0, s59, 131072
    s_nop 0
    buffer_load_dwordx4 v48, s[4:7], s60 offen offset:0 lds
    v_mfma_f32_16x16x32_bf16 v[120:123], v[14:17], v[164:167], v[120:123]
    ds_read_b128 a[152:155], v66 offset:8192
    s_add_u32 s88, s88, s91
    v_mfma_f32_32x32x16_bf16 v[216:231], v[164:167], a[136:139], v[216:231]
    ds_read_b128 a[28:31], v63 offset:8192
    ds_read_b128 a[156:159], v67 offset:8192
    buffer_load_dwordx4 v49, s[4:7], s60 offen offset:1024 lds
    s_lshl3_add_u32 s88, s46, s88
    s_add_u32 s88, s88, 4096
    s_waitcnt lgkmcnt(10)
    v_mfma_f32_32x32x16_bf16 v[200:215], v[156:159], a[12:15], v[200:215]
    ds_read_b64_tr_b16 v[164:165], v73 offset:17408
    ds_read_b64_tr_b16 v[166:167], v73 offset:17920
    ds_read_b128 a[32:35], v60 offset:16384
    s_add_u32 s60, s60, 128
    s_and_b32 s60, s60, 0x3ff
    s_add_u32 m0, s59, 139264
    v_mfma_f32_16x16x32_bf16 v[120:123], v[14:17], v[156:159], v[120:123]
    ds_read_b128 a[160:163], v64 offset:16384
    v_or_b32 v37, s44, v0
    v_mfma_f32_32x32x16_bf16 v[216:231], v[156:159], a[140:143], v[216:231]
    ds_read_b128 a[36:39], v61 offset:16384
    ds_read_b128 a[164:167], v65 offset:16384
    ds_read_b128 v[232:235], v68 offset:0
    buffer_load_dwordx4 v48, s[4:7], s60 offen offset:0 lds
    v_cmp_eq_u32 vcc, 0, v37
    s_waitcnt lgkmcnt(11)
    v_mfma_f32_32x32x16_bf16 v[200:215], v[160:163], a[16:19], v[200:215]
    ds_read_b64_tr_b16 v[156:157], v73 offset:18432
    ds_read_b64_tr_b16 v[158:159], v73 offset:18944
    ds_read_b128 a[40:43], v62 offset:16384
    buffer_load_dwordx4 v49, s[4:7], s60 offen offset:1024 lds
    s_mov_b64 s[4:5], s[20:21]
    s_mov_b32 s6, 1835008
    s_mov_b32 s97, 0x30000
    s_cmp_eq_u32 s63, 5
    s_cselect_b32 s97, 0xffeb0000, s97
    v_add_u32 v51, s97, v51
    s_add_u32 m0, s62, 49152
    v_mfma_f32_16x16x32_bf16 v[120:123], v[14:17], v[160:163], v[120:123]
    ds_read_b128 a[168:171], v66 offset:16384
    v_mov_b32 v90, s53
    v_mfma_f32_32x32x16_bf16 v[216:231], v[160:163], a[144:147], v[216:231]
    ds_read_b128 a[44:47], v63 offset:16384
    ds_read_b128 a[172:175], v67 offset:16384
    ds_read_b128 v[236:239], v69 offset:0
    buffer_load_dwordx4 v51, s[8:11], 0 offen offset:0 lds
    v_mov_b32 v91, s54
    s_waitcnt lgkmcnt(12)
    v_mfma_f32_32x32x16_bf16 v[200:215], v[164:167], a[20:23], v[200:215]
    ds_read_b64_tr_b16 v[160:161], v73 offset:19456
    ds_read_b64_tr_b16 v[162:163], v73 offset:19968
    ds_read_b128 a[48:51], v60 offset:24576
    v_mov_b32 v37, s88
    v_cndmask_b32 v81, v39, v37, vcc
    s_lshl_b32 s88, s49, 1
    v_mfma_f32_16x16x32_bf16 v[120:123], v[14:17], v[164:167], v[120:123]
    ds_read_b128 a[176:179], v64 offset:24576
    s_add_u32 s88, s88, s51
    v_mfma_f32_32x32x16_bf16 v[216:231], v[164:167], a[148:151], v[216:231]
    ds_read_b128 a[52:55], v61 offset:24576
    ds_read_b128 a[180:183], v65 offset:24576
    ds_read_b128 v[240:243], v68 offset:8192
    buffer_load_dwordx4 v51, s[8:11], s92 offen offset:1024 lds
    s_lshl_b32 s89, s88, 5
    s_lshl1_add_u32 s89, s47, s89
    s_waitcnt lgkmcnt(14)
    v_dot2c_f32_bf16 v74, s57, v232
    v_dot2c_f32_bf16 v76, v232, v232
    v_dot2c_f32_bf16 v74, s57, v233
    v_dot2c_f32_bf16 v76, v233, v233
    v_dot2c_f32_bf16 v74, s57, v234
    v_dot2c_f32_bf16 v76, v234, v234
    v_dot2c_f32_bf16 v74, s57, v235
    v_dot2c_f32_bf16 v76, v235, v235
    s_waitcnt lgkmcnt(12)
    v_mfma_f32_32x32x16_bf16 v[200:215], v[156:159], a[24:27], v[200:215]
    buffer_load_dwordx4 v51, s[8:11], s93 offen offset:2048 lds
    buffer_load_dwordx4 v51, s[8:11], s94 offen offset:3072 lds
    s_waitcnt vmcnt(8)
    s_barrier
    ds_read_b64_tr_b16 v[164:165], v73 offset:32768
    ds_read_b64_tr_b16 v[166:167], v73 offset:33280
    ds_read_b128 a[56:59], v62 offset:24576
    buffer_store_dwordx4 v[52:55], v58, s[40:43], 0 offen sc1
    v_mfma_f32_16x16x32_bf16 v[120:123], v[14:17], v[156:159], v[120:123]
    ds_read_b128 a[184:187], v66 offset:24576
    s_add_u32 s89, s89, s52
    v_mfma_f32_32x32x16_bf16 v[216:231], v[156:159], a[152:155], v[216:231]
    ds_read_b128 a[60:63], v63 offset:24576
    ds_read_b128 a[188:191], v67 offset:24576
    ds_read_b128 v[244:247], v69 offset:8192
    s_movk_i32 s97, 16384
    buffer_store_dwordx4 v[52:55], v58, s[40:43], s97 offen sc1
    s_waitcnt lgkmcnt(14)
    v_dot2c_f32_bf16 v74, s57, v236
    v_dot2c_f32_bf16 v76, v236, v236
    v_dot2c_f32_bf16 v74, s57, v237
    v_dot2c_f32_bf16 v76, v237, v237
    v_dot2c_f32_bf16 v74, s57, v238
    v_dot2c_f32_bf16 v76, v238, v238
    v_dot2c_f32_bf16 v74, s57, v239
    v_dot2c_f32_bf16 v76, v239, v239
    s_waitcnt lgkmcnt(12)
    v_mfma_f32_32x32x16_bf16 v[200:215], v[160:163], a[28:31], v[200:215]
    ds_read_b64_tr_b16 v[156:157], v73 offset:33792
    ds_read_b64_tr_b16 v[158:159], v73 offset:34304
    ds_read_b128 a[64:67], v60 offset:32768
    s_lshl_b32 s90, s89, 10
    s_lshl_b32 s91, s50, 17
    s_add_u32 s90, s90, s91
    v_mfma_f32_16x16x32_bf16 v[120:123], v[14:17], v[160:163], v[120:123]
    ds_read_b128 a[192:195], v64 offset:32768
    s_add_u32 s90, s90, 4194304
    v_mfma_f32_32x32x16_bf16 v[216:231], v[160:163], a[156:159], v[216:231]
    ds_read_b128 a[68:71], v61 offset:32768
    ds_read_b128 a[196:199], v65 offset:32768
    ds_read_b128 v[248:251], v68 offset:16384
    buffer_store_dwordx4 v[52:55], v59, s[40:43], 0 offen sc1
    s_mov_b32 s97, 0x30000
    s_cmp_eq_u32 s63, 4
    s_cselect_b32 s97, 0xffeb0000, s97
    v_add_u32 v51, s97, v51
    s_add_u32 m0, s62, 65536
    s_waitcnt lgkmcnt(14)
    v_dot2c_f32_bf16 v74, s57, v240
    v_dot2c_f32_bf16 v76, v240, v240
    v_dot2c_f32_bf16 v74, s57, v241
    v_dot2c_f32_bf16 v76, v241, v241
    v_dot2c_f32_bf16 v74, s57, v242
    v_dot2c_f32_bf16 v76, v242, v242
    v_dot2c_f32_bf16 v74, s57, v243
    v_dot2c_f32_bf16 v76, v243, v243
    s_waitcnt lgkmcnt(12)
    v_mfma_f32_32x32x16_bf16 v[200:215], v[164:167], a[32:35], v[200:215]
    ds_read_b64_tr_b16 v[160:161], v73 offset:34816
    ds_read_b64_tr_b16 v[162:163], v73 offset:35328
    ds_read_b128 a[72:75], v62 offset:32768
    buffer_load_dwordx4 v51, s[8:11], 0 offen offset:0 lds
    v_and_b32 v1, 15, v0
    v_lshlrev_b32 v38, 4, v1
    v_mfma_f32_16x16x32_bf16 v[120:123], v[14:17], v[164:167], v[120:123]
    ds_read_b128 a[200:203], v66 offset:32768
    v_lshl_add_u32 v111, v38, 0, s90
    v_mfma_f32_32x32x16_bf16 v[216:231], v[164:167], a[160:163], v[216:231]
    ds_read_b128 a[76:79], v63 offset:32768
    ds_read_b128 a[204:207], v67 offset:32768
    ds_read_b128 v[232:235], v69 offset:16384
    buffer_load_dwordx4 v51, s[8:11], s92 offen offset:1024 lds
    v_bfe_u32 v1, v0, 4, 1
    v_lshl_add_u32 v111, v1, 14, v111
    s_waitcnt lgkmcnt(14)
    v_dot2c_f32_bf16 v74, s57, v244
    v_dot2c_f32_bf16 v76, v244, v244
    v_dot2c_f32_bf16 v74, s57, v245
    v_dot2c_f32_bf16 v76, v245, v245
    v_dot2c_f32_bf16 v74, s57, v246
    v_dot2c_f32_bf16 v76, v246, v246
    v_dot2c_f32_bf16 v74, s57, v247
    v_dot2c_f32_bf16 v76, v247, v247
    s_waitcnt lgkmcnt(12)
    v_mfma_f32_32x32x16_bf16 v[200:215], v[156:159], a[36:39], v[200:215]
    ds_read_b64_tr_b16 v[164:165], v73 offset:35840
    ds_read_b64_tr_b16 v[166:167], v73 offset:36352
    ds_read_b128 a[80:83], v60 offset:40960
    v_lshrrev_b32 v1, 5, v0
    v_lshl_add_u32 v111, v1, 8, v111
    s_lshl_b32 s89, s89, 2
    v_mfma_f32_16x16x32_bf16 v[120:123], v[14:17], v[156:159], v[120:123]
    ds_read_b128 a[208:211], v64 offset:40960
    v_mov_b32 v112, s89
    v_mfma_f32_32x32x16_bf16 v[216:231], v[156:159], a[164:167], v[216:231]
    ds_read_b128 a[84:87], v61 offset:40960
    ds_read_b128 a[212:215], v65 offset:40960
    ds_read_b128 v[236:239], v68 offset:24576
    buffer_load_dwordx4 v51, s[8:11], s93 offen offset:2048 lds
    v_cmp_eq_u32 vcc, 0, v0
    s_waitcnt lgkmcnt(14)
    v_dot2c_f32_bf16 v74, s57, v248
    v_dot2c_f32_bf16 v76, v248, v248
    v_dot2c_f32_bf16 v74, s57, v249
    v_dot2c_f32_bf16 v76, v249, v249
    v_dot2c_f32_bf16 v74, s57, v250
    v_dot2c_f32_bf16 v76, v250, v250
    v_dot2c_f32_bf16 v74, s57, v251
    v_dot2c_f32_bf16 v76, v251, v251
    s_waitcnt lgkmcnt(12)
    v_mfma_f32_32x32x16_bf16 v[200:215], v[160:163], a[40:43], v[200:215]
    buffer_load_dwordx4 v51, s[8:11], s94 offen offset:3072 lds
    s_mov_b32 s97, 0x30000
    s_cmp_eq_u32 s63, 3
    s_cselect_b32 s97, 0xffeb0000, s97
    v_add_u32 v51, s97, v51
    s_add_u32 m0, s62, 0
    s_nop 0
    buffer_load_dwordx4 v51, s[8:11], 0 offen offset:0 lds
    s_waitcnt vmcnt(8)
    s_barrier
    ds_read_b64_tr_b16 v[156:157], v73 offset:49152
    ds_read_b64_tr_b16 v[158:159], v73 offset:49664
    ds_read_b128 a[88:91], v62 offset:40960
    buffer_load_dwordx4 v51, s[8:11], s92 offen offset:1024 lds
    v_mfma_f32_16x16x32_bf16 v[120:123], v[14:17], v[160:163], v[120:123]
    ds_read_b128 a[216:219], v66 offset:40960
    v_mfma_f32_32x32x16_bf16 v[216:231], v[160:163], a[168:171], v[216:231]
    ds_read_b128 a[92:95], v63 offset:40960
    ds_read_b128 a[220:223], v67 offset:40960
    ds_read_b128 v[240:243], v69 offset:24576
    buffer_load_dwordx4 v51, s[8:11], s93 offen offset:2048 lds
    s_nop 1
    s_waitcnt lgkmcnt(14)
    v_dot2c_f32_bf16 v74, s57, v232
    v_dot2c_f32_bf16 v76, v232, v232
    v_dot2c_f32_bf16 v74, s57, v233
    v_dot2c_f32_bf16 v76, v233, v233
    v_dot2c_f32_bf16 v74, s57, v234
    v_dot2c_f32_bf16 v76, v234, v234
    v_dot2c_f32_bf16 v74, s57, v235
    v_dot2c_f32_bf16 v76, v235, v235
    s_waitcnt lgkmcnt(12)
    v_mfma_f32_32x32x16_bf16 v[200:215], v[164:167], a[44:47], v[200:215]
    ds_read_b64_tr_b16 v[160:161], v73 offset:50176
    ds_read_b64_tr_b16 v[162:163], v73 offset:50688
    ds_read_b128 a[96:99], v60 offset:49152
    v_cndmask_b32 v112, v39, v112, vcc
    s_lshl_b32 s89, s88, 7
    v_and_b32 v1, 15, v0
    v_mfma_f32_16x16x32_bf16 v[120:123], v[14:17], v[164:167], v[120:123]
    ds_read_b128 a[224:227], v64 offset:49152
    v_lshl_add_u32 v44, v1, 2, s89
    v_mfma_f32_32x32x16_bf16 v[216:231], v[164:167], a[172:175], v[216:231]
    ds_read_b128 a[100:103], v61 offset:49152
    ds_read_b128 a[228:231], v65 offset:49152
    ds_read_b128 v[244:247], v68 offset:32768
    buffer_load_dwordx4 v51, s[8:11], s94 offen offset:3072 lds
    s_mov_b32 s97, 0x30000
    s_cmp_eq_u32 s63, 2
    s_cselect_b32 s97, 0xffeb0000, s97
    v_add_u32 v51, s97, v51
    s_add_u32 m0, s62, 16384
    s_waitcnt lgkmcnt(14)
    v_dot2c_f32_bf16 v74, s57, v236
    v_dot2c_f32_bf16 v76, v236, v236
    v_dot2c_f32_bf16 v74, s57, v237
    v_dot2c_f32_bf16 v76, v237, v237
    v_dot2c_f32_bf16 v74, s57, v238
    v_dot2c_f32_bf16 v76, v238, v238
    v_dot2c_f32_bf16 v74, s57, v239
    v_dot2c_f32_bf16 v76, v239, v239
    s_waitcnt lgkmcnt(12)
    v_mfma_f32_32x32x16_bf16 v[200:215], v[156:159], a[48:51], v[200:215]
    ds_read_b64_tr_b16 v[164:165], v73 offset:51200
    ds_read_b64_tr_b16 v[166:167], v73 offset:51712
    ds_read_b128 a[104:107], v62 offset:49152
    buffer_load_dwordx4 v51, s[8:11], 0 offen offset:0 lds
    s_lshl_b32 s89, s88, 15
    s_lshl_b32 s91, s50, 17
    v_mfma_f32_16x16x32_bf16 v[120:123], v[14:17], v[156:159], v[120:123]
    ds_read_b128 a[232:235], v66 offset:49152
    s_add_u32 s89, s89, s91
    v_mfma_f32_32x32x16_bf16 v[216:231], v[156:159], a[176:179], v[216:231]
    ds_read_b128 a[108:111], v63 offset:49152
    ds_read_b128 a[236:239], v67 offset:49152
    ds_read_b128 v[248:251], v69 offset:32768
    buffer_load_dwordx4 v51, s[8:11], s92 offen offset:1024 lds
    s_lshl_b32 s91, s63, 12
    s_add_u32 s89, s89, s91
    s_waitcnt lgkmcnt(14)
    v_dot2c_f32_bf16 v74, s57, v240
    v_dot2c_f32_bf16 v76, v240, v240
    v_dot2c_f32_bf16 v74, s57, v241
    v_dot2c_f32_bf16 v76, v241, v241
    v_dot2c_f32_bf16 v74, s57, v242
    v_dot2c_f32_bf16 v76, v242, v242
    v_dot2c_f32_bf16 v74, s57, v243
    v_dot2c_f32_bf16 v76, v243, v243
    s_waitcnt lgkmcnt(12)
    v_mfma_f32_32x32x16_bf16 v[200:215], v[160:163], a[52:55], v[200:215]
    ds_read_b64_tr_b16 v[156:157], v73 offset:52224
    ds_read_b64_tr_b16 v[158:159], v73 offset:52736
    ds_read_b128 a[112:115], v60 offset:57344
    s_lshl_b32 s91, s52, 8
    s_add_u32 s89, s89, s91
    s_add_u32 s89, s89, 4325376
    v_mfma_f32_16x16x32_bf16 v[120:123], v[14:17], v[160:163], v[120:123]
    ds_read_b128 a[240:243], v64 offset:57344
    v_lshl_add_u32 v113, v38, 0, s89
    v_mfma_f32_32x32x16_bf16 v[216:231], v[160:163], a[180:183], v[216:231]
    ds_read_b128 a[116:119], v61 offset:57344
    ds_read_b128 a[244:247], v65 offset:57344
    ds_read_b128 v[232:235], v68 offset:40960
    buffer_load_dwordx4 v51, s[8:11], s93 offen offset:2048 lds
    v_lshrrev_b32 v1, 4, v0
    v_lshl_add_u32 v113, v1, 9, v113
    s_waitcnt lgkmcnt(14)
    v_dot2c_f32_bf16 v74, s57, v244
    v_dot2c_f32_bf16 v76, v244, v244
    v_dot2c_f32_bf16 v74, s57, v245
    v_dot2c_f32_bf16 v76, v245, v245
    v_dot2c_f32_bf16 v74, s57, v246
    v_dot2c_f32_bf16 v76, v246, v246
    v_dot2c_f32_bf16 v74, s57, v247
    v_dot2c_f32_bf16 v76, v247, v247
    s_waitcnt lgkmcnt(12)
    v_mfma_f32_32x32x16_bf16 v[200:215], v[164:167], a[56:59], v[200:215]
    buffer_load_dwordx4 v51, s[8:11], s94 offen offset:3072 lds
    s_waitcnt vmcnt(8)
    s_barrier
    buffer_store_dwordx2 v[90:91], v81, s[40:43], 0 offen sc1
    ds_read_b64_tr_b16 v[100:101], v79 offset:0
    ds_read_b64_tr_b16 v[102:103], v79 offset:128
    ds_read_b64_tr_b16 v[92:93], v80 offset:0
    ds_read_b64_tr_b16 v[94:95], v80 offset:128
    v_add_u32 v73, 0x10000, v73
    ds_read_b64_tr_b16 v[160:161], v73 offset:0
    ds_read_b64_tr_b16 v[162:163], v73 offset:512
    ds_read_b128 a[120:123], v62 offset:57344
    s_mov_b32 s97, 0x30000
    s_cmp_eq_u32 s63, 1
    s_cselect_b32 s97, 0xffeb0000, s97
    v_add_u32 v51, s97, v51
    s_add_u32 m0, s62, 32768
    s_nop 0
    buffer_load_dwordx4 v51, s[8:11], 0 offen offset:0 lds
    v_mfma_f32_16x16x32_bf16 v[120:123], v[14:17], v[164:167], v[120:123]
    ds_read_b128 a[248:251], v66 offset:57344
    s_lshl_b32 s89, s88, 11
    s_lshl_b32 s91, s47, 8
    s_add_u32 s89, s89, s91
    s_lshl_b32 s91, s52, 7
    s_add_u32 s89, s89, s91
    s_add_u32 s89, s89, 131072
    v_mfma_f32_32x32x16_bf16 v[216:231], v[164:167], a[184:187], v[216:231]
    ds_read_b128 a[124:127], v63 offset:57344
    ds_read_b128 a[252:255], v67 offset:57344
    ds_read_b128 v[236:239], v69 offset:40960
    buffer_load_dwordx4 v51, s[8:11], s92 offen offset:1024 lds
    v_and_b32 v1, 15, v0
    v_lshl_add_u32 v114, v1, 3, s89
    s_waitcnt lgkmcnt(15)
    v_dot2c_f32_bf16 v74, s57, v248
    v_dot2c_f32_bf16 v76, v248, v248
    v_dot2c_f32_bf16 v74, s57, v249
    v_dot2c_f32_bf16 v76, v249, v249
    v_dot2c_f32_bf16 v74, s57, v250
    v_dot2c_f32_bf16 v76, v250, v250
    v_dot2c_f32_bf16 v74, s57, v251
    v_dot2c_f32_bf16 v76, v251, v251
    s_waitcnt lgkmcnt(15)
    v_mfma_f32_32x32x16_bf16 v[200:215], v[156:159], a[60:63], v[200:215]
    ds_read_b64_tr_b16 v[164:165], v73 offset:1024
    ds_read_b64_tr_b16 v[166:167], v73 offset:1536
    v_lshrrev_b32 v1, 5, v0
    v_lshl_add_u32 v114, v1, 2, v114
    v_and_b32 v37, 16, v0
    v_cmp_eq_u32 vcc, 0, v37
    v_mfma_f32_16x16x32_bf16 v[120:123], v[14:17], v[156:159], v[120:123]
    s_nop 1
    v_cndmask_b32 v114, v39, v114, vcc
    v_readfirstlane_b32 s88, v111
    v_readfirstlane_b32 s89, v113
    v_readfirstlane_b32 s90, v114
    v_and_b32 v1, 7, v0
    v_mfma_f32_32x32x16_bf16 v[216:231], v[156:159], a[188:191], v[216:231]
    ds_read_b128 v[240:243], v68 offset:49152
    buffer_load_dwordx4 v51, s[8:11], s93 offen offset:2048 lds
    v_lshl_add_u32 v37, v1, 7, s88
    v_bfe_u32 v1, v0, 3, 1
    v_lshl_add_u32 v37, v1, 14, v37
    v_and_b32 v1, 1, v0
    s_waitcnt lgkmcnt(14)
    v_dot2c_f32_bf16 v74, s57, v232
    v_dot2c_f32_bf16 v76, v232, v232
    v_dot2c_f32_bf16 v74, s57, v233
    v_dot2c_f32_bf16 v76, v233, v233
    v_dot2c_f32_bf16 v74, s57, v234
    v_dot2c_f32_bf16 v76, v234, v234
    v_dot2c_f32_bf16 v74, s57, v235
    v_dot2c_f32_bf16 v76, v235, v235
    s_waitcnt lgkmcnt(8)
    v_mfma_f32_32x32x16_bf16 v[200:215], v[160:163], a[64:67], v[200:215]
    ds_read_b64_tr_b16 v[156:157], v73 offset:2048
    ds_read_b64_tr_b16 v[158:159], v73 offset:2560
    buffer_load_dwordx4 v51, s[8:11], s94 offen offset:3072 lds
    v_lshl_add_u32 v38, v1, 7, s89
    v_bfe_u32 v1, v0, 1, 3
    v_lshl_add_u32 v38, v1, 9, v38
    v_mfma_f32_16x16x32_bf16 v[120:123], v[14:17], v[160:163], v[120:123]
    v_cmp_gt_u32 vcc, 64, v0
    v_readfirstlane_b32 s88, v42
    v_readfirstlane_b32 s89, v44
    v_cndmask_b32 v119, v38, v37, vcc
    s_mul_i32 s91, s99, 248
    v_writelane_b32 v119, s90, 32
    s_add_u32 s88, s88, s91
    v_mfma_f32_32x32x16_bf16 v[216:231], v[160:163], a[192:195], v[216:231]
    ds_read_b128 v[244:247], v69 offset:49152
    v_and_b32 v47, 3, v0
    v_lshlrev_b32 v46, 10, v47
    s_lshl_b32 s97, s96, 12
    buffer_load_dword v2, v46, s[16:19], s97 offen offset:384
    s_waitcnt lgkmcnt(6)
    v_dot2c_f32_bf16 v74, s57, v236
    v_dot2c_f32_bf16 v76, v236, v236
    v_dot2c_f32_bf16 v74, s57, v237
    v_dot2c_f32_bf16 v76, v237, v237
    v_dot2c_f32_bf16 v74, s57, v238
    v_dot2c_f32_bf16 v76, v238, v238
    v_dot2c_f32_bf16 v74, s57, v239
    v_dot2c_f32_bf16 v76, v239, v239
    s_waitcnt lgkmcnt(4)
    v_mfma_f32_32x32x16_bf16 v[200:215], v[164:167], a[68:71], v[200:215]
    ds_read_b64_tr_b16 v[160:161], v73 offset:3072
    ds_read_b64_tr_b16 v[162:163], v73 offset:3584
    v_writelane_b32 v119, s88, 33
    s_add_u32 s88, s88, 128
    s_add_u32 s90, s89, 16384
    v_writelane_b32 v119, s88, 34
    v_mfma_f32_16x16x32_bf16 v[120:123], v[14:17], v[164:167], v[120:123]
    v_writelane_b32 v119, s90, 35
    s_add_u32 s90, s89, 24576
    v_writelane_b32 v119, s90, 36
    v_lshrrev_b32 v1, 4, v0
    v_lshlrev_b32 v115, 7, v1
    v_and_b32 v1, 15, v0
    v_lshl_add_u32 v115, v1, 2, v115
    v_mfma_f32_32x32x16_bf16 v[216:231], v[164:167], a[196:199], v[216:231]
    ds_read_b128 v[248:251], v68 offset:57344
    v_and_b32 v47, 3, v0
    v_lshlrev_b32 v46, 7, v47
    s_lshl_b32 s97, s2, 11
    s_lshl_b32 s98, s44, 9
    s_add_u32 s97, s97, s98
    buffer_load_dword v2, v46, s[16:19], s97 offen offset:0
    s_waitcnt lgkmcnt(6)
    v_dot2c_f32_bf16 v74, s57, v240
    v_dot2c_f32_bf16 v76, v240, v240
    v_dot2c_f32_bf16 v74, s57, v241
    v_dot2c_f32_bf16 v76, v241, v241
    v_dot2c_f32_bf16 v74, s57, v242
    v_dot2c_f32_bf16 v76, v242, v242
    v_dot2c_f32_bf16 v74, s57, v243
    v_dot2c_f32_bf16 v76, v243, v243
    s_waitcnt lgkmcnt(4)
    v_mfma_f32_32x32x16_bf16 v[200:215], v[156:159], a[72:75], v[200:215]
    s_waitcnt vmcnt(11)
    s_barrier
    v_add_u32 v73, 0xffff0000, v73
    ds_read_b64_tr_b16 v[164:165], v73 offset:0
    ds_read_b64_tr_b16 v[166:167], v73 offset:512
    v_min_u32 v46, 13, v0
    v_lshlrev_b32 v46, 7, v46
    s_mul_i32 s97, s2, 7168
    s_mul_i32 s98, s44, 1792
    s_add_u32 s97, s97, s98
    buffer_load_dword v2, v46, s[4:7], s97 offen offset:0
    s_add_u32 m0, s62, 81920
    v_mfma_f32_16x16x32_bf16 v[120:123], v[14:17], v[156:159], v[120:123]
    s_mul_i32 s89, s44, 1088
    s_add_u32 s89, s89, 151040
    v_and_b32 v1, 15, v0
    v_lshl_add_u32 v116, v1, 4, s89
    v_lshrrev_b32 v1, 4, v0
    v_mul_u32_u24 v1, 272, v1
    v_add_u32 v116, v116, v1
    v_mfma_f32_32x32x16_bf16 v[216:231], v[156:159], a[200:203], v[216:231]
    s_branch L_page1
    .p2align 12
L_pad1:
    s_setpc_b64 s[0:1]
    s_nop 0
L_page1:
    ds_read_b128 v[232:235], v69 offset:57344
    buffer_load_dwordx4 v50, s[8:11], 0 offen offset:0 lds
    v_and_b32 v1, 3, v0
    v_lshl_add_u32 v117, v1, 2, s89
    v_lshrrev_b32 v1, 5, v0
    v_lshl_add_u32 v117, v1, 1, v117
    s_waitcnt lgkmcnt(6)
    v_dot2c_f32_bf16 v74, s57, v244
    v_dot2c_f32_bf16 v76, v244, v244
    v_dot2c_f32_bf16 v74, s57, v245
    v_dot2c_f32_bf16 v76, v245, v245
    v_dot2c_f32_bf16 v74, s57, v246
    v_dot2c_f32_bf16 v76, v246, v246
    v_dot2c_f32_bf16 v74, s57, v247
    v_dot2c_f32_bf16 v76, v247, v247
    s_waitcnt lgkmcnt(4)
    v_mfma_f32_32x32x16_bf16 v[200:215], v[160:163], a[76:79], v[200:215]
    ds_read_b64_tr_b16 v[156:157], v73 offset:1024
    ds_read_b64_tr_b16 v[158:159], v73 offset:1536
    v_bfe_u32 v1, v0, 2, 2
    v_mul_u32_u24 v1, 272, v1
    v_add_u32 v117, v117, v1
    s_mul_i32 s89, s52, 2176
    v_mfma_f32_16x16x32_bf16 v[120:123], v[14:17], v[160:163], v[120:123]
    s_add_u32 s89, s89, 151040
    v_and_b32 v37, 31, v0
    v_min_u32 v37, 16, v37
    v_lshl_add_u32 v118, v37, 4, s89
    v_lshrrev_b32 v1, 5, v0
    v_mul_u32_u24 v1, 272, v1
    v_add_u32 v118, v118, v1
    v_mfma_f32_32x32x16_bf16 v[216:231], v[160:163], a[204:207], v[216:231]
    buffer_load_dwordx4 v50, s[8:11], s92 offen offset:1024 lds
    v_lshrrev_b32 v37, 4, v0
    v_xor_b32 v37, v37, v0
    v_and_b32 v37, 7, v37
    s_lshl_b32 s88, s95, 17
    s_lshl_b32 s91, s99, 11
    s_waitcnt lgkmcnt(5)
    v_dot2c_f32_bf16 v74, s57, v248
    v_dot2c_f32_bf16 v76, v248, v248
    v_dot2c_f32_bf16 v74, s57, v249
    v_dot2c_f32_bf16 v76, v249, v249
    v_dot2c_f32_bf16 v74, s57, v250
    v_dot2c_f32_bf16 v76, v250, v250
    v_dot2c_f32_bf16 v74, s57, v251
    v_dot2c_f32_bf16 v76, v251, v251
    s_waitcnt lgkmcnt(3)
    v_mfma_f32_32x32x16_bf16 v[200:215], v[164:167], a[80:83], v[200:215]
    ds_read_b64_tr_b16 v[160:161], v73 offset:2048
    ds_read_b64_tr_b16 v[162:163], v73 offset:2560
    s_add_u32 s88, s88, s91
    v_lshl_add_u32 v34, v37, 4, s88
    v_bfe_u32 v1, v0, 3, 2
    v_lshl_add_u32 v34, v1, 12, v34
    v_mfma_f32_16x16x32_bf16 v[120:123], v[14:17], v[164:167], v[120:123]
    v_lshrrev_b32 v1, 5, v0
    v_lshl_add_u32 v34, v1, 15, v34
    v_xor_b32 v35, 64, v34
    v_bfe_u32 v37, v0, 1, 3
    v_xor_b32 v37, v37, v1
    v_lshl_add_u32 v30, v37, 4, s62
    v_and_b32 v1, 31, v0
    v_mfma_f32_32x32x16_bf16 v[216:231], v[164:167], a[208:211], v[216:231]
    buffer_load_dwordx4 v50, s[8:11], s93 offen offset:2048 lds
    v_lshl_add_u32 v30, v1, 7, v30
    v_xor_b32 v31, 32, v30
    v_xor_b32 v32, 64, v30
    v_xor_b32 v33, 96, v30
    v_mov_b32 v52, 0
    s_waitcnt lgkmcnt(4)
    v_dot2c_f32_bf16 v74, s57, v232
    v_dot2c_f32_bf16 v76, v232, v232
    v_dot2c_f32_bf16 v74, s57, v233
    v_dot2c_f32_bf16 v76, v233, v233
    v_dot2c_f32_bf16 v74, s57, v234
    v_dot2c_f32_bf16 v76, v234, v234
    v_dot2c_f32_bf16 v74, s57, v235
    v_dot2c_f32_bf16 v76, v235, v235
    s_nop 2
    v_permlane32_swap_b32 v74, v76
    v_add_f32 v74, v74, v76
    v_mov_b32 v76, v74
    s_nop 1
    v_permlane16_swap_b32 v74, v76
    v_add_f32 v74, v74, v76
    ds_write_b32 v70, v74
    s_waitcnt lgkmcnt(3)
    v_mfma_f32_32x32x16_bf16 v[200:215], v[156:159], a[84:87], v[200:215]
    ds_read_b64_tr_b16 v[164:165], v73 offset:3072
    ds_read_b64_tr_b16 v[166:167], v73 offset:3584
    v_mov_b32 v53, 0
    v_mov_b32 v54, 0
    v_mov_b32 v55, 0
    v_and_b32 v38, 16, v0
    v_mfma_f32_16x16x32_bf16 v[120:123], v[14:17], v[156:159], v[120:123]
    v_cmp_ne_u32 vcc, 0, v38
    v_bfe_u32 v1, v0, 2, 3
    v_lshl_add_u32 v37, v1, 3, s45
    v_lshl_add_u32 v38, s47, 3, v1
    v_cndmask_b32 v168, 0, 1.0, vcc
    v_cndmask_b32 v104, 0, v100, vcc
    v_cndmask_b32 v100, v100, 0, vcc
    v_mfma_f32_32x32x16_bf16 v[216:231], v[156:159], a[212:215], v[216:231]
    buffer_load_dwordx4 v50, s[8:11], s94 offen offset:3072 lds
    v_cndmask_b32 v105, 0, v101, vcc
    v_cndmask_b32 v101, v101, 0, vcc
    v_cndmask_b32 v106, 0, v102, vcc
    v_cndmask_b32 v102, v102, 0, vcc
    s_waitcnt lgkmcnt(3)
    v_mfma_f32_32x32x16_bf16 v[200:215], v[160:163], a[88:91], v[200:215]
    s_waitcnt vmcnt(12)
    s_barrier
    ds_read_b64_tr_b16 v[156:157], v73 offset:16384
    ds_read_b64_tr_b16 v[158:159], v73 offset:16896
    s_mov_b32 s97, 0x60000
    s_cmp_eq_u32 s85, 3
    s_cselect_b32 s97, 0xffee0000, s97
    v_add_u32 v50, s97, v50
    s_add_u32 m0, s62, 98304
    v_mfma_f32_16x16x32_bf16 v[120:123], v[14:17], v[160:163], v[120:123]
    v_cndmask_b32 v107, 0, v103, vcc
    v_cndmask_b32 v103, v103, 0, vcc
    v_cndmask_b32 v96, 0, v92, vcc
    v_cndmask_b32 v92, v92, 0, vcc
    v_cndmask_b32 v97, 0, v93, vcc
    v_cndmask_b32 v93, v93, 0, vcc
    v_cndmask_b32 v98, 0, v94, vcc
    v_mfma_f32_32x32x16_bf16 v[216:231], v[160:163], a[216:219], v[216:231]
    buffer_load_dwordx4 v50, s[8:11], 0 offen offset:0 lds
    v_cndmask_b32 v94, v94, 0, vcc
    v_cndmask_b32 v99, 0, v95, vcc
    v_cndmask_b32 v95, v95, 0, vcc
    v_cmp_le_u32 vcc, 32, v0
    s_waitcnt lgkmcnt(2)
    v_mfma_f32_32x32x16_bf16 v[200:215], v[164:167], a[92:95], v[200:215]
    ds_read_b64_tr_b16 v[160:161], v73 offset:17408
    ds_read_b64_tr_b16 v[162:163], v73 offset:17920
    v_sub_u32 v58, v58, v36
    v_min_u32 v1, 8, v0
    v_lshl_add_u32 v58, v1, 7, v58
    v_add_u32 v59, 16384, v57
    v_mfma_f32_16x16x32_bf16 v[120:123], v[14:17], v[164:167], v[120:123]
    v_cndmask_b32 v37, v37, v38, vcc
    v_lshlrev_b32 v81, 7, v37
    v_and_b32 v1, 3, v0
    v_lshl_add_u32 v81, v1, 3, v81
    v_add_u32 v81, 4096, v81
    v_mov_b32 v169, v168
    v_mov_b32 v170, v168
    v_mfma_f32_32x32x16_bf16 v[216:231], v[164:167], a[220:223], v[216:231]
    buffer_load_dwordx4 v50, s[8:11], s92 offen offset:1024 lds
    v_mov_b32 v171, v168
    v_mov_b32 v172, v168
    v_mov_b32 v173, v168
    v_mov_b32 v174, v168
    s_waitcnt lgkmcnt(2)
    v_mfma_f32_32x32x16_bf16 v[200:215], v[156:159], a[96:99], v[200:215]
    ds_read_b64_tr_b16 v[164:165], v73 offset:18432
    ds_read_b64_tr_b16 v[166:167], v73 offset:18944
    v_mov_b32 v175, v168
    v_mov_b32 v176, v168
    v_mov_b32 v177, v168
    v_mov_b32 v178, v168
    v_mfma_f32_16x16x32_bf16 v[120:123], v[14:17], v[156:159], v[120:123]
    v_mov_b32 v179, v168
    v_mov_b32 v180, v168
    v_mov_b32 v181, v168
    v_mov_b32 v182, v168
    v_mov_b32 v183, v168
    s_lshr_b32 s89, s46, 1
    s_and_b32 s90, s46, 1
    v_mfma_f32_32x32x16_bf16 v[216:231], v[156:159], a[224:227], v[216:231]
    buffer_load_dwordx4 v50, s[8:11], s93 offen offset:2048 lds
    s_mov_b32 s58, 262144
    s_lshl_b32 s88, s45, 19
    s_lshl_b32 s91, s51, 15
    s_add_u32 s88, s88, s91
    s_waitcnt lgkmcnt(2)
    v_mfma_f32_32x32x16_bf16 v[200:215], v[160:163], a[100:103], v[200:215]
    ds_read_b64_tr_b16 v[156:157], v73 offset:19456
    ds_read_b64_tr_b16 v[158:159], v73 offset:19968
    s_lshl_b32 s91, s89, 14
    s_add_u32 s88, s88, s91
    s_lshl_b32 s91, s47, 11
    s_add_u32 s88, s88, s91
    v_mfma_f32_16x16x32_bf16 v[120:123], v[14:17], v[160:163], v[120:123]
    s_lshl_b32 s91, s52, 10
    s_add_u32 s88, s88, s91
    s_mul_i32 s91, s90, 272
    s_add_u32 s88, s88, s91
    s_add_u32 s88, s88, 4194304
    v_lshrrev_b32 v1, 5, v0
    v_lshl_add_u32 v110, v1, 16, s88
    v_mfma_f32_32x32x16_bf16 v[216:231], v[160:163], a[228:231], v[216:231]
    buffer_load_dwordx4 v50, s[8:11], s94 offen offset:3072 lds
    v_and_b32 v1, 31, v0
    v_lshl_add_u32 v110, v1, 4, v110
    v_cmp_ge_u32 vcc, 16, v1
    s_waitcnt lgkmcnt(2)
    v_mfma_f32_32x32x16_bf16 v[200:215], v[164:167], a[104:107], v[200:215]
    s_waitcnt vmcnt(11)
    s_barrier
    ds_read_b64 v[74:75], v71
    ds_read_b64 v[76:77], v72
    ds_read_b64_tr_b16 v[160:161], v73 offset:32768
    ds_read_b64_tr_b16 v[162:163], v73 offset:33280
    v_mfma_f32_16x16x32_bf16 v[120:123], v[14:17], v[164:167], v[120:123]
    s_nop 1
    v_cndmask_b32 v110, v39, v110, vcc
    v_mfma_f32_32x32x16_bf16 v[216:231], v[164:167], a[232:235], v[216:231]
    buffer_load_dwordx2 v[90:91], v81, s[40:43], 0 offen sc1
    s_waitcnt lgkmcnt(4)
    v_mfma_f32_32x32x16_bf16 v[200:215], v[156:159], a[108:111], v[200:215]
    ds_read_b64_tr_b16 v[164:165], v73 offset:33792
    ds_read_b64_tr_b16 v[166:167], v73 offset:34304
    v_mfma_f32_16x16x32_bf16 v[120:123], v[14:17], v[156:159], v[120:123]
    v_mfma_f32_32x32x16_bf16 v[216:231], v[156:159], a[236:239], v[216:231]
    buffer_load_dword v2, v119, s[40:43], 0 offen offset:0 sc1
    s_waitcnt lgkmcnt(2)
    v_mfma_f32_32x32x16_bf16 v[200:215], v[160:163], a[112:115], v[200:215]
    ds_read_b64_tr_b16 v[156:157], v73 offset:34816
    ds_read_b64_tr_b16 v[158:159], v73 offset:35328
    s_mov_b32 s97, 0x60000
    s_cmp_eq_u32 s85, 2
    s_cselect_b32 s97, 0xffee0000, s97
    v_add_u32 v50, s97, v50
    s_add_u32 m0, s62, 114688
    v_mfma_f32_16x16x32_bf16 v[120:123], v[14:17], v[160:163], v[120:123]
    v_mfma_f32_32x32x16_bf16 v[216:231], v[160:163], a[240:243], v[216:231]
    buffer_load_dwordx4 v50, s[8:11], 0 offen offset:0 lds
    v_mul_f32 v74, 0x3b000000, v74
    v_mul_f32 v37, v74, v74
    v_fmamk_f32 v75, v75, 0xbb000000, v37
    v_min_f32 v75, 0, v75
    s_waitcnt lgkmcnt(2)
    v_mfma_f32_32x32x16_bf16 v[200:215], v[164:167], a[116:119], v[200:215]
    ds_read_b64_tr_b16 v[160:161], v73 offset:35840
    ds_read_b64_tr_b16 v[162:163], v73 offset:36352
    v_sub_f32 v75, 0x3727c5ac, v75
    v_rsq_f32 v75, v75
    v_cvt_pk_bf16_f32 v82, -v74, -v74
    v_mfma_f32_16x16x32_bf16 v[120:123], v[14:17], v[164:167], v[120:123]
    v_and_b32 v37, 0xffff0000, v82
    v_sub_f32 v37, -v74, v37
    v_cvt_pk_bf16_f32 v83, v37, 0
    v_mov_b32 v84, 0
    v_mov_b32 v85, 0
    v_mul_f32 v108, 0x3fb8aa3b, v75
    v_mul_f32 v76, 0x3b000000, v76
    v_mfma_f32_32x32x16_bf16 v[216:231], v[164:167], a[244:247], v[216:231]
    buffer_load_dwordx4 v50, s[8:11], s92 offen offset:1024 lds
    v_mul_f32 v37, v76, v76
    v_fmamk_f32 v77, v77, 0xbb000000, v37
    v_min_f32 v77, 0, v77
    v_sub_f32 v77, 0x3727c5ac, v77
    s_waitcnt lgkmcnt(2)
    v_mfma_f32_32x32x16_bf16 v[200:215], v[156:159], a[120:123], v[200:215]
    v_rsq_f32 v77, v77
    v_cvt_pk_bf16_f32 v86, -v76, -v76
    v_and_b32 v37, 0xffff0000, v86
    v_sub_f32 v37, -v76, v37
    v_cvt_pk_bf16_f32 v87, v37, 0
    v_mfma_f32_16x16x32_bf16 v[120:123], v[14:17], v[156:159], v[120:123]
    v_mov_b32 v88, 0
    v_mov_b32 v89, 0
    v_mfma_f32_32x32x16_bf16 v[216:231], v[156:159], a[248:251], v[216:231]
    buffer_load_dwordx4 v50, s[8:11], s93 offen offset:2048 lds
    v_mul_f32 v109, 0x3fb8aa3b, v77
    s_waitcnt lgkmcnt(0)
    v_mfma_f32_32x32x16_bf16 v[200:215], v[160:163], a[124:127], v[200:215]
    v_mfma_f32_16x16x32_bf16 v[120:123], v[14:17], v[160:163], v[120:123]
    v_mfma_f32_32x32x16_bf16 v[216:231], v[160:163], a[252:255], v[216:231]
    buffer_load_dwordx4 v50, s[8:11], s94 offen offset:3072 lds
    s_nop 5
    v_cvt_pk_bf16_f32 v121, v120, 0
    v_lshlrev_b32 v122, 16, v121
    v_sub_f32 v122, v120, v122
    v_cvt_pk_bf16_f32 v120, v120, v122
    v_mov_b32 v122, 0
    v_mov_b32 v123, 0
    s_nop 1
    v_mfma_f32_32x32x16_bf16 v[200:215], v[120:123], v[82:85], v[200:215]
    v_mfma_f32_32x32x16_bf16 v[216:231], v[120:123], v[86:89], v[216:231]
    s_barrier
    s_mov_b32 s97, 0x60000
    s_cmp_eq_u32 s85, 1
    s_cselect_b32 s97, 0xffee0000, s97
    v_add_u32 v50, s97, v50
    s_add_u32 m0, s62, 49152
    s_nop 0
    buffer_load_dwordx4 v50, s[8:11], 0 offen offset:0 lds
    s_nop 2
    v_cvt_pk_bf16_f32 v60, v200, v201
    v_cvt_pk_bf16_f32 v61, v202, v203
    v_cvt_pk_bf16_f32 v62, v204, v205
    v_cvt_pk_bf16_f32 v63, v206, v207
    s_nop 1
    v_mfma_f32_32x32x16_bf16 v[152:167], v[100:103], v[60:63], 0
    v_cvt_pk_bf16_f32 v64, v216, v217
    v_cvt_pk_bf16_f32 v65, v218, v219
    v_cvt_pk_bf16_f32 v66, v220, v221
    v_cvt_pk_bf16_f32 v67, v222, v223
    s_nop 1
    v_mfma_f32_32x32x16_bf16 v[152:167], v[104:107], v[64:67], v[152:167]
    buffer_load_dwordx4 v50, s[8:11], s92 offen offset:1024 lds
    v_mul_f32 v224, v224, v77
    v_mul_f32 v225, v225, v77
    v_mul_f32 v226, v226, v77
    v_mul_f32 v227, v227, v77
    v_mul_f32 v228, v228, v77
    v_mul_f32 v229, v229, v77
    v_mul_f32 v230, v230, v77
    v_mul_f32 v231, v231, v77
    v_cvt_pk_bf16_f32 v244, v224, v225
    v_cvt_pk_bf16_f32 v245, v226, v227
    v_cvt_pk_bf16_f32 v246, v228, v229
    v_cvt_pk_bf16_f32 v247, v230, v231
    v_mul_f32 v208, v208, v75
    v_mul_f32 v209, v209, v75
    v_mul_f32 v210, v210, v75
    v_mul_f32 v211, v211, v75
    v_mul_f32 v212, v212, v75
    v_mul_f32 v213, v213, v75
    v_mul_f32 v214, v214, v75
    v_mul_f32 v215, v215, v75
    v_mfma_f32_32x32x16_bf16 v[184:199], v[244:247], v[6:9], v[168:183]
    v_cvt_pk_bf16_f32 v240, v208, v209
    v_cvt_pk_bf16_f32 v241, v210, v211
    v_cvt_pk_bf16_f32 v242, v212, v213
    v_cvt_pk_bf16_f32 v243, v214, v215
    v_max3_f32 v232, v152, v153, v154
    v_max3_f32 v236, v155, v156, v157
    v_max3_f32 v232, v158, v159, v232
    v_max_f32 v232, v232, v236
    v_mfma_f32_32x32x16_bf16 v[168:183], v[240:243], v[6:9], v[168:183]
    v_max3_f32 v233, v160, v161, v162
    v_max3_f32 v237, v163, v164, v165
    v_max3_f32 v233, v166, v167, v233
    v_max_f32 v233, v233, v237
    v_min3_f32 v234, v152, v153, v154
    v_min3_f32 v236, v155, v156, v157
    v_min3_f32 v234, v158, v159, v234
    v_min_f32 v234, v234, v236
    v_min3_f32 v235, v160, v161, v162
    v_min3_f32 v237, v163, v164, v165
    v_min3_f32 v235, v166, v167, v235
    v_min_f32 v235, v235, v237
    buffer_load_dwordx4 v50, s[8:11], s93 offen offset:2048 lds
    v_permlane32_swap_b32 v232, v233
    v_permlane32_swap_b32 v234, v235
    v_max_f32 v232, v232, v233
    v_min_f32 v234, v234, v235
    v_mov_b32 v233, v232
    v_mov_b32 v235, v234
    s_nop 0
    v_permlane32_swap_b32 v232, v233
    v_permlane32_swap_b32 v234, v235
    v_pk_mul_f32 v[232:233], v[232:233], v[108:109] op_sel_hi:[1,1]
    v_pk_mul_f32 v[234:235], v[234:235], v[108:109] op_sel_hi:[1,1]
    v_pk_fma_f32 v[120:121], v[152:153], v[108:109], v[232:233] op_sel:[0,0,0] op_sel_hi:[1,0,0] neg_lo:[0,0,1] neg_hi:[0,0,1]
    v_pk_fma_f32 v[128:129], v[152:153], v[108:109], v[234:235] op_sel:[0,0,0] op_sel_hi:[1,0,0] neg_lo:[1,0,0] neg_hi:[1,0,0]
    v_pk_fma_f32 v[122:123], v[154:155], v[108:109], v[232:233] op_sel:[0,0,0] op_sel_hi:[1,0,0] neg_lo:[0,0,1] neg_hi:[0,0,1]
    v_pk_fma_f32 v[130:131], v[154:155], v[108:109], v[234:235] op_sel:[0,0,0] op_sel_hi:[1,0,0] neg_lo:[1,0,0] neg_hi:[1,0,0]
    v_pk_fma_f32 v[124:125], v[156:157], v[108:109], v[232:233] op_sel:[0,0,0] op_sel_hi:[1,0,0] neg_lo:[0,0,1] neg_hi:[0,0,1]
    v_pk_fma_f32 v[132:133], v[156:157], v[108:109], v[234:235] op_sel:[0,0,0] op_sel_hi:[1,0,0] neg_lo:[1,0,0] neg_hi:[1,0,0]
    v_pk_fma_f32 v[126:127], v[158:159], v[108:109], v[232:233] op_sel:[0,0,0] op_sel_hi:[1,0,0] neg_lo:[0,0,1] neg_hi:[0,0,1]
    v_pk_fma_f32 v[134:135], v[158:159], v[108:109], v[234:235] op_sel:[0,0,0] op_sel_hi:[1,0,0] neg_lo:[1,0,0] neg_hi:[1,0,0]
    v_pk_fma_f32 v[136:137], v[160:161], v[108:109], v[232:233] op_sel:[0,1,1] op_sel_hi:[1,1,1] neg_lo:[0,0,1] neg_hi:[0,0,1]
    v_pk_fma_f32 v[144:145], v[160:161], v[108:109], v[234:235] op_sel:[0,1,1] op_sel_hi:[1,1,1] neg_lo:[1,0,0] neg_hi:[1,0,0]
    v_pk_fma_f32 v[138:139], v[162:163], v[108:109], v[232:233] op_sel:[0,1,1] op_sel_hi:[1,1,1] neg_lo:[0,0,1] neg_hi:[0,0,1]
    v_pk_fma_f32 v[146:147], v[162:163], v[108:109], v[234:235] op_sel:[0,1,1] op_sel_hi:[1,1,1] neg_lo:[1,0,0] neg_hi:[1,0,0]
    v_pk_fma_f32 v[140:141], v[164:165], v[108:109], v[232:233] op_sel:[0,1,1] op_sel_hi:[1,1,1] neg_lo:[0,0,1] neg_hi:[0,0,1]
    v_pk_fma_f32 v[148:149], v[164:165], v[108:109], v[234:235] op_sel:[0,1,1] op_sel_hi:[1,1,1] neg_lo:[1,0,0] neg_hi:[1,0,0]
    v_pk_fma_f32 v[142:143], v[166:167], v[108:109], v[232:233] op_sel:[0,1,1] op_sel_hi:[1,1,1] neg_lo:[0,0,1] neg_hi:[0,0,1]
    v_pk_fma_f32 v[150:151], v[166:167], v[108:109], v[234:235] op_sel:[0,1,1] op_sel_hi:[1,1,1] neg_lo:[1,0,0] neg_hi:[1,0,0]
    buffer_load_dwordx4 v50, s[8:11], s94 offen offset:3072 lds
    v_exp_f32 v120, v120
    v_exp_f32 v121, v121
    v_exp_f32 v122, v122
    v_exp_f32 v123, v123
    v_exp_f32 v124, v124
    v_exp_f32 v125, v125
    v_exp_f32 v126, v126
    v_exp_f32 v127, v127
    v_readfirstlane_b32 s97, v113
    v_and_b32 v47, 1, v0
    v_lshlrev_b32 v46, 7, v47
    v_bfe_u32 v47, v0, 1, 3
    v_lshl_add_u32 v46, v47, 9, v46
    s_nop 0
    buffer_load_dword v2, v46, s[40:43], s97 offen sc1
    v_exp_f32 v128, v128
    v_exp_f32 v129, v129
    v_exp_f32 v130, v130
    v_exp_f32 v131, v131
    v_exp_f32 v132, v132
    v_exp_f32 v133, v133
    v_exp_f32 v134, v134
    v_exp_f32 v135, v135
    s_add_u32 m0, s62, 65536
    s_mov_b32 s92, 3072
    s_mov_b32 s93, 14336
    s_mov_b32 s94, 17408
    buffer_load_dwordx4 v40, s[16:19], 0 offen offset:0 lds
    v_exp_f32 v136, v136
    v_exp_f32 v137, v137
    v_exp_f32 v138, v138
    v_exp_f32 v139, v139
    v_exp_f32 v140, v140
    v_exp_f32 v141, v141
    v_exp_f32 v142, v142
    v_exp_f32 v143, v143
    v_exp_f32 v144, v144
    v_exp_f32 v145, v145
    v_exp_f32 v146, v146
    v_exp_f32 v147, v147
    v_exp_f32 v148, v148
    v_exp_f32 v149, v149
    v_exp_f32 v150, v150
    v_exp_f32 v151, v151
    v_pk_add_f32 v[152:153], v[120:121], v[122:123]
    v_pk_add_f32 v[154:155], v[124:125], v[126:127]
    v_pk_add_f32 v[156:157], v[128:129], v[130:131]
    v_pk_add_f32 v[158:159], v[132:133], v[134:135]
    v_pk_add_f32 v[160:161], v[136:137], v[138:139]
    v_pk_add_f32 v[162:163], v[140:141], v[142:143]
    v_pk_add_f32 v[164:165], v[144:145], v[146:147]
    v_pk_add_f32 v[166:167], v[148:149], v[150:151]
    v_pk_add_f32 v[152:153], v[152:153], v[154:155]
    v_pk_add_f32 v[156:157], v[156:157], v[158:159]
    v_pk_add_f32 v[160:161], v[160:161], v[162:163]
    v_pk_add_f32 v[164:165], v[164:165], v[166:167]
    v_add_f32 v232, v152, v153
    v_add_f32 v233, v156, v157
    v_add_f32 v234, v160, v161
    v_add_f32 v235, v164, v165
    v_permlane32_swap_b32 v232, v233
    s_nop 0
    v_permlane32_swap_b32 v234, v235
    v_add_f32 v232, v232, v233
    v_add_f32 v234, v234, v235
    v_rcp_f32 v232, v232
    v_rcp_f32 v234, v234
    v_mov_b32 v233, v232
    v_mov_b32 v235, v234
    s_nop 0
    v_permlane32_swap_b32 v232, v233
    v_permlane32_swap_b32 v234, v235
    v_pk_mul_f32 v[120:121], v[120:121], v[232:233] op_sel:[0,0] op_sel_hi:[1,0]
    v_pk_mul_f32 v[122:123], v[122:123], v[232:233] op_sel:[0,0] op_sel_hi:[1,0]
    v_pk_mul_f32 v[124:125], v[124:125], v[232:233] op_sel:[0,0] op_sel_hi:[1,0]
    v_pk_mul_f32 v[126:127], v[126:127], v[232:233] op_sel:[0,0] op_sel_hi:[1,0]
    v_pk_mul_f32 v[128:129], v[128:129], v[232:233] op_sel:[0,1] op_sel_hi:[1,1]
    v_pk_mul_f32 v[130:131], v[130:131], v[232:233] op_sel:[0,1] op_sel_hi:[1,1]
    v_pk_mul_f32 v[132:133], v[132:133], v[232:233] op_sel:[0,1] op_sel_hi:[1,1]
    v_pk_mul_f32 v[134:135], v[134:135], v[232:233] op_sel:[0,1] op_sel_hi:[1,1]
    v_pk_mul_f32 v[136:137], v[136:137], v[234:235] op_sel:[0,0] op_sel_hi:[1,0]
    v_pk_mul_f32 v[138:139], v[138:139], v[234:235] op_sel:[0,0] op_sel_hi:[1,0]
    v_pk_mul_f32 v[140:141], v[140:141], v[234:235] op_sel:[0,0] op_sel_hi:[1,0]
    v_pk_mul_f32 v[142:143], v[142:143], v[234:235] op_sel:[0,0] op_sel_hi:[1,0]
    v_pk_mul_f32 v[144:145], v[144:145], v[234:235] op_sel:[0,1] op_sel_hi:[1,1]
    v_pk_mul_f32 v[146:147], v[146:147], v[234:235] op_sel:[0,1] op_sel_hi:[1,1]
    v_pk_mul_f32 v[148:149], v[148:149], v[234:235] op_sel:[0,1] op_sel_hi:[1,1]
    v_pk_mul_f32 v[150:151], v[150:151], v[234:235] op_sel:[0,1] op_sel_hi:[1,1]
    v_cvt_pk_bf16_f32 v152, v120, v121
    v_cvt_pk_bf16_f32 v153, v122, v123
    v_cvt_pk_bf16_f32 v154, v124, v125
    v_cvt_pk_bf16_f32 v155, v126, v127
    v_cvt_pk_bf16_f32 v240, v168, v169
    v_cvt_pk_bf16_f32 v241, v170, v171
    v_mfma_f32_32x32x16_bf16 v[200:215], v[152:155], v[6:9], 0
    v_cvt_pk_bf16_f32 v156, v128, v129
    v_cvt_pk_bf16_f32 v157, v130, v131
    v_cvt_pk_bf16_f32 v158, v132, v133
    v_cvt_pk_bf16_f32 v159, v134, v135
    v_cvt_pk_bf16_f32 v242, v172, v173
    v_cvt_pk_bf16_f32 v243, v174, v175
    v_mfma_f32_32x32x16_bf16 v[200:215], v[156:159], v[10:13], v[200:215]
    v_cvt_pk_bf16_f32 v160, v136, v137
    v_cvt_pk_bf16_f32 v161, v138, v139
    v_cvt_pk_bf16_f32 v162, v140, v141
    v_cvt_pk_bf16_f32 v163, v142, v143
    v_cvt_pk_bf16_f32 v244, v176, v177
    v_cvt_pk_bf16_f32 v245, v178, v179
    v_mfma_f32_32x32x16_bf16 v[216:231], v[160:163], v[6:9], 0
    v_cvt_pk_bf16_f32 v164, v144, v145
    v_cvt_pk_bf16_f32 v165, v146, v147
    v_cvt_pk_bf16_f32 v166, v148, v149
    v_cvt_pk_bf16_f32 v167, v150, v151
    v_cvt_pk_bf16_f32 v246, v180, v181
    v_cvt_pk_bf16_f32 v247, v182, v183
    v_mfma_f32_32x32x16_bf16 v[216:231], v[164:167], v[10:13], v[216:231]
    v_cvt_pk_bf16_f32 v248, v184, v185
    v_cvt_pk_bf16_f32 v249, v186, v187
    v_cvt_pk_bf16_f32 v250, v188, v189
    v_cvt_pk_bf16_f32 v251, v190, v191
    v_cvt_pk_bf16_f32 v152, v200, v201
    v_cvt_pk_bf16_f32 v153, v202, v203
    v_cvt_pk_bf16_f32 v154, v204, v205
    v_cvt_pk_bf16_f32 v155, v206, v207
    v_cvt_pk_bf16_f32 v156, v208, v209
    v_cvt_pk_bf16_f32 v157, v210, v211
    v_mfma_f32_32x32x16_bf16 v[120:135], v[152:155], v[240:243], 0
    v_cvt_pk_bf16_f32 v158, v212, v213
    v_cvt_pk_bf16_f32 v159, v214, v215
    v_cvt_pk_bf16_f32 v252, v192, v193
    v_cvt_pk_bf16_f32 v253, v194, v195
    v_cvt_pk_bf16_f32 v254, v196, v197
    v_cvt_pk_bf16_f32 v255, v198, v199
    v_mfma_f32_32x32x16_bf16 v[120:135], v[156:159], v[244:247], v[120:135]
    v_cvt_pk_bf16_f32 v160, v216, v217
    v_cvt_pk_bf16_f32 v161, v218, v219
    v_cvt_pk_bf16_f32 v162, v220, v221
    v_cvt_pk_bf16_f32 v163, v222, v223
    v_cvt_pk_bf16_f32 v164, v224, v225
    v_cvt_pk_bf16_f32 v165, v226, v227
    v_mfma_f32_32x32x16_bf16 v[120:135], v[160:163], v[248:251], v[120:135]
    v_cvt_pk_bf16_f32 v166, v228, v229
    v_cvt_pk_bf16_f32 v167, v230, v231
    s_nop 1
    v_mfma_f32_32x32x16_bf16 v[120:135], v[164:167], v[252:255], v[120:135]
    s_waitcnt vmcnt(11)
    v_xor_b32 v91, s54, v91
    v_lshrrev_b32 v37, 3, v91
    v_xor_b32 v90, s53, v90
    v_or_b32 v37, v37, v90
    v_cmp_ne_u32 vcc, 0, v37
    s_cbranch_vccnz L_retry_1
L_got_2:
    v_cmp_ne_u32 vcc, 0, v91
    s_nop 0
    s_cmp_eq_u32 vcc_lo, 0
    s_cbranch_scc0 L_part2_wt
L_part2:
    s_nop 0
    v_cvt_pk_bf16_f32 v240, v120, v121
    v_cvt_pk_bf16_f32 v241, v122, v123
    v_cvt_pk_bf16_f32 v242, v124, v125
    v_cvt_pk_bf16_f32 v243, v126, v127
    v_cvt_pk_bf16_f32 v244, v128, v129
    v_cvt_pk_bf16_f32 v245, v130, v131
    v_cvt_pk_bf16_f32 v246, v132, v133
    v_cvt_pk_bf16_f32 v247, v134, v135
    buffer_store_dwordx4 v[240:243], v110, s[40:43], 0 offen offset:0
    buffer_store_dwordx4 v[244:247], v110, s[40:43], s58 offen offset:0
    s_barrier
    v_add_u32 v78, 0x14000, v78
    ds_read_b64_tr_b16 v[136:137], v78 offset:0
    ds_read_b64_tr_b16 v[138:139], v78 offset:512
    ds_read_b64_tr_b16 v[140:141], v78 offset:1024
    ds_read_b64_tr_b16 v[142:143], v78 offset:1536
    ds_read_b64_tr_b16 v[144:145], v78 offset:2048
    ds_read_b64_tr_b16 v[146:147], v78 offset:2560
    s_waitcnt lgkmcnt(4)
    v_mfma_f32_32x32x16_bf16 v[200:215], v[136:139], a[0:3], 0
    ds_read_b64_tr_b16 v[148:149], v78 offset:3072
    ds_read_b64_tr_b16 v[150:151], v78 offset:3584
    s_mul_i32 s58, s47, 36864
    s_mul_i32 s91, s44, 9216
    s_add_u32 s58, s58, s91
    s_add_u32 s58, s58, 524288
    v_mfma_f32_16x16x32_bf16 v[74:77], v[14:17], v[136:139], 0
    s_add_u32 s59, s58, 4096
    s_waitcnt lgkmcnt(4)
    v_mfma_f32_32x32x16_bf16 v[200:215], v[140:143], a[4:7], v[200:215]
    ds_read_b64_tr_b16 v[136:137], v78 offset:8192
    ds_read_b64_tr_b16 v[138:139], v78 offset:8704
    s_add_u32 s60, s58, 8192
    v_mov_b32 v64, 0
    v_mov_b32 v65, 0
    v_mov_b32 v66, 0
    v_mfma_f32_16x16x32_bf16 v[74:77], v[14:17], v[140:143], v[74:77]
    v_mov_b32 v67, 0
    s_waitcnt lgkmcnt(4)
    v_mfma_f32_32x32x16_bf16 v[200:215], v[144:147], a[8:11], v[200:215]
    ds_read_b64_tr_b16 v[140:141], v78 offset:9216
    ds_read_b64_tr_b16 v[142:143], v78 offset:9728
    v_mov_b32 v68, 0
    v_mov_b32 v69, 0
    v_mov_b32 v70, 0
    v_mov_b32 v71, 0
    v_mfma_f32_16x16x32_bf16 v[74:77], v[14:17], v[144:147], v[74:77]
    v_mov_b32 v72, 0
    s_waitcnt lgkmcnt(4)
    v_mfma_f32_32x32x16_bf16 v[200:215], v[148:151], a[12:15], v[200:215]
    ds_read_b64_tr_b16 v[144:145], v78 offset:10240
    ds_read_b64_tr_b16 v[146:147], v78 offset:10752
    v_mov_b32 v73, 0
    v_mov_b32 v45, s53
    v_lshlrev_b32 v224, 16, v18
    v_and_b32 v225, 0xffff0000, v18
    v_mfma_f32_16x16x32_bf16 v[74:77], v[14:17], v[148:151], v[74:77]
    v_lshlrev_b32 v226, 16, v19
    s_waitcnt lgkmcnt(4)
    v_mfma_f32_32x32x16_bf16 v[200:215], v[136:139], a[16:19], v[200:215]
    ds_read_b64_tr_b16 v[148:149], v78 offset:11264
    ds_read_b64_tr_b16 v[150:151], v78 offset:11776
    v_and_b32 v227, 0xffff0000, v19
    v_lshlrev_b32 v228, 16, v20
    v_and_b32 v229, 0xffff0000, v20
    v_lshlrev_b32 v230, 16, v21
    v_mfma_f32_16x16x32_bf16 v[74:77], v[14:17], v[136:139], v[74:77]
    buffer_load_dwordx2 v[248:249], v57, s[40:43], 0 offen offset:0 sc1
    buffer_load_dwordx2 v[250:251], v57, s[40:43], 0 offen offset:272 sc1
    s_waitcnt lgkmcnt(4)
    v_mfma_f32_32x32x16_bf16 v[200:215], v[140:143], a[20:23], v[200:215]
    s_barrier
    ds_read_b64_tr_b16 v[136:137], v78 offset:16384
    ds_read_b64_tr_b16 v[138:139], v78 offset:16896
    v_and_b32 v231, 0xffff0000, v21
    v_lshlrev_b32 v232, 16, v22
    v_mfma_f32_16x16x32_bf16 v[74:77], v[14:17], v[140:143], v[74:77]
    buffer_load_dwordx2 v[252:253], v59, s[40:43], 0 offen offset:0 sc1
    buffer_load_dwordx2 v[254:255], v59, s[40:43], 0 offen offset:272 sc1
    s_waitcnt lgkmcnt(4)
    v_mfma_f32_32x32x16_bf16 v[200:215], v[144:147], a[24:27], v[200:215]
    s_branch L_page2
    .p2align 12
L_pad2:
    s_setpc_b64 s[0:1]
    s_nop 0
L_page2:
    ds_read_b64_tr_b16 v[140:141], v78 offset:17408
    ds_read_b64_tr_b16 v[142:143], v78 offset:17920
    v_and_b32 v233, 0xffff0000, v22
    v_lshlrev_b32 v234, 16, v23
    v_and_b32 v235, 0xffff0000, v23
    v_lshlrev_b32 v236, 16, v24
    v_mfma_f32_16x16x32_bf16 v[74:77], v[14:17], v[144:147], v[74:77]
    buffer_load_dwordx4 v40, s[16:19], s92 offen offset:1024 lds
    s_waitcnt lgkmcnt(4)
    v_mfma_f32_32x32x16_bf16 v[200:215], v[148:151], a[28:31], v[200:215]
    ds_read_b64_tr_b16 v[144:145], v78 offset:18432
    ds_read_b64_tr_b16 v[146:147], v78 offset:18944
    v_and_b32 v237, 0xffff0000, v24
    v_lshlrev_b32 v238, 16, v25
    v_and_b32 v239, 0xffff0000, v25
    v_mfma_f32_16x16x32_bf16 v[74:77], v[14:17], v[148:151], v[74:77]
    buffer_load_dwordx4 v40, s[16:19], s93 offen offset:2048 lds
    s_waitcnt lgkmcnt(4)
    v_mfma_f32_32x32x16_bf16 v[200:215], v[136:139], a[32:35], v[200:215]
    ds_read_b64_tr_b16 v[148:149], v78 offset:19456
    ds_read_b64_tr_b16 v[150:151], v78 offset:19968
    v_mfma_f32_16x16x32_bf16 v[74:77], v[14:17], v[136:139], v[74:77]
    buffer_load_dwordx4 v40, s[16:19], s94 offen offset:3072 lds
    s_waitcnt lgkmcnt(4)
    v_mfma_f32_32x32x16_bf16 v[200:215], v[140:143], a[36:39], v[200:215]
    ds_read_b64_tr_b16 v[136:137], v78 offset:24576
    ds_read_b64_tr_b16 v[138:139], v78 offset:25088
    s_mov_b32 s97, 0x20000
    s_cmp_eq_u32 s87, 3
    s_cselect_b32 s97, 0xfffa0000, s97
    v_add_u32 v40, s97, v40
    s_add_u32 m0, s62, 0
    v_mfma_f32_16x16x32_bf16 v[74:77], v[14:17], v[140:143], v[74:77]
    buffer_load_dwordx4 v40, s[16:19], 0 offen offset:0 lds
    s_waitcnt lgkmcnt(4)
    v_mfma_f32_32x32x16_bf16 v[200:215], v[144:147], a[40:43], v[200:215]
    ds_read_b64_tr_b16 v[140:141], v78 offset:25600
    ds_read_b64_tr_b16 v[142:143], v78 offset:26112
    v_mfma_f32_16x16x32_bf16 v[74:77], v[14:17], v[144:147], v[74:77]
    buffer_load_dwordx4 v40, s[16:19], s92 offen offset:1024 lds
    s_waitcnt lgkmcnt(4)
    v_mfma_f32_32x32x16_bf16 v[200:215], v[148:151], a[44:47], v[200:215]
    ds_read_b64_tr_b16 v[144:145], v78 offset:26624
    ds_read_b64_tr_b16 v[146:147], v78 offset:27136
    v_mfma_f32_16x16x32_bf16 v[74:77], v[14:17], v[148:151], v[74:77]
    buffer_load_dwordx4 v40, s[16:19], s93 offen offset:2048 lds
    s_waitcnt lgkmcnt(4)
    v_mfma_f32_32x32x16_bf16 v[200:215], v[136:139], a[48:51], v[200:215]
    ds_read_b64_tr_b16 v[148:149], v78 offset:27648
    ds_read_b64_tr_b16 v[150:151], v78 offset:28160
    v_mfma_f32_16x16x32_bf16 v[74:77], v[14:17], v[136:139], v[74:77]
    s_waitcnt vmcnt(6)
    v_dot2c_f32_bf16 v52, s55, v248
    v_dot2c_f32_bf16 v53, s56, v248
    v_dot2c_f32_bf16 v54, s55, v249
    v_dot2c_f32_bf16 v55, s56, v249
    v_dot2c_f32_bf16 v52, s55, v250
    v_dot2c_f32_bf16 v53, s56, v250
    v_dot2c_f32_bf16 v54, s55, v251
    v_dot2c_f32_bf16 v55, s56, v251
    v_dot2c_f32_bf16 v52, s55, v252
    v_dot2c_f32_bf16 v53, s56, v252
    v_dot2c_f32_bf16 v54, s55, v253
    v_dot2c_f32_bf16 v55, s56, v253
    v_dot2c_f32_bf16 v52, s55, v254
    v_dot2c_f32_bf16 v53, s56, v254
    v_dot2c_f32_bf16 v54, s55, v255
    v_dot2c_f32_bf16 v55, s56, v255
    v_cmp_u_f32 vcc, v52, v52
    v_cvt_pk_bf16_f32 v248, v52, v53
    s_nop 0
    v_cvt_pk_bf16_f32 v249, v54, v55
    s_cbranch_vccnz L_retry_4
L_got_5:
    buffer_store_dwordx2 v[248:249], v56, s[40:43], 0 offen sc1
    s_waitcnt lgkmcnt(4)
    v_mfma_f32_32x32x16_bf16 v[200:215], v[140:143], a[52:55], v[200:215]
    s_barrier
    ds_read_b64_tr_b16 v[136:137], v78 offset:32768
    ds_read_b64_tr_b16 v[138:139], v78 offset:33280
    v_mfma_f32_16x16x32_bf16 v[74:77], v[14:17], v[140:143], v[74:77]
    buffer_load_dwordx4 v40, s[16:19], s94 offen offset:3072 lds
    s_waitcnt lgkmcnt(4)
    v_mfma_f32_32x32x16_bf16 v[200:215], v[144:147], a[56:59], v[200:215]
    ds_read_b64_tr_b16 v[140:141], v78 offset:33792
    ds_read_b64_tr_b16 v[142:143], v78 offset:34304
    s_mov_b32 s97, 0x20000
    s_cmp_eq_u32 s87, 2
    s_cselect_b32 s97, 0xfffa0000, s97
    v_add_u32 v40, s97, v40
    s_add_u32 m0, s62, 16384
    v_mfma_f32_16x16x32_bf16 v[74:77], v[14:17], v[144:147], v[74:77]
    buffer_load_dwordx4 v40, s[16:19], 0 offen offset:0 lds
    s_waitcnt lgkmcnt(4)
    v_mfma_f32_32x32x16_bf16 v[200:215], v[148:151], a[60:63], v[200:215]
    ds_read_b64_tr_b16 v[144:145], v78 offset:34816
    ds_read_b64_tr_b16 v[146:147], v78 offset:35328
    v_mfma_f32_16x16x32_bf16 v[74:77], v[14:17], v[148:151], v[74:77]
    buffer_load_dwordx4 v40, s[16:19], s92 offen offset:1024 lds
    s_waitcnt lgkmcnt(4)
    v_mfma_f32_32x32x16_bf16 v[200:215], v[136:139], a[64:67], v[200:215]
    ds_read_b64_tr_b16 v[148:149], v78 offset:35840
    ds_read_b64_tr_b16 v[150:151], v78 offset:36352
    v_mfma_f32_16x16x32_bf16 v[74:77], v[14:17], v[136:139], v[74:77]
    buffer_load_dwordx4 v40, s[16:19], s93 offen offset:2048 lds
    s_waitcnt lgkmcnt(4)
    v_mfma_f32_32x32x16_bf16 v[200:215], v[140:143], a[68:71], v[200:215]
    ds_read_b64_tr_b16 v[136:137], v78 offset:40960
    ds_read_b64_tr_b16 v[138:139], v78 offset:41472
    v_mfma_f32_16x16x32_bf16 v[74:77], v[14:17], v[140:143], v[74:77]
    buffer_load_dwordx4 v40, s[16:19], s94 offen offset:3072 lds
    s_waitcnt lgkmcnt(4)
    v_mfma_f32_32x32x16_bf16 v[200:215], v[144:147], a[72:75], v[200:215]
    ds_read_b64_tr_b16 v[140:141], v78 offset:41984
    ds_read_b64_tr_b16 v[142:143], v78 offset:42496
    s_mov_b32 s97, 0x20000
    s_cmp_eq_u32 s87, 1
    s_cselect_b32 s97, 0xfffa0000, s97
    v_add_u32 v40, s97, v40
    s_add_u32 m0, s62, 32768
    v_mfma_f32_16x16x32_bf16 v[74:77], v[14:17], v[144:147], v[74:77]
    buffer_load_dwordx4 v40, s[16:19], 0 offen offset:0 lds
    s_waitcnt lgkmcnt(4)
    v_mfma_f32_32x32x16_bf16 v[200:215], v[148:151], a[76:79], v[200:215]
    ds_read_b64_tr_b16 v[144:145], v78 offset:43008
    ds_read_b64_tr_b16 v[146:147], v78 offset:43520
    v_mfma_f32_16x16x32_bf16 v[74:77], v[14:17], v[148:151], v[74:77]
    buffer_load_dwordx4 v40, s[16:19], s92 offen offset:1024 lds
    s_waitcnt lgkmcnt(4)
    v_mfma_f32_32x32x16_bf16 v[200:215], v[136:139], a[80:83], v[200:215]
    ds_read_b64_tr_b16 v[148:149], v78 offset:44032
    ds_read_b64_tr_b16 v[150:151], v78 offset:44544
    v_mfma_f32_16x16x32_bf16 v[74:77], v[14:17], v[136:139], v[74:77]
    buffer_load_dwordx4 v40, s[16:19], s93 offen offset:2048 lds
    s_waitcnt lgkmcnt(4)
    v_mfma_f32_32x32x16_bf16 v[200:215], v[140:143], a[84:87], v[200:215]
    s_barrier
    v_add_u32 v78, 0xffff8000, v78
    ds_read_b64_tr_b16 v[136:137], v78 offset:0
    ds_read_b64_tr_b16 v[138:139], v78 offset:512
    v_mfma_f32_16x16x32_bf16 v[74:77], v[14:17], v[140:143], v[74:77]
    buffer_load_dwordx4 v40, s[16:19], s94 offen offset:3072 lds
    s_waitcnt lgkmcnt(4)
    v_mfma_f32_32x32x16_bf16 v[200:215], v[144:147], a[88:91], v[200:215]
    ds_read_b64_tr_b16 v[140:141], v78 offset:1024
    ds_read_b64_tr_b16 v[142:143], v78 offset:1536
    v_add_u32 v41, 0x700, v41
    s_add_u32 m0, s62, 131072
    s_mov_b32 s92, 27648
    s_mov_b32 s93, 55296
    s_mov_b32 s94, 82944
    v_mfma_f32_16x16x32_bf16 v[74:77], v[14:17], v[144:147], v[74:77]
    buffer_load_dwordx4 v41, s[20:23], 0 offen offset:0 lds
    s_waitcnt lgkmcnt(4)
    v_mfma_f32_32x32x16_bf16 v[200:215], v[148:151], a[92:95], v[200:215]
    ds_read_b64_tr_b16 v[144:145], v78 offset:2048
    ds_read_b64_tr_b16 v[146:147], v78 offset:2560
    v_mfma_f32_16x16x32_bf16 v[74:77], v[14:17], v[148:151], v[74:77]
    buffer_load_dwordx4 v41, s[20:23], s92 offen offset:1024 lds
    s_waitcnt lgkmcnt(4)
    v_mfma_f32_32x32x16_bf16 v[200:215], v[136:139], a[96:99], v[200:215]
    ds_read_b64_tr_b16 v[148:149], v78 offset:3072
    ds_read_b64_tr_b16 v[150:151], v78 offset:3584
    v_mfma_f32_16x16x32_bf16 v[74:77], v[14:17], v[136:139], v[74:77]
    buffer_load_dwordx4 v41, s[20:23], s93 offen offset:2048 lds
    s_waitcnt lgkmcnt(4)
    v_mfma_f32_32x32x16_bf16 v[200:215], v[140:143], a[100:103], v[200:215]
    ds_read_b64_tr_b16 v[136:137], v78 offset:8192
    ds_read_b64_tr_b16 v[138:139], v78 offset:8704
    v_mfma_f32_16x16x32_bf16 v[74:77], v[14:17], v[140:143], v[74:77]
    buffer_load_dwordx4 v41, s[20:23], s94 offen offset:3072 lds
    s_waitcnt lgkmcnt(4)
    v_mfma_f32_32x32x16_bf16 v[200:215], v[144:147], a[104:107], v[200:215]
    ds_read_b64_tr_b16 v[140:141], v78 offset:9216
    ds_read_b64_tr_b16 v[142:143], v78 offset:9728
    s_mov_b32 s97, 0x70000
    s_cmp_eq_u32 s86, 0
    s_cselect_b32 s97, 0xffeb0000, s97
    v_add_u32 v41, s97, v41
    s_add_u32 m0, s62, 81920
    v_mfma_f32_16x16x32_bf16 v[74:77], v[14:17], v[144:147], v[74:77]
    buffer_load_dwordx4 v41, s[20:23], 0 offen offset:0 lds
    s_waitcnt lgkmcnt(4)
    v_mfma_f32_32x32x16_bf16 v[200:215], v[148:151], a[108:111], v[200:215]
    ds_read_b64_tr_b16 v[144:145], v78 offset:10240
    ds_read_b64_tr_b16 v[146:147], v78 offset:10752
    v_mfma_f32_16x16x32_bf16 v[74:77], v[14:17], v[148:151], v[74:77]
    buffer_load_dwordx4 v41, s[20:23], s92 offen offset:1024 lds
    s_waitcnt lgkmcnt(4)
    v_mfma_f32_32x32x16_bf16 v[200:215], v[136:139], a[112:115], v[200:215]
    ds_read_b64_tr_b16 v[148:149], v78 offset:11264
    ds_read_b64_tr_b16 v[150:151], v78 offset:11776
    v_mfma_f32_16x16x32_bf16 v[74:77], v[14:17], v[136:139], v[74:77]
    buffer_load_dwordx4 v41, s[20:23], s93 offen offset:2048 lds
    s_waitcnt lgkmcnt(4)
    v_mfma_f32_32x32x16_bf16 v[200:215], v[140:143], a[116:119], v[200:215]
    v_mfma_f32_16x16x32_bf16 v[74:77], v[14:17], v[140:143], v[74:77]
    buffer_load_dwordx4 v41, s[20:23], s94 offen offset:3072 lds
    s_waitcnt lgkmcnt(2)
    v_mfma_f32_32x32x16_bf16 v[200:215], v[144:147], a[120:123], v[200:215]
    s_mov_b32 s97, 0x70000
    s_cmp_eq_u32 s86, 3
    s_cselect_b32 s97, 0xffeb0000, s97
    v_add_u32 v41, s97, v41
    s_add_u32 m0, s62, 98304
    v_mfma_f32_16x16x32_bf16 v[74:77], v[14:17], v[144:147], v[74:77]
    buffer_load_dwordx4 v41, s[20:23], 0 offen offset:0 lds
    s_waitcnt lgkmcnt(0)
    v_mfma_f32_16x16x32_bf16 v[74:77], v[14:17], v[148:151], v[74:77]
    v_mfma_f32_32x32x16_bf16 v[200:215], v[148:151], a[124:127], v[200:215]
    buffer_load_dwordx4 v41, s[20:23], s92 offen offset:1024 lds
    s_nop 5
    v_cvt_pk_bf16_f32 v75, v74, 0
    v_lshlrev_b32 v76, 16, v75
    v_sub_f32 v76, v74, v76
    v_cvt_pk_bf16_f32 v74, v74, v76
    v_mov_b32 v76, 0
    v_mov_b32 v77, 0
    s_nop 1
    v_mfma_f32_32x32x16_bf16 v[200:215], v[74:77], v[82:85], v[200:215]
    s_barrier
    s_nop 10
    v_cvt_pk_bf16_f32 v52, v200, v201
    v_cvt_pk_bf16_f32 v53, v202, v203
    v_cvt_pk_bf16_f32 v54, v204, v205
    v_cvt_pk_bf16_f32 v55, v206, v207
    s_nop 1
    v_mfma_f32_32x32x16_bf16 v[240:255], v[92:95], v[52:55], 0
    v_cvt_pk_bf16_f32 v56, v208, v209
    v_cvt_pk_bf16_f32 v57, v210, v211
    v_cvt_pk_bf16_f32 v58, v212, v213
    v_cvt_pk_bf16_f32 v59, v214, v215
    s_nop 1
    v_mfma_f32_32x32x16_bf16 v[240:255], v[96:99], v[56:59], v[240:255]
    s_nop 11
    v_max3_f32 v100, v240, v241, v242
    v_max3_f32 v104, v243, v244, v245
    v_max3_f32 v100, v246, v247, v100
    v_max_f32 v100, v100, v104
    v_max3_f32 v101, v248, v249, v250
    v_max3_f32 v105, v251, v252, v253
    v_max3_f32 v101, v254, v255, v101
    v_max_f32 v101, v101, v105
    v_min3_f32 v102, v240, v241, v242
    v_min3_f32 v104, v243, v244, v245
    v_min3_f32 v102, v246, v247, v102
    v_min_f32 v102, v102, v104
    v_min3_f32 v103, v248, v249, v250
    v_min3_f32 v105, v251, v252, v253
    v_min3_f32 v103, v254, v255, v103
    v_min_f32 v103, v103, v105
    v_permlane32_swap_b32 v100, v101
    s_nop 0
    v_permlane32_swap_b32 v102, v103
    v_max_f32 v100, v100, v101
    v_min_f32 v102, v102, v103
    v_mov_b32 v101, v100
    v_mov_b32 v103, v102
    s_nop 0
    v_permlane32_swap_b32 v100, v101
    v_permlane32_swap_b32 v102, v103
    v_pk_mul_f32 v[100:101], v[100:101], v[108:109] op_sel_hi:[1,0]
    v_pk_mul_f32 v[102:103], v[102:103], v[108:109] op_sel_hi:[1,0]
    v_pk_fma_f32 v[120:121], v[240:241], v[108:109], v[100:101] op_sel:[0,0,0] op_sel_hi:[1,0,0] neg_lo:[0,0,1] neg_hi:[0,0,1]
    v_pk_fma_f32 v[128:129], v[240:241], v[108:109], v[102:103] op_sel:[0,0,0] op_sel_hi:[1,0,0] neg_lo:[1,0,0] neg_hi:[1,0,0]
    v_pk_fma_f32 v[122:123], v[242:243], v[108:109], v[100:101] op_sel:[0,0,0] op_sel_hi:[1,0,0] neg_lo:[0,0,1] neg_hi:[0,0,1]
    v_pk_fma_f32 v[130:131], v[242:243], v[108:109], v[102:103] op_sel:[0,0,0] op_sel_hi:[1,0,0] neg_lo:[1,0,0] neg_hi:[1,0,0]
    v_pk_fma_f32 v[124:125], v[244:245], v[108:109], v[100:101] op_sel:[0,0,0] op_sel_hi:[1,0,0] neg_lo:[0,0,1] neg_hi:[0,0,1]
    v_pk_fma_f32 v[132:133], v[244:245], v[108:109], v[102:103] op_sel:[0,0,0] op_sel_hi:[1,0,0] neg_lo:[1,0,0] neg_hi:[1,0,0]
    v_pk_fma_f32 v[126:127], v[246:247], v[108:109], v[100:101] op_sel:[0,0,0] op_sel_hi:[1,0,0] neg_lo:[0,0,1] neg_hi:[0,0,1]
    v_pk_fma_f32 v[134:135], v[246:247], v[108:109], v[102:103] op_sel:[0,0,0] op_sel_hi:[1,0,0] neg_lo:[1,0,0] neg_hi:[1,0,0]
    v_pk_fma_f32 v[136:137], v[248:249], v[108:109], v[100:101] op_sel:[0,0,1] op_sel_hi:[1,0,1] neg_lo:[0,0,1] neg_hi:[0,0,1]
    v_pk_fma_f32 v[144:145], v[248:249], v[108:109], v[102:103] op_sel:[0,0,1] op_sel_hi:[1,0,1] neg_lo:[1,0,0] neg_hi:[1,0,0]
    v_pk_fma_f32 v[138:139], v[250:251], v[108:109], v[100:101] op_sel:[0,0,1] op_sel_hi:[1,0,1] neg_lo:[0,0,1] neg_hi:[0,0,1]
    v_pk_fma_f32 v[146:147], v[250:251], v[108:109], v[102:103] op_sel:[0,0,1] op_sel_hi:[1,0,1] neg_lo:[1,0,0] neg_hi:[1,0,0]
    v_pk_fma_f32 v[140:141], v[252:253], v[108:109], v[100:101] op_sel:[0,0,1] op_sel_hi:[1,0,1] neg_lo:[0,0,1] neg_hi:[0,0,1]
    v_pk_fma_f32 v[148:149], v[252:253], v[108:109], v[102:103] op_sel:[0,0,1] op_sel_hi:[1,0,1] neg_lo:[1,0,0] neg_hi:[1,0,0]
    v_pk_fma_f32 v[142:143], v[254:255], v[108:109], v[100:101] op_sel:[0,0,1] op_sel_hi:[1,0,1] neg_lo:[0,0,1] neg_hi:[0,0,1]
    v_pk_fma_f32 v[150:151], v[254:255], v[108:109], v[102:103] op_sel:[0,0,1] op_sel_hi:[1,0,1] neg_lo:[1,0,0] neg_hi:[1,0,0]
    v_exp_f32 v120, v120
    v_exp_f32 v121, v121
    v_exp_f32 v122, v122
    v_exp_f32 v123, v123
    v_exp_f32 v124, v124
    v_exp_f32 v125, v125
    v_exp_f32 v126, v126
    v_exp_f32 v127, v127
    buffer_load_dword v60, v115, s[40:43], s60 offen offset:0 sc1
    buffer_load_dword v61, v115, s[40:43], s60 offen offset:512 sc1
    v_exp_f32 v128, v128
    v_exp_f32 v129, v129
    v_exp_f32 v130, v130
    v_exp_f32 v131, v131
    v_exp_f32 v132, v132
    v_exp_f32 v133, v133
    v_exp_f32 v134, v134
    v_exp_f32 v135, v135
    buffer_load_dwordx4 v[168:171], v36, s[40:43], s58 offen offset:0 sc1
    buffer_load_dwordx4 v[172:175], v36, s[40:43], s58 offen offset:1024 sc1
    v_exp_f32 v136, v136
    v_exp_f32 v137, v137
    v_exp_f32 v138, v138
    v_exp_f32 v139, v139
    v_exp_f32 v140, v140
    v_exp_f32 v141, v141
    v_exp_f32 v142, v142
    v_exp_f32 v143, v143
    buffer_load_dwordx4 v[176:179], v36, s[40:43], s58 offen offset:2048 sc1
    buffer_load_dwordx4 v[180:183], v36, s[40:43], s58 offen offset:3072 sc1
    v_exp_f32 v144, v144
    v_exp_f32 v145, v145
    v_exp_f32 v146, v146
    v_exp_f32 v147, v147
    v_exp_f32 v148, v148
    v_exp_f32 v149, v149
    v_exp_f32 v150, v150
    v_exp_f32 v151, v151
    buffer_load_dwordx4 v[184:187], v36, s[40:43], s59 offen offset:0 sc1
    buffer_load_dwordx4 v[188:191], v36, s[40:43], s59 offen offset:1024 sc1
    v_pk_add_f32 v[240:241], v[120:121], v[122:123]
    v_pk_add_f32 v[242:243], v[124:125], v[126:127]
    v_pk_add_f32 v[244:245], v[128:129], v[130:131]
    v_pk_add_f32 v[246:247], v[132:133], v[134:135]
    v_pk_add_f32 v[248:249], v[136:137], v[138:139]
    v_pk_add_f32 v[250:251], v[140:141], v[142:143]
    v_pk_add_f32 v[252:253], v[144:145], v[146:147]
    v_pk_add_f32 v[254:255], v[148:149], v[150:151]
    v_pk_add_f32 v[240:241], v[240:241], v[242:243]
    v_pk_add_f32 v[244:245], v[244:245], v[246:247]
    v_pk_add_f32 v[248:249], v[248:249], v[250:251]
    v_pk_add_f32 v[252:253], v[252:253], v[254:255]
    v_add_f32 v100, v240, v241
    v_add_f32 v101, v244, v245
    v_add_f32 v102, v248, v249
    v_add_f32 v103, v252, v253
    buffer_load_dwordx4 v[192:195], v36, s[40:43], s59 offen offset:2048 sc1
    buffer_load_dwordx4 v[196:199], v36, s[40:43], s59 offen offset:3072 sc1
    v_permlane32_swap_b32 v100, v101
    v_permlane32_swap_b32 v102, v103
    v_add_f32 v100, v100, v101
    v_add_f32 v102, v102, v103
    v_rcp_f32 v100, v100
    v_rcp_f32 v102, v102
    v_mov_b32 v101, v100
    v_mov_b32 v103, v102
    s_nop 0
    v_permlane32_swap_b32 v100, v101
    v_permlane32_swap_b32 v102, v103
    v_pk_mul_f32 v[120:121], v[120:121], v[100:101] op_sel:[0,0] op_sel_hi:[1,0]
    v_pk_mul_f32 v[122:123], v[122:123], v[100:101] op_sel:[0,0] op_sel_hi:[1,0]
    v_pk_mul_f32 v[124:125], v[124:125], v[100:101] op_sel:[0,0] op_sel_hi:[1,0]
    v_pk_mul_f32 v[126:127], v[126:127], v[100:101] op_sel:[0,0] op_sel_hi:[1,0]
    v_pk_mul_f32 v[128:129], v[128:129], v[100:101] op_sel:[0,1] op_sel_hi:[1,1]
    v_pk_mul_f32 v[130:131], v[130:131], v[100:101] op_sel:[0,1] op_sel_hi:[1,1]
    v_pk_mul_f32 v[132:133], v[132:133], v[100:101] op_sel:[0,1] op_sel_hi:[1,1]
    v_pk_mul_f32 v[134:135], v[134:135], v[100:101] op_sel:[0,1] op_sel_hi:[1,1]
    v_pk_mul_f32 v[136:137], v[136:137], v[102:103] op_sel:[0,0] op_sel_hi:[1,0]
    v_pk_mul_f32 v[138:139], v[138:139], v[102:103] op_sel:[0,0] op_sel_hi:[1,0]
    v_pk_mul_f32 v[140:141], v[140:141], v[102:103] op_sel:[0,0] op_sel_hi:[1,0]
    v_pk_mul_f32 v[142:143], v[142:143], v[102:103] op_sel:[0,0] op_sel_hi:[1,0]
    v_pk_mul_f32 v[144:145], v[144:145], v[102:103] op_sel:[0,1] op_sel_hi:[1,1]
    v_pk_mul_f32 v[146:147], v[146:147], v[102:103] op_sel:[0,1] op_sel_hi:[1,1]
    v_pk_mul_f32 v[148:149], v[148:149], v[102:103] op_sel:[0,1] op_sel_hi:[1,1]
    v_pk_mul_f32 v[150:151], v[150:151], v[102:103] op_sel:[0,1] op_sel_hi:[1,1]
    buffer_load_dwordx4 v41, s[20:23], s93 offen offset:2048 lds
    v_cvt_pk_bf16_f32 v152, v120, v121
    v_cvt_pk_bf16_f32 v153, v122, v123
    v_cvt_pk_bf16_f32 v154, v124, v125
    v_cvt_pk_bf16_f32 v155, v126, v127
    v_cvt_pk_bf16_f32 v156, v128, v129
    v_cvt_pk_bf16_f32 v157, v130, v131
    v_cvt_pk_bf16_f32 v158, v132, v133
    v_cvt_pk_bf16_f32 v159, v134, v135
    v_cvt_pk_bf16_f32 v160, v136, v137
    v_cvt_pk_bf16_f32 v161, v138, v139
    v_cvt_pk_bf16_f32 v162, v140, v141
    v_cvt_pk_bf16_f32 v163, v142, v143
    v_cvt_pk_bf16_f32 v164, v144, v145
    v_cvt_pk_bf16_f32 v165, v146, v147
    v_cvt_pk_bf16_f32 v166, v148, v149
    v_cvt_pk_bf16_f32 v167, v150, v151
    s_mov_b32 s61, 0
    s_branch L_got_8
L_again_9:
    buffer_load_dword v60, v115, s[40:43], s60 offen offset:0 sc1
    buffer_load_dword v61, v115, s[40:43], s60 offen offset:512 sc1
    buffer_load_dwordx4 v[168:171], v36, s[40:43], s58 offen offset:0 sc1
    buffer_load_dwordx4 v[172:175], v36, s[40:43], s58 offen offset:1024 sc1
    buffer_load_dwordx4 v[176:179], v36, s[40:43], s58 offen offset:2048 sc1
    buffer_load_dwordx4 v[180:183], v36, s[40:43], s58 offen offset:3072 sc1
    buffer_load_dwordx4 v[184:187], v36, s[40:43], s59 offen offset:0 sc1
    buffer_load_dwordx4 v[188:191], v36, s[40:43], s59 offen offset:1024 sc1
    buffer_load_dwordx4 v[192:195], v36, s[40:43], s59 offen offset:2048 sc1
    buffer_load_dwordx4 v[196:199], v36, s[40:43], s59 offen offset:3072 sc1
    v_mov_b32 v64, 0
    v_mov_b32 v65, 0
    v_mov_b32 v66, 0
    v_mov_b32 v67, 0
    v_mov_b32 v68, 0
    v_mov_b32 v69, 0
    v_mov_b32 v70, 0
    v_mov_b32 v71, 0
    v_mov_b32 v72, 0
    v_mov_b32 v73, 0
    s_addk_i32 s61, 1
    s_cmp_gt_u32 s61, 0x80000
    s_cbranch_scc1 L_abort
    s_waitcnt vmcnt(0)
L_got_8:
    s_waitcnt vmcnt(9)
    v_dot2c_f32_bf16 v72, s55, v60
    v_dot2c_f32_bf16 v73, s56, v60
    v_dot2c_f32_bf16 v72, s55, v61
    v_dot2c_f32_bf16 v73, s56, v61
    s_waitcnt vmcnt(8)
    v_dot2c_f32_bf16 v64, s55, v168
    v_dot2c_f32_bf16 v68, s55, v170
    v_dot2c_f32_bf16 v65, s56, v168
    v_dot2c_f32_bf16 v66, s55, v169
    v_dot2c_f32_bf16 v67, s56, v169
    v_dot2c_f32_bf16 v69, s56, v170
    v_dot2c_f32_bf16 v70, s55, v171
    v_dot2c_f32_bf16 v71, s56, v171
    v_permlane32_swap_b32 v72, v73
    v_add_f32 v72, v72, v73
    v_mov_b32 v73, v72
    s_waitcnt vmcnt(7)
    v_dot2c_f32_bf16 v64, s55, v172
    v_dot2c_f32_bf16 v68, s55, v174
    v_dot2c_f32_bf16 v65, s56, v172
    v_dot2c_f32_bf16 v66, s55, v173
    v_dot2c_f32_bf16 v67, s56, v173
    v_dot2c_f32_bf16 v69, s56, v174
    v_dot2c_f32_bf16 v70, s55, v175
    v_dot2c_f32_bf16 v71, s56, v175
    v_permlane16_swap_b32 v72, v73
    v_add_f32 v72, v72, v73
    v_cvt_pk_bf16_f32 v73, v72, v72
    s_waitcnt vmcnt(6)
    v_dot2c_f32_bf16 v64, s55, v176
    v_dot2c_f32_bf16 v68, s55, v178
    v_dot2c_f32_bf16 v65, s56, v176
    v_dot2c_f32_bf16 v66, s55, v177
    v_dot2c_f32_bf16 v67, s56, v177
    v_dot2c_f32_bf16 v69, s56, v178
    v_dot2c_f32_bf16 v70, s55, v179
    v_dot2c_f32_bf16 v71, s56, v179
    s_waitcnt vmcnt(5)
    v_dot2c_f32_bf16 v64, s55, v180
    v_dot2c_f32_bf16 v68, s55, v182
    v_dot2c_f32_bf16 v65, s56, v180
    v_dot2c_f32_bf16 v66, s55, v181
    v_dot2c_f32_bf16 v67, s56, v181
    v_dot2c_f32_bf16 v69, s56, v182
    v_dot2c_f32_bf16 v70, s55, v183
    v_dot2c_f32_bf16 v71, s56, v183
    s_waitcnt vmcnt(4)
    v_dot2c_f32_bf16 v64, s55, v184
    v_dot2c_f32_bf16 v68, s55, v186
    v_dot2c_f32_bf16 v65, s56, v184
    v_dot2c_f32_bf16 v66, s55, v185
    v_dot2c_f32_bf16 v67, s56, v185
    v_dot2c_f32_bf16 v69, s56, v186
    v_dot2c_f32_bf16 v70, s55, v187
    v_dot2c_f32_bf16 v71, s56, v187
    s_waitcnt vmcnt(3)
    v_dot2c_f32_bf16 v64, s55, v188
    v_dot2c_f32_bf16 v68, s55, v190
    v_dot2c_f32_bf16 v65, s56, v188
    v_dot2c_f32_bf16 v66, s55, v189
    v_dot2c_f32_bf16 v67, s56, v189
    v_dot2c_f32_bf16 v69, s56, v190
    v_dot2c_f32_bf16 v70, s55, v191
    v_dot2c_f32_bf16 v71, s56, v191
    s_waitcnt vmcnt(2)
    v_dot2c_f32_bf16 v64, s55, v192
    v_dot2c_f32_bf16 v68, s55, v194
    v_dot2c_f32_bf16 v65, s56, v192
    v_dot2c_f32_bf16 v66, s55, v193
    v_dot2c_f32_bf16 v67, s56, v193
    v_dot2c_f32_bf16 v69, s56, v194
    v_dot2c_f32_bf16 v70, s55, v195
    v_dot2c_f32_bf16 v71, s56, v195
    s_waitcnt vmcnt(1)
    v_dot2c_f32_bf16 v64, s55, v196
    v_dot2c_f32_bf16 v68, s55, v198
    v_dot2c_f32_bf16 v65, s56, v196
    v_dot2c_f32_bf16 v66, s55, v197
    v_dot2c_f32_bf16 v67, s56, v197
    v_dot2c_f32_bf16 v69, s56, v198
    v_dot2c_f32_bf16 v70, s55, v199
    v_dot2c_f32_bf16 v71, s56, v199
    v_add_f32 v37, v64, v72
    v_cmp_u_f32 vcc, v37, v68
    v_cvt_pk_bf16_f32 v60, v64, v65
    v_cvt_pk_bf16_f32 v61, v66, v67
    v_cvt_pk_bf16_f32 v62, v68, v69
    v_cvt_pk_bf16_f32 v63, v70, v71
    s_cbranch_vccnz L_again_9
    ds_write_b128 v116, v[60:63]
    ds_write_b16 v117, v73 offset:256
    s_waitcnt lgkmcnt(0)
    s_barrier
    ds_read_b128 v[168:171], v118 offset:0
    ds_read_b128 v[172:175], v118 offset:544
    ds_read_b128 v[176:179], v118 offset:1088
    ds_read_b128 v[180:183], v118 offset:1632
    s_waitcnt lgkmcnt(3)
    v_mfma_f32_32x32x16_bf16 v[240:255], v[168:171], v[152:155], 0
    ds_read_b64_tr_b16 a[0:1], v26 offset:0
    ds_read_b64_tr_b16 a[2:3], v26 offset:1024
    s_waitcnt lgkmcnt(4)
    v_mfma_f32_32x32x16_bf16 v[240:255], v[172:175], v[156:159], v[240:255]
    ds_read_b64_tr_b16 a[4:5], v27 offset:0
    ds_read_b64_tr_b16 a[6:7], v27 offset:1024
    s_waitcnt lgkmcnt(5)
    v_mfma_f32_32x32x16_bf16 v[208:223], v[176:179], v[160:163], 0
    ds_read_b64_tr_b16 a[8:9], v28 offset:0
    ds_read_b64_tr_b16 a[10:11], v28 offset:1024
    s_waitcnt lgkmcnt(6)
    v_mfma_f32_32x32x16_bf16 v[208:223], v[180:183], v[164:167], v[208:223]
    ds_read_b64_tr_b16 a[12:13], v29 offset:0
    ds_read_b64_tr_b16 a[14:15], v29 offset:1024
    ds_read_b64_tr_b16 a[16:17], v26 offset:4096
    ds_read_b64_tr_b16 a[18:19], v26 offset:5120
    v_add_f32 v248, 0x358637bd, v248
    v_rcp_f32 v248, v248
    s_nop 0
    v_mul_f32 v240, v240, v248
    v_mul_f32 v241, v241, v248
    v_mul_f32 v242, v242, v248
    v_mul_f32 v243, v243, v248
    v_mul_f32 v244, v244, v248
    v_mul_f32 v245, v245, v248
    v_mul_f32 v246, v246, v248
    v_mul_f32 v247, v247, v248
    v_cvt_pk_bf16_f32 v184, v240, v241
    v_cvt_pk_bf16_f32 v185, v242, v243
    v_cvt_pk_bf16_f32 v186, v244, v245
    v_cvt_pk_bf16_f32 v187, v246, v247
    v_add_f32 v216, 0x358637bd, v216
    v_rcp_f32 v216, v216
    s_nop 0
    v_pk_mul_f32 v[208:209], v[208:209], v[216:217] op_sel_hi:[1,0]
    v_pk_mul_f32 v[210:211], v[210:211], v[216:217] op_sel_hi:[1,0]
    v_pk_mul_f32 v[212:213], v[212:213], v[216:217] op_sel_hi:[1,0]
    v_pk_mul_f32 v[214:215], v[214:215], v[216:217] op_sel_hi:[1,0]
    v_cvt_pk_bf16_f32 v188, v208, v209
    v_cvt_pk_bf16_f32 v189, v210, v211
    v_cvt_pk_bf16_f32 v190, v212, v213
    v_cvt_pk_bf16_f32 v191, v214, v215
    buffer_store_dwordx4 v[184:187], v111, s[40:43], 0 offen offset:0
    buffer_store_dwordx4 v[188:191], v111, s[40:43], 0 offen offset:512
    ds_read_b64_tr_b16 a[20:21], v27 offset:4096
    ds_read_b64_tr_b16 a[22:23], v27 offset:5120
    ds_read_b64_tr_b16 a[24:25], v28 offset:4096
    ds_read_b64_tr_b16 a[26:27], v28 offset:5120
    ds_read_b64_tr_b16 a[28:29], v29 offset:4096
    ds_read_b64_tr_b16 a[30:31], v29 offset:5120
    ds_read_b64_tr_b16 a[32:33], v26 offset:8192
    ds_read_b64_tr_b16 a[34:35], v26 offset:9216
    ds_read_b64_tr_b16 a[36:37], v27 offset:8192
    ds_read_b64_tr_b16 a[38:39], v27 offset:9216
    ds_read_b64_tr_b16 a[40:41], v28 offset:8192
    ds_read_b64_tr_b16 a[42:43], v28 offset:9216
    ds_read_b64_tr_b16 a[44:45], v29 offset:8192
    ds_read_b64_tr_b16 a[46:47], v29 offset:9216
    ds_read_b64_tr_b16 a[48:49], v26 offset:12288
    ds_read_b64_tr_b16 a[50:51], v26 offset:13312
    ds_read_b64_tr_b16 a[52:53], v27 offset:12288
    ds_read_b64_tr_b16 a[54:55], v27 offset:13312
    ds_read_b64_tr_b16 a[56:57], v28 offset:12288
    ds_read_b64_tr_b16 a[58:59], v28 offset:13312
    ds_read_b64_tr_b16 a[60:61], v29 offset:12288
    ds_read_b64_tr_b16 a[62:63], v29 offset:13312
    v_add_u32 v26, 0xffff0000, v26
    v_add_u32 v27, 0xffff0000, v27
    v_add_u32 v28, 0xffff0000, v28
    v_add_u32 v29, 0xffff0000, v29
    ds_read_b64_tr_b16 a[64:65], v26 offset:0
    ds_read_b64_tr_b16 a[66:67], v26 offset:1024
    ds_read_b64_tr_b16 a[68:69], v27 offset:0
    ds_read_b64_tr_b16 a[70:71], v27 offset:1024
    ds_read_b64_tr_b16 a[72:73], v28 offset:0
    ds_read_b64_tr_b16 a[74:75], v28 offset:1024
    s_movk_i32 s58, 16384
    s_waitcnt vmcnt(0)
    buffer_store_dword v45, v112, s[40:43], s58 offen
    ds_read_b64_tr_b16 a[76:77], v29 offset:0
    ds_read_b64_tr_b16 a[78:79], v29 offset:1024
    ds_read_b64_tr_b16 a[80:81], v26 offset:4096
    ds_read_b64_tr_b16 a[82:83], v26 offset:5120
    ds_read_b64_tr_b16 a[84:85], v27 offset:4096
    ds_read_b64_tr_b16 a[86:87], v27 offset:5120
    ds_read_b64_tr_b16 a[88:89], v28 offset:4096
    ds_read_b64_tr_b16 a[90:91], v28 offset:5120
    ds_read_b64_tr_b16 a[92:93], v29 offset:4096
    ds_read_b64_tr_b16 a[94:95], v29 offset:5120
    ds_read_b64_tr_b16 a[96:97], v26 offset:8192
    ds_read_b64_tr_b16 a[98:99], v26 offset:9216
    s_lshl_b32 s59, s49, 16
    s_lshl_b32 s91, s50, 17
    s_add_u32 s59, s59, s91
    s_lshl_b32 s91, s44, 14
    s_add_u32 s59, s59, s91
    s_add_u32 s59, s59, 4194304
    v_add_u32 v38, s59, v36
    s_lshl_b32 s59, s87, 12
    buffer_load_dword v47, v44, s[40:43], s58 offen sc1
    ds_read_b64_tr_b16 a[100:101], v27 offset:8192
    ds_read_b64_tr_b16 a[102:103], v27 offset:9216
    ds_read_b64_tr_b16 a[104:105], v28 offset:8192
    ds_read_b64_tr_b16 a[106:107], v28 offset:9216
    ds_read_b64_tr_b16 a[108:109], v29 offset:8192
    ds_read_b64_tr_b16 a[110:111], v29 offset:9216
    ds_read_b64_tr_b16 a[112:113], v26 offset:12288
    ds_read_b64_tr_b16 a[114:115], v26 offset:13312
    ds_read_b64_tr_b16 a[116:117], v27 offset:12288
    ds_read_b64_tr_b16 a[118:119], v27 offset:13312
    ds_read_b64_tr_b16 a[120:121], v28 offset:12288
    ds_read_b64_tr_b16 a[122:123], v28 offset:13312
    v_mov_b32 v4, 0
    v_mov_b32 v5, 0
    s_branch L_page3
    .p2align 12
L_pad3:
    s_setpc_b64 s[0:1]
    s_nop 0
L_page3:
    s_mov_b32 s61, 0
    s_branch L_got_11
L_again_12:
    buffer_load_dword v47, v44, s[40:43], s58 offen sc1
    s_addk_i32 s61, 1
    s_cmp_gt_u32 s61, 0x80000
    s_cbranch_scc1 L_abort
    s_waitcnt vmcnt(0)
L_got_11:
    s_waitcnt vmcnt(0)
    v_cmp_ne_u32 vcc, s53, v47
    s_cbranch_vccnz L_again_12
    buffer_load_dwordx4 v[160:163], v38, s[40:43], s59 offen offset:0 sc1
    buffer_load_dwordx4 v[164:167], v38, s[40:43], s59 offen offset:1024 sc1
    buffer_load_dwordx4 v[168:171], v38, s[40:43], s59 offen offset:2048 sc1
    buffer_load_dwordx4 v[172:175], v38, s[40:43], s59 offen offset:3072 sc1
    s_add_u32 s59, s59, 4096
    s_and_b32 s59, s59, 0x3fff
    buffer_load_dwordx4 v[176:179], v38, s[40:43], s59 offen offset:0 sc1
    buffer_load_dwordx4 v[180:183], v38, s[40:43], s59 offen offset:1024 sc1
    buffer_load_dwordx4 v[184:187], v38, s[40:43], s59 offen offset:2048 sc1
    s_waitcnt vmcnt(6) lgkmcnt(15)
    v_mfma_f32_16x16x32_bf16 v[224:227], a[0:3], v[160:163], v[224:227]
    buffer_load_dwordx4 v[188:191], v38, s[40:43], s59 offen offset:3072 sc1
    ds_read_b64_tr_b16 a[124:125], v29 offset:12288
    v_mfma_f32_16x16x32_bf16 v[228:231], a[4:7], v[160:163], v[228:231]
    ds_read_b64_tr_b16 a[126:127], v29 offset:13312
    ds_read_b64_tr_b16 a[128:129], v26 offset:16384
    s_waitcnt lgkmcnt(15)
    v_mfma_f32_16x16x32_bf16 v[232:235], a[8:11], v[160:163], v[232:235]
    ds_read_b64_tr_b16 a[130:131], v26 offset:17408
    v_mfma_f32_16x16x32_bf16 v[236:239], a[12:15], v[160:163], v[236:239]
    ds_read_b64_tr_b16 a[132:133], v27 offset:16384
    s_waitcnt vmcnt(6) lgkmcnt(15)
    v_mfma_f32_16x16x32_bf16 v[224:227], a[16:19], v[164:167], v[224:227]
    ds_read_b64_tr_b16 a[134:135], v27 offset:17408
    s_add_u32 s59, s59, 4096
    s_and_b32 s59, s59, 0x3fff
    buffer_load_dwordx4 v[192:195], v38, s[40:43], s59 offen offset:0 sc1
    v_mfma_f32_16x16x32_bf16 v[228:231], a[20:23], v[164:167], v[228:231]
    ds_read_b64_tr_b16 a[136:137], v28 offset:16384
    ds_read_b64_tr_b16 a[138:139], v28 offset:17408
    s_waitcnt lgkmcnt(15)
    v_mfma_f32_16x16x32_bf16 v[232:235], a[24:27], v[164:167], v[232:235]
    ds_read_b64_tr_b16 a[140:141], v29 offset:16384
    v_mfma_f32_16x16x32_bf16 v[236:239], a[28:31], v[164:167], v[236:239]
    ds_read_b64_tr_b16 a[142:143], v29 offset:17408
    s_waitcnt vmcnt(6) lgkmcnt(15)
    v_mfma_f32_16x16x32_bf16 v[224:227], a[32:35], v[168:171], v[224:227]
    ds_read_b64_tr_b16 a[144:145], v26 offset:20480
    buffer_load_dwordx4 v[196:199], v38, s[40:43], s59 offen offset:1024 sc1
    v_mfma_f32_16x16x32_bf16 v[228:231], a[36:39], v[168:171], v[228:231]
    ds_read_b64_tr_b16 a[146:147], v26 offset:21504
    ds_read_b64_tr_b16 a[148:149], v27 offset:20480
    s_waitcnt lgkmcnt(15)
    v_mfma_f32_16x16x32_bf16 v[232:235], a[40:43], v[168:171], v[232:235]
    ds_read_b64_tr_b16 a[150:151], v27 offset:21504
    v_mfma_f32_16x16x32_bf16 v[236:239], a[44:47], v[168:171], v[236:239]
    ds_read_b64_tr_b16 a[152:153], v28 offset:20480
    s_waitcnt vmcnt(6) lgkmcnt(15)
    v_mfma_f32_16x16x32_bf16 v[224:227], a[48:51], v[172:175], v[224:227]
    ds_read_b64_tr_b16 a[154:155], v28 offset:21504
    buffer_load_dwordx4 v[200:203], v38, s[40:43], s59 offen offset:2048 sc1
    v_mfma_f32_16x16x32_bf16 v[228:231], a[52:55], v[172:175], v[228:231]
    ds_read_b64_tr_b16 a[156:157], v29 offset:20480
    ds_read_b64_tr_b16 a[158:159], v29 offset:21504
    s_waitcnt lgkmcnt(15)
    v_mfma_f32_16x16x32_bf16 v[232:235], a[56:59], v[172:175], v[232:235]
    ds_read_b64_tr_b16 a[160:161], v26 offset:24576
    v_mfma_f32_16x16x32_bf16 v[236:239], a[60:63], v[172:175], v[236:239]
    ds_read_b64_tr_b16 a[162:163], v26 offset:25600
    s_waitcnt vmcnt(6) lgkmcnt(15)
    v_mfma_f32_16x16x32_bf16 v[224:227], a[64:67], v[176:179], v[224:227]
    ds_read_b64_tr_b16 a[164:165], v27 offset:24576
    buffer_load_dwordx4 v[204:207], v38, s[40:43], s59 offen offset:3072 sc1
    v_mfma_f32_16x16x32_bf16 v[228:231], a[68:71], v[176:179], v[228:231]
    ds_read_b64_tr_b16 a[166:167], v27 offset:25600
    ds_read_b64_tr_b16 a[168:169], v28 offset:24576
    s_waitcnt lgkmcnt(15)
    v_mfma_f32_16x16x32_bf16 v[232:235], a[72:75], v[176:179], v[232:235]
    ds_read_b64_tr_b16 a[170:171], v28 offset:25600
    v_mfma_f32_16x16x32_bf16 v[236:239], a[76:79], v[176:179], v[236:239]
    ds_read_b64_tr_b16 a[172:173], v29 offset:24576
    s_waitcnt vmcnt(6) lgkmcnt(15)
    v_mfma_f32_16x16x32_bf16 v[224:227], a[80:83], v[180:183], v[224:227]
    ds_read_b64_tr_b16 a[174:175], v29 offset:25600
    s_add_u32 s59, s59, 4096
    s_and_b32 s59, s59, 0x3fff
    buffer_load_dwordx4 v[208:211], v38, s[40:43], s59 offen offset:0 sc1
    v_mfma_f32_16x16x32_bf16 v[228:231], a[84:87], v[180:183], v[228:231]
    ds_read_b64_tr_b16 a[176:177], v26 offset:28672
    ds_read_b64_tr_b16 a[178:179], v26 offset:29696
    s_waitcnt lgkmcnt(15)
    v_mfma_f32_16x16x32_bf16 v[232:235], a[88:91], v[180:183], v[232:235]
    ds_read_b64_tr_b16 a[180:181], v27 offset:28672
    v_mfma_f32_16x16x32_bf16 v[236:239], a[92:95], v[180:183], v[236:239]
    ds_read_b64_tr_b16 a[182:183], v27 offset:29696
    s_waitcnt vmcnt(6) lgkmcnt(15)
    v_mfma_f32_16x16x32_bf16 v[224:227], a[96:99], v[184:187], v[224:227]
    ds_read_b64_tr_b16 a[184:185], v28 offset:28672
    buffer_load_dwordx4 v[212:215], v38, s[40:43], s59 offen offset:1024 sc1
    v_mfma_f32_16x16x32_bf16 v[228:231], a[100:103], v[184:187], v[228:231]
    ds_read_b64_tr_b16 a[186:187], v28 offset:29696
    ds_read_b64_tr_b16 a[188:189], v29 offset:28672
    s_waitcnt lgkmcnt(15)
    v_mfma_f32_16x16x32_bf16 v[232:235], a[104:107], v[184:187], v[232:235]
    ds_read_b64_tr_b16 a[190:191], v29 offset:29696
    v_mfma_f32_16x16x32_bf16 v[236:239], a[108:111], v[184:187], v[236:239]
    ds_read_b64_tr_b16 a[192:193], v26 offset:32768
    s_waitcnt vmcnt(6) lgkmcnt(15)
    v_mfma_f32_16x16x32_bf16 v[224:227], a[112:115], v[188:191], v[224:227]
    ds_read_b64_tr_b16 a[194:195], v26 offset:33792
    buffer_load_dwordx4 v[216:219], v38, s[40:43], s59 offen offset:2048 sc1
    v_mfma_f32_16x16x32_bf16 v[228:231], a[116:119], v[188:191], v[228:231]
    ds_read_b64_tr_b16 a[196:197], v27 offset:32768
    ds_read_b64_tr_b16 a[198:199], v27 offset:33792
    s_waitcnt lgkmcnt(15)
    v_mfma_f32_16x16x32_bf16 v[232:235], a[120:123], v[188:191], v[232:235]
    ds_read_b64_tr_b16 a[200:201], v28 offset:32768
    v_mfma_f32_16x16x32_bf16 v[236:239], a[124:127], v[188:191], v[236:239]
    ds_read_b64_tr_b16 a[202:203], v28 offset:33792
    s_waitcnt vmcnt(6) lgkmcnt(15)
    v_mfma_f32_16x16x32_bf16 v[224:227], a[128:131], v[192:195], v[224:227]
    ds_read_b64_tr_b16 a[204:205], v29 offset:32768
    buffer_load_dwordx4 v[220:223], v38, s[40:43], s59 offen offset:3072 sc1
    v_mfma_f32_16x16x32_bf16 v[228:231], a[132:135], v[192:195], v[228:231]
    ds_read_b64_tr_b16 a[206:207], v29 offset:33792
    ds_read_b64_tr_b16 a[208:209], v26 offset:36864
    s_waitcnt lgkmcnt(15)
    v_mfma_f32_16x16x32_bf16 v[232:235], a[136:139], v[192:195], v[232:235]
    ds_read_b64_tr_b16 a[210:211], v26 offset:37888
    v_mfma_f32_16x16x32_bf16 v[236:239], a[140:143], v[192:195], v[236:239]
    ds_read_b64_tr_b16 a[212:213], v27 offset:36864
    s_waitcnt vmcnt(6) lgkmcnt(15)
    v_mfma_f32_16x16x32_bf16 v[224:227], a[144:147], v[196:199], v[224:227]
    ds_read_b64_tr_b16 a[214:215], v27 offset:37888
    buffer_load_dwordx4 v41, s[20:23], s94 offen offset:3072 lds
    v_mfma_f32_16x16x32_bf16 v[228:231], a[148:151], v[196:199], v[228:231]
    ds_read_b64_tr_b16 a[216:217], v28 offset:36864
    ds_read_b64_tr_b16 a[218:219], v28 offset:37888
    s_waitcnt lgkmcnt(15)
    v_mfma_f32_16x16x32_bf16 v[232:235], a[152:155], v[196:199], v[232:235]
    ds_read_b64_tr_b16 a[220:221], v29 offset:36864
    v_mfma_f32_16x16x32_bf16 v[236:239], a[156:159], v[196:199], v[236:239]
    ds_read_b64_tr_b16 a[222:223], v29 offset:37888
    s_waitcnt vmcnt(6) lgkmcnt(15)
    v_mfma_f32_16x16x32_bf16 v[224:227], a[160:163], v[200:203], v[224:227]
    ds_read_b64_tr_b16 a[224:225], v26 offset:40960
    s_mov_b32 s97, 0x70000
    s_cmp_eq_u32 s86, 2
    s_cselect_b32 s97, 0xffeb0000, s97
    v_add_u32 v41, s97, v41
    s_add_u32 m0, s62, 114688
    s_nop 0
    buffer_load_dwordx4 v41, s[20:23], 0 offen offset:0 lds
    v_mfma_f32_16x16x32_bf16 v[228:231], a[164:167], v[200:203], v[228:231]
    ds_read_b64_tr_b16 a[226:227], v26 offset:41984
    ds_read_b64_tr_b16 a[228:229], v27 offset:40960
    s_waitcnt lgkmcnt(15)
    v_mfma_f32_16x16x32_bf16 v[232:235], a[168:171], v[200:203], v[232:235]
    ds_read_b64_tr_b16 a[230:231], v27 offset:41984
    v_mfma_f32_16x16x32_bf16 v[236:239], a[172:175], v[200:203], v[236:239]
    ds_read_b64_tr_b16 a[232:233], v28 offset:40960
    s_waitcnt vmcnt(6) lgkmcnt(15)
    v_mfma_f32_16x16x32_bf16 v[224:227], a[176:179], v[204:207], v[224:227]
    ds_read_b64_tr_b16 a[234:235], v28 offset:41984
    buffer_load_dwordx4 v41, s[20:23], s92 offen offset:1024 lds
    v_mfma_f32_16x16x32_bf16 v[228:231], a[180:183], v[204:207], v[228:231]
    ds_read_b64_tr_b16 a[236:237], v29 offset:40960
    ds_read_b64_tr_b16 a[238:239], v29 offset:41984
    s_waitcnt lgkmcnt(15)
    v_mfma_f32_16x16x32_bf16 v[232:235], a[184:187], v[204:207], v[232:235]
    ds_read_b64_tr_b16 a[240:241], v26 offset:45056
    v_mfma_f32_16x16x32_bf16 v[236:239], a[188:191], v[204:207], v[236:239]
    ds_read_b64_tr_b16 a[242:243], v26 offset:46080
    s_waitcnt vmcnt(6) lgkmcnt(15)
    v_mfma_f32_16x16x32_bf16 v[224:227], a[192:195], v[208:211], v[224:227]
    ds_read_b64_tr_b16 a[244:245], v27 offset:45056
    buffer_load_dwordx4 v41, s[20:23], s93 offen offset:2048 lds
    v_mfma_f32_16x16x32_bf16 v[228:231], a[196:199], v[208:211], v[228:231]
    ds_read_b64_tr_b16 a[246:247], v27 offset:46080
    ds_read_b64_tr_b16 a[248:249], v28 offset:45056
    s_waitcnt lgkmcnt(15)
    v_mfma_f32_16x16x32_bf16 v[232:235], a[200:203], v[208:211], v[232:235]
    ds_read_b64_tr_b16 a[250:251], v28 offset:46080
    v_mfma_f32_16x16x32_bf16 v[236:239], a[204:207], v[208:211], v[236:239]
    ds_read_b64_tr_b16 a[252:253], v29 offset:45056
    s_waitcnt vmcnt(6) lgkmcnt(15)
    v_mfma_f32_16x16x32_bf16 v[224:227], a[208:211], v[212:215], v[224:227]
    ds_read_b64_tr_b16 a[254:255], v29 offset:46080
    buffer_load_dwordx4 v41, s[20:23], s94 offen offset:3072 lds
    v_mfma_f32_16x16x32_bf16 v[228:231], a[212:215], v[212:215], v[228:231]
    s_waitcnt lgkmcnt(15)
    v_mfma_f32_16x16x32_bf16 v[232:235], a[216:219], v[212:215], v[232:235]
    v_mfma_f32_16x16x32_bf16 v[236:239], a[220:223], v[212:215], v[236:239]
    s_waitcnt vmcnt(6) lgkmcnt(12)
    v_mfma_f32_16x16x32_bf16 v[224:227], a[224:227], v[216:219], v[224:227]
    v_mfma_f32_16x16x32_bf16 v[228:231], a[228:231], v[216:219], v[228:231]
    s_waitcnt lgkmcnt(8)
    v_mfma_f32_16x16x32_bf16 v[232:235], a[232:235], v[216:219], v[232:235]
    v_mfma_f32_16x16x32_bf16 v[236:239], a[236:239], v[216:219], v[236:239]
    s_waitcnt vmcnt(5) lgkmcnt(4)
    v_mfma_f32_16x16x32_bf16 v[224:227], a[240:243], v[220:223], v[224:227]
    v_mfma_f32_16x16x32_bf16 v[228:231], a[244:247], v[220:223], v[228:231]
    s_waitcnt lgkmcnt(0)
    v_mfma_f32_16x16x32_bf16 v[232:235], a[248:251], v[220:223], v[232:235]
    v_mfma_f32_16x16x32_bf16 v[236:239], a[252:255], v[220:223], v[236:239]
    s_movk_i32 s58, 24576
    s_nop 2
    v_cvt_pk_bf16_f32 v18, v224, v225
    v_cvt_pk_bf16_f32 v19, v226, v227
    v_cvt_pk_bf16_f32 v20, v228, v229
    v_cvt_pk_bf16_f32 v21, v230, v231
    v_cvt_pk_bf16_f32 v22, v232, v233
    v_cvt_pk_bf16_f32 v23, v234, v235
    v_cvt_pk_bf16_f32 v24, v236, v237
    v_cvt_pk_bf16_f32 v25, v238, v239
    buffer_store_dwordx4 v[18:21], v113, s[40:43], 0 offen offset:0
    buffer_store_dwordx4 v[22:25], v113, s[40:43], 0 offen offset:2048
    v_dot2c_f32_bf16 v4, s57, v18
    v_dot2c_f32_bf16 v5, v18, v18
    v_dot2c_f32_bf16 v4, s57, v19
    v_dot2c_f32_bf16 v5, v19, v19
    v_dot2c_f32_bf16 v4, s57, v20
    v_dot2c_f32_bf16 v5, v20, v20
    v_dot2c_f32_bf16 v4, s57, v21
    v_dot2c_f32_bf16 v5, v21, v21
    v_dot2c_f32_bf16 v4, s57, v22
    v_dot2c_f32_bf16 v5, v22, v22
    v_dot2c_f32_bf16 v4, s57, v23
    v_dot2c_f32_bf16 v5, v23, v23
    v_dot2c_f32_bf16 v4, s57, v24
    v_dot2c_f32_bf16 v5, v24, v24
    v_dot2c_f32_bf16 v4, s57, v25
    v_dot2c_f32_bf16 v5, v25, v25
    s_nop 2
    v_permlane32_swap_b32 v4, v5
    v_add_f32 v4, v4, v5
    v_mov_b32 v5, v4
    s_nop 1
    v_permlane16_swap_b32 v4, v5
    v_add_f32 v4, v4, v5
    buffer_store_dword v4, v114, s[40:43], 0 offen
    s_barrier
    v_and_b32 v40, 131071, v40
    s_mov_b32 s97, 0x6f900
    s_cmp_eq_u32 s86, 1
    s_cselect_b32 s97, 0xffeaf900, s97
    v_add_u32 v41, s97, v41
    s_add_u32 m0, s62, 49152
    s_nop 0
    buffer_load_dwordx4 v41, s[20:23], 0 offen offset:0 lds
    buffer_load_dwordx4 v41, s[20:23], s92 offen offset:1024 lds
    v_and_b32 v37, 19, v0
    v_bfe_u32 v1, v0, 2, 1
    v_lshl_add_u32 v37, v1, 3, v37
    v_bfe_u32 v1, v0, 3, 1
    v_lshl_add_u32 v37, v1, 2, v37
    s_lshl_b32 s88, s95, 15
    s_lshl_b32 s91, s50, 17
    s_add_u32 s88, s88, s91
    s_add_u32 s88, s88, 4325376
    v_lshl_add_u32 v49, v37, 4, s88
    v_lshrrev_b32 v1, 5, v0
    v_lshl_add_u32 v49, v1, 9, v49
    s_lshl_b32 s88, s95, 11
    s_add_u32 s88, s88, 131072
    v_lshl_add_u32 v48, v37, 3, s88
    v_lshl_add_u32 v48, v1, 10, v48
    s_lshl_b32 s88, s95, 6
    v_lshl_add_u32 v51, v37, 1, s88
    s_lshl_b32 s3, s50, 18
    s_add_u32 s3, s3, 4194304
    s_mul_i32 s88, s44, 57344
    s_lshl_b32 s91, s48, 11
    s_add_u32 s88, s88, s91
    s_add_u32 s88, s88, s3
    v_and_b32 v38, 15, v37
    v_lshl_add_u32 v50, v1, 8, s88
    v_lshl_add_u32 v50, v38, 4, v50
    v_bfe_u32 v1, v0, 4, 1
    v_mul_u32_u24 v1, 28672, v1
    v_add_u32 v50, v50, v1
    s_lshl_b32 s88, s95, 7
    v_and_b32 v1, 15, v0
    v_lshl_add_u32 v38, v1, 2, s88
    s_or_b32 s88, s2, s44
    v_or_b32 v37, s88, v0
    v_cmp_eq_u32 vcc, 0, v37
    s_add_u32 s59, s44, s86
    s_and_b32 s59, s59, 3
    s_lshl_b32 s59, s59, 13
    s_lshl_b32 s60, s44, 14
    v_cndmask_b32 v1, v39, v37, vcc
    s_waitcnt vmcnt(3)
    buffer_store_dword v45, v112, s[40:43], s58 offen
    buffer_store_dword v45, v1, s[40:43], 0 offen offset:0
    s_cmp_ge_u32 s48, 14
    s_cbranch_scc1 L_spare
L_s4:
    s_barrier
    buffer_load_dword v47, v38, s[40:43], s58 offen sc1
    buffer_load_dwordx4 v41, s[20:23], s93 offen offset:2048 lds
    buffer_load_dwordx4 v41, s[20:23], s94 offen offset:3072 lds
    s_add_u32 s97, s60, 81920
    v_add_u32 v52, s97, v43
    v_xor_b32 v53, 64, v52
    ds_read_b64_tr_b16 v[76:77], v52 offset:0
    ds_read_b64_tr_b16 v[78:79], v52 offset:2048
    ds_read_b64_tr_b16 v[80:81], v53 offset:0
    ds_read_b64_tr_b16 v[82:83], v53 offset:2048
    ds_read_b64_tr_b16 v[84:85], v52 offset:1024
    ds_read_b64_tr_b16 v[86:87], v52 offset:3072
    ds_read_b64_tr_b16 v[88:89], v53 offset:1024
    ds_read_b64_tr_b16 v[90:91], v53 offset:3072
    s_mov_b32 s61, 0
    s_branch L_got_14
L_again_15:
    buffer_load_dword v47, v38, s[40:43], s58 offen sc1
    s_addk_i32 s61, 1
    s_cmp_gt_u32 s61, 0x80000
    s_cbranch_scc1 L_abort
    s_waitcnt vmcnt(0)
L_got_14:
    s_waitcnt vmcnt(2)
    v_cmp_ne_u32 vcc, s53, v47
    s_cbranch_vccnz L_again_15
    buffer_load_dwordx4 v[128:131], v49, s[40:43], s59 offen offset:0 sc1
    buffer_load_dwordx4 v[132:135], v49, s[40:43], s59 offen offset:1024 sc1
    buffer_load_dwordx4 v[136:139], v49, s[40:43], s59 offen offset:2048 sc1
    buffer_load_dwordx4 v[140:143], v49, s[40:43], s59 offen offset:3072 sc1
    s_add_u32 s59, s59, 4096
    s_and_b32 s59, s59, 0x7fff
    buffer_load_dwordx4 v[144:147], v49, s[40:43], s59 offen offset:0 sc1
    s_waitcnt vmcnt(4) lgkmcnt(6)
    v_mfma_f32_32x32x16_bf16 v[96:111], v[76:79], v[128:131], 0
    buffer_load_dwordx4 v[148:151], v49, s[40:43], s59 offen offset:1024 sc1
    ds_read_b64_tr_b16 v[92:93], v52 offset:4096
    ds_read_b64_tr_b16 v[94:95], v52 offset:6144
    v_mfma_f32_16x16x32_bf16 v[62:65], v[14:17], v[76:79], 0
    s_waitcnt lgkmcnt(6)
    v_mfma_f32_32x32x16_bf16 v[112:127], v[80:83], v[128:131], 0
    buffer_load_dwordx4 v[152:155], v49, s[40:43], s59 offen offset:2048 sc1
    ds_read_b64_tr_b16 v[76:77], v53 offset:4096
    ds_read_b64_tr_b16 v[78:79], v53 offset:6144
    v_mfma_f32_16x16x32_bf16 v[66:69], v[14:17], v[80:83], 0
    s_waitcnt vmcnt(5) lgkmcnt(6)
    v_mfma_f32_32x32x16_bf16 v[96:111], v[84:87], v[132:135], v[96:111]
    buffer_load_dwordx4 v[156:159], v49, s[40:43], s59 offen offset:3072 sc1
    ds_read_b64_tr_b16 v[80:81], v52 offset:5120
    ds_read_b64_tr_b16 v[82:83], v52 offset:7168
    v_mfma_f32_16x16x32_bf16 v[62:65], v[14:17], v[84:87], v[62:65]
    s_waitcnt lgkmcnt(6)
    v_mfma_f32_32x32x16_bf16 v[112:127], v[88:91], v[132:135], v[112:127]
    s_add_u32 s59, s59, 4096
    s_and_b32 s59, s59, 0x7fff
    buffer_load_dwordx4 v[160:163], v49, s[40:43], s59 offen offset:0 sc1
    ds_read_b64_tr_b16 v[84:85], v53 offset:5120
    ds_read_b64_tr_b16 v[86:87], v53 offset:7168
    v_mfma_f32_16x16x32_bf16 v[66:69], v[14:17], v[88:91], v[66:69]
    s_waitcnt vmcnt(6) lgkmcnt(6)
    v_mfma_f32_32x32x16_bf16 v[96:111], v[92:95], v[136:139], v[96:111]
    buffer_load_dwordx4 v[164:167], v49, s[40:43], s59 offen offset:1024 sc1
    ds_read_b64_tr_b16 v[88:89], v52 offset:8192
    ds_read_b64_tr_b16 v[90:91], v52 offset:10240
    v_mfma_f32_16x16x32_bf16 v[62:65], v[14:17], v[92:95], v[62:65]
    s_waitcnt lgkmcnt(6)
    v_mfma_f32_32x32x16_bf16 v[112:127], v[76:79], v[136:139], v[112:127]
    buffer_load_dwordx4 v[168:171], v49, s[40:43], s59 offen offset:2048 sc1
    ds_read_b64_tr_b16 v[92:93], v53 offset:8192
    ds_read_b64_tr_b16 v[94:95], v53 offset:10240
    v_mfma_f32_16x16x32_bf16 v[66:69], v[14:17], v[76:79], v[66:69]
    s_waitcnt vmcnt(7) lgkmcnt(6)
    v_mfma_f32_32x32x16_bf16 v[96:111], v[80:83], v[140:143], v[96:111]
    buffer_load_dwordx4 v[172:175], v49, s[40:43], s59 offen offset:3072 sc1
    ds_read_b64_tr_b16 v[76:77], v52 offset:9216
    ds_read_b64_tr_b16 v[78:79], v52 offset:11264
    v_mfma_f32_16x16x32_bf16 v[62:65], v[14:17], v[80:83], v[62:65]
    s_waitcnt lgkmcnt(6)
    v_mfma_f32_32x32x16_bf16 v[112:127], v[84:87], v[140:143], v[112:127]
    buffer_load_dwordx2 v[54:55], v48, s[40:43], 0 offen offset:0 sc1
    ds_read_b64_tr_b16 v[80:81], v53 offset:9216
    ds_read_b64_tr_b16 v[82:83], v53 offset:11264
    v_mfma_f32_16x16x32_bf16 v[66:69], v[14:17], v[84:87], v[66:69]
    s_waitcnt vmcnt(8) lgkmcnt(6)
    v_mfma_f32_32x32x16_bf16 v[96:111], v[88:91], v[144:147], v[96:111]
    buffer_load_dwordx2 v[56:57], v48, s[40:43], 0 offen offset:256 sc1
    ds_read_b64_tr_b16 v[84:85], v52 offset:12288
    ds_read_b64_tr_b16 v[86:87], v52 offset:14336
    v_mfma_f32_16x16x32_bf16 v[62:65], v[14:17], v[88:91], v[62:65]
    s_waitcnt lgkmcnt(6)
    v_mfma_f32_32x32x16_bf16 v[112:127], v[92:95], v[144:147], v[112:127]
    buffer_load_dwordx2 v[58:59], v48, s[40:43], 0 offen offset:512 sc1
    ds_read_b64_tr_b16 v[88:89], v53 offset:12288
    ds_read_b64_tr_b16 v[90:91], v53 offset:14336
    v_mfma_f32_16x16x32_bf16 v[66:69], v[14:17], v[92:95], v[66:69]
    s_waitcnt vmcnt(9) lgkmcnt(6)
    v_mfma_f32_32x32x16_bf16 v[96:111], v[76:79], v[148:151], v[96:111]
    buffer_load_dwordx2 v[60:61], v48, s[40:43], 0 offen offset:768 sc1
    ds_read_b64_tr_b16 v[92:93], v52 offset:13312
    ds_read_b64_tr_b16 v[94:95], v52 offset:15360
    v_mfma_f32_16x16x32_bf16 v[62:65], v[14:17], v[76:79], v[62:65]
    s_waitcnt lgkmcnt(6)
    v_mfma_f32_32x32x16_bf16 v[112:127], v[80:83], v[148:151], v[112:127]
    s_add_u32 s59, s59, 4096
    s_and_b32 s59, s59, 0x7fff
    buffer_load_dwordx4 v[176:179], v49, s[40:43], s59 offen offset:0 sc1
    ds_read_b64_tr_b16 v[76:77], v53 offset:13312
    ds_read_b64_tr_b16 v[78:79], v53 offset:15360
    v_mfma_f32_16x16x32_bf16 v[66:69], v[14:17], v[80:83], v[66:69]
    s_waitcnt vmcnt(10) lgkmcnt(6)
    v_mfma_f32_32x32x16_bf16 v[96:111], v[84:87], v[152:155], v[96:111]
    buffer_load_dwordx4 v[180:183], v49, s[40:43], s59 offen offset:1024 sc1
    s_add_u32 s60, s60, 16384
    s_and_b32 s60, s60, 0xffff
    s_add_u32 s97, s60, 81920
    v_add_u32 v52, s97, v43
    v_xor_b32 v53, 64, v52
    ds_read_b64_tr_b16 v[80:81], v52 offset:0
    ds_read_b64_tr_b16 v[82:83], v52 offset:2048
    v_mfma_f32_16x16x32_bf16 v[62:65], v[14:17], v[84:87], v[62:65]
    s_waitcnt lgkmcnt(6)
    v_mfma_f32_32x32x16_bf16 v[112:127], v[88:91], v[152:155], v[112:127]
    buffer_load_dwordx4 v[184:187], v49, s[40:43], s59 offen offset:2048 sc1
    ds_read_b64_tr_b16 v[84:85], v53 offset:0
    ds_read_b64_tr_b16 v[86:87], v53 offset:2048
    v_mfma_f32_16x16x32_bf16 v[66:69], v[14:17], v[88:91], v[66:69]
    s_waitcnt vmcnt(11) lgkmcnt(6)
    v_mfma_f32_32x32x16_bf16 v[96:111], v[92:95], v[156:159], v[96:111]
    buffer_load_dwordx4 v[188:191], v49, s[40:43], s59 offen offset:3072 sc1
    ds_read_b64_tr_b16 v[88:89], v52 offset:1024
    ds_read_b64_tr_b16 v[90:91], v52 offset:3072
    v_mfma_f32_16x16x32_bf16 v[62:65], v[14:17], v[92:95], v[62:65]
    s_waitcnt lgkmcnt(6)
    v_mfma_f32_32x32x16_bf16 v[112:127], v[76:79], v[156:159], v[112:127]
    s_add_u32 s59, s59, 4096
    s_and_b32 s59, s59, 0x7fff
    buffer_load_dwordx4 v[192:195], v49, s[40:43], s59 offen offset:0 sc1
    ds_read_b64_tr_b16 v[92:93], v53 offset:1024
    ds_read_b64_tr_b16 v[94:95], v53 offset:3072
    v_mfma_f32_16x16x32_bf16 v[66:69], v[14:17], v[76:79], v[66:69]
    s_waitcnt vmcnt(12) lgkmcnt(6)
    v_mfma_f32_32x32x16_bf16 v[96:111], v[80:83], v[160:163], v[96:111]
    buffer_load_dwordx4 v[196:199], v49, s[40:43], s59 offen offset:1024 sc1
    ds_read_b64_tr_b16 v[76:77], v52 offset:4096
    ds_read_b64_tr_b16 v[78:79], v52 offset:6144
    s_waitcnt lgkmcnt(6)
    v_mfma_f32_32x32x16_bf16 v[112:127], v[84:87], v[160:163], v[112:127]
    ds_read_b64_tr_b16 v[80:81], v53 offset:4096
    ds_read_b64_tr_b16 v[82:83], v53 offset:6144
    s_waitcnt vmcnt(12) lgkmcnt(6)
    v_mfma_f32_32x32x16_bf16 v[96:111], v[88:91], v[164:167], v[96:111]
    buffer_load_dwordx4 v[200:203], v49, s[40:43], s59 offen offset:2048 sc1
    ds_read_b64_tr_b16 v[84:85], v52 offset:5120
    ds_read_b64_tr_b16 v[86:87], v52 offset:7168
    s_lshl2_add_u32 s97, s44, 155648
    v_add_u32 v38, s97, v36
    s_waitcnt lgkmcnt(6)
    v_mfma_f32_32x32x16_bf16 v[112:127], v[92:95], v[164:167], v[112:127]
    ds_read_b64_tr_b16 v[88:89], v53 offset:5120
    ds_read_b64_tr_b16 v[90:91], v53 offset:7168
    s_waitcnt vmcnt(12) lgkmcnt(6)
    v_mfma_f32_32x32x16_bf16 v[96:111], v[76:79], v[168:171], v[96:111]
    buffer_load_dwordx4 v[204:207], v49, s[40:43], s59 offen offset:3072 sc1
    ds_read_b64_tr_b16 v[92:93], v52 offset:8192
    ds_read_b64_tr_b16 v[94:95], v52 offset:10240
    ds_write_b32 v38, v62 offset:0
    s_waitcnt lgkmcnt(7)
    v_mfma_f32_32x32x16_bf16 v[112:127], v[80:83], v[168:171], v[112:127]
    ds_read_b64_tr_b16 v[76:77], v53 offset:8192
    ds_read_b64_tr_b16 v[78:79], v53 offset:10240
    ds_write_b32 v38, v66 offset:1024
    s_waitcnt vmcnt(12) lgkmcnt(8)
    v_mfma_f32_32x32x16_bf16 v[96:111], v[84:87], v[172:175], v[96:111]
    s_add_u32 s59, s59, 4096
    s_and_b32 s59, s59, 0x7fff
    buffer_load_dwordx4 v[208:211], v49, s[40:43], s59 offen offset:0 sc1
    ds_read_b64_tr_b16 v[80:81], v52 offset:9216
    ds_read_b64_tr_b16 v[82:83], v52 offset:11264
    s_waitcnt lgkmcnt(8)
    v_mfma_f32_32x32x16_bf16 v[112:127], v[88:91], v[172:175], v[112:127]
    ds_read_b64_tr_b16 v[84:85], v53 offset:9216
    ds_read_b64_tr_b16 v[86:87], v53 offset:11264
    s_waitcnt vmcnt(8) lgkmcnt(8)
    v_mfma_f32_32x32x16_bf16 v[96:111], v[92:95], v[176:179], v[96:111]
    buffer_load_dwordx4 v[212:215], v49, s[40:43], s59 offen offset:1024 sc1
    ds_read_b64_tr_b16 v[88:89], v52 offset:12288
    ds_read_b64_tr_b16 v[90:91], v52 offset:14336
    v_add_u32 v38, 155648, v36
    s_waitcnt lgkmcnt(7)
    v_mfma_f32_32x32x16_bf16 v[112:127], v[76:79], v[176:179], v[112:127]
    ds_read_b64_tr_b16 v[92:93], v53 offset:12288
    ds_read_b64_tr_b16 v[94:95], v53 offset:14336
    s_waitcnt vmcnt(8) lgkmcnt(6)
    v_mfma_f32_32x32x16_bf16 v[96:111], v[80:83], v[180:183], v[96:111]
    buffer_load_dwordx4 v[216:219], v49, s[40:43], s59 offen offset:2048 sc1
    v_add_f32 v54, v54, v56
    v_add_f32 v58, v58, v60
    v_add_f32 v4, v54, v58
    v_add_f32 v55, v55, v57
    v_add_f32 v59, v59, v61
    v_add_f32 v5, v55, v59
    v_cmp_u_f32 vcc, v4, v5
    s_cbranch_vccnz L_retry_16
L_got_17:
    ds_read_b64_tr_b16 v[76:77], v52 offset:13312
    ds_read_b64_tr_b16 v[78:79], v52 offset:15360
    s_waitcnt lgkmcnt(6)
    v_mfma_f32_32x32x16_bf16 v[112:127], v[84:87], v[180:183], v[112:127]
    ds_read_b64_tr_b16 v[80:81], v53 offset:13312
    ds_read_b64_tr_b16 v[82:83], v53 offset:15360
    s_mov_b32 s12, 0xc0135761
    s_mov_b32 s13, 0xbdd2d3e8
    s_waitcnt vmcnt(8) lgkmcnt(6)
    v_mfma_f32_32x32x16_bf16 v[96:111], v[88:91], v[184:187], v[96:111]
    buffer_load_dwordx4 v[220:223], v49, s[40:43], s59 offen offset:3072 sc1
    s_add_u32 s60, s60, 16384
    s_and_b32 s60, s60, 0xffff
    s_add_u32 s97, s60, 81920
    v_add_u32 v52, s97, v43
    v_xor_b32 v53, 64, v52
    ds_read_b64_tr_b16 v[84:85], v52 offset:0
    ds_read_b64_tr_b16 v[86:87], v52 offset:2048
    s_waitcnt lgkmcnt(6)
    v_mfma_f32_32x32x16_bf16 v[112:127], v[92:95], v[184:187], v[112:127]
    ds_read_b64_tr_b16 v[88:89], v53 offset:0
    ds_read_b64_tr_b16 v[90:91], v53 offset:2048
    v_permlane32_swap_b32 v4, v5
    s_waitcnt vmcnt(8) lgkmcnt(6)
    v_mfma_f32_32x32x16_bf16 v[96:111], v[76:79], v[188:191], v[96:111]
    s_add_u32 s59, s59, 4096
    s_and_b32 s59, s59, 0x7fff
    buffer_load_dwordx4 v[224:227], v49, s[40:43], s59 offen offset:0 sc1
    ds_read_b64_tr_b16 v[92:93], v52 offset:1024
    ds_read_b64_tr_b16 v[94:95], v52 offset:3072
    s_waitcnt lgkmcnt(6)
    v_mfma_f32_32x32x16_bf16 v[112:127], v[80:83], v[188:191], v[112:127]
    ds_read_b64_tr_b16 v[76:77], v53 offset:1024
    ds_read_b64_tr_b16 v[78:79], v53 offset:3072
    v_add_f32 v4, v4, v5
    v_mov_b32 v5, v4
    s_waitcnt vmcnt(8) lgkmcnt(6)
    v_mfma_f32_32x32x16_bf16 v[96:111], v[84:87], v[192:195], v[96:111]
    buffer_load_dwordx4 v[228:231], v49, s[40:43], s59 offen offset:1024 sc1
    ds_read_b64_tr_b16 v[80:81], v52 offset:4096
    ds_read_b64_tr_b16 v[82:83], v52 offset:6144
    s_barrier
    s_waitcnt lgkmcnt(6)
    v_mfma_f32_32x32x16_bf16 v[112:127], v[88:91], v[192:195], v[112:127]
    ds_read_b64_tr_b16 v[84:85], v53 offset:4096
    ds_read_b64_tr_b16 v[86:87], v53 offset:6144
    v_permlane32_swap_b32 v4, v5
    s_waitcnt vmcnt(8) lgkmcnt(6)
    v_mfma_f32_32x32x16_bf16 v[96:111], v[92:95], v[196:199], v[96:111]
    s_branch L_page4
    .p2align 12
L_pad4:
    s_setpc_b64 s[0:1]
    s_nop 0
L_page4:
    buffer_load_dwordx4 v[232:235], v49, s[40:43], s59 offen offset:2048 sc1
    ds_read_b64_tr_b16 v[88:89], v52 offset:5120
    ds_read_b64_tr_b16 v[90:91], v52 offset:7168
    ds_read_b128 v[62:65], v38 offset:0
    s_waitcnt lgkmcnt(7)
    v_mfma_f32_32x32x16_bf16 v[112:127], v[76:79], v[196:199], v[112:127]
    ds_read_b64_tr_b16 v[92:93], v53 offset:5120
    ds_read_b64_tr_b16 v[94:95], v53 offset:7168
    ds_read_b128 v[66:69], v38 offset:1024
    v_mul_f32 v4, 0x3b000000, v4
    s_waitcnt vmcnt(8) lgkmcnt(8)
    v_mfma_f32_32x32x16_bf16 v[96:111], v[80:83], v[200:203], v[96:111]
    buffer_load_dwordx4 v[236:239], v49, s[40:43], s59 offen offset:3072 sc1
    ds_read_b64_tr_b16 v[76:77], v52 offset:8192
    ds_read_b64_tr_b16 v[78:79], v52 offset:10240
    v_mul_f32 v37, v4, v4
    s_waitcnt lgkmcnt(8)
    v_mfma_f32_32x32x16_bf16 v[112:127], v[84:87], v[200:203], v[112:127]
    ds_read_b64_tr_b16 v[80:81], v53 offset:8192
    ds_read_b64_tr_b16 v[82:83], v53 offset:10240
    v_fmamk_f32 v5, v5, 0xbb000000, v37
    v_min_f32 v5, 0, v5
    s_waitcnt vmcnt(8) lgkmcnt(8)
    v_mfma_f32_32x32x16_bf16 v[96:111], v[88:91], v[204:207], v[96:111]
    s_add_u32 s59, s59, 4096
    s_and_b32 s59, s59, 0x7fff
    buffer_load_dwordx4 v[240:243], v49, s[40:43], s59 offen offset:0 sc1
    ds_read_b64_tr_b16 v[84:85], v52 offset:9216
    ds_read_b64_tr_b16 v[86:87], v52 offset:11264
    s_waitcnt lgkmcnt(7)
    v_mfma_f32_32x32x16_bf16 v[112:127], v[92:95], v[204:207], v[112:127]
    ds_read_b64_tr_b16 v[88:89], v53 offset:9216
    ds_read_b64_tr_b16 v[90:91], v53 offset:11264
    v_sub_f32 v5, 0x3727c5ac, v5
    v_mul_f32 v60, 0x3727c5ac, v5
    s_waitcnt vmcnt(8) lgkmcnt(6)
    v_mfma_f32_32x32x16_bf16 v[96:111], v[76:79], v[208:211], v[96:111]
    buffer_load_dwordx4 v[244:247], v49, s[40:43], s59 offen offset:1024 sc1
    ds_read_b64_tr_b16 v[92:93], v52 offset:12288
    ds_read_b64_tr_b16 v[94:95], v52 offset:14336
    s_waitcnt lgkmcnt(6)
    v_mfma_f32_32x32x16_bf16 v[112:127], v[80:83], v[208:211], v[112:127]
    ds_read_b64_tr_b16 v[76:77], v53 offset:12288
    ds_read_b64_tr_b16 v[78:79], v53 offset:14336
    v_rsq_f32 v5, v5
    s_waitcnt vmcnt(8) lgkmcnt(6)
    v_mfma_f32_32x32x16_bf16 v[96:111], v[84:87], v[212:215], v[96:111]
    buffer_load_dwordx4 v[248:251], v49, s[40:43], s59 offen offset:2048 sc1
    ds_read_b64_tr_b16 v[80:81], v52 offset:13312
    ds_read_b64_tr_b16 v[82:83], v52 offset:15360
    v_cvt_pk_bf16_f32 v54, -v4, -v4
    s_waitcnt lgkmcnt(6)
    v_mfma_f32_32x32x16_bf16 v[112:127], v[88:91], v[212:215], v[112:127]
    ds_read_b64_tr_b16 v[84:85], v53 offset:13312
    ds_read_b64_tr_b16 v[86:87], v53 offset:15360
    v_and_b32 v37, 0xffff0000, v54
    v_sub_f32 v37, -v4, v37
    s_waitcnt vmcnt(8) lgkmcnt(6)
    v_mfma_f32_32x32x16_bf16 v[96:111], v[92:95], v[216:219], v[96:111]
    buffer_load_dwordx4 v[252:255], v49, s[40:43], s59 offen offset:3072 sc1
    s_add_u32 s60, s60, 16384
    s_and_b32 s60, s60, 0xffff
    s_add_u32 s97, s60, 81920
    v_add_u32 v52, s97, v43
    v_xor_b32 v53, 64, v52
    ds_read_b64_tr_b16 v[88:89], v52 offset:0
    ds_read_b64_tr_b16 v[90:91], v52 offset:2048
    s_waitcnt lgkmcnt(6)
    v_mfma_f32_32x32x16_bf16 v[112:127], v[76:79], v[216:219], v[112:127]
    ds_read_b64_tr_b16 v[92:93], v53 offset:0
    ds_read_b64_tr_b16 v[94:95], v53 offset:2048
    v_cvt_pk_bf16_f32 v55, v37, 0
    v_mov_b32 v56, 0
    s_waitcnt vmcnt(8) lgkmcnt(6)
    v_mfma_f32_32x32x16_bf16 v[96:111], v[80:83], v[220:223], v[96:111]
    buffer_load_ushort v51, v51, s[28:31], 0 offen
    ds_read_b64_tr_b16 v[76:77], v52 offset:1024
    ds_read_b64_tr_b16 v[78:79], v52 offset:3072
    v_mov_b32 v57, 0
    s_waitcnt lgkmcnt(6)
    v_mfma_f32_32x32x16_bf16 v[112:127], v[84:87], v[220:223], v[112:127]
    ds_read_b64_tr_b16 v[80:81], v53 offset:1024
    ds_read_b64_tr_b16 v[82:83], v53 offset:3072
    s_mov_b32 s97, 0x70000
    s_cmp_eq_u32 s86, 0
    s_cselect_b32 s97, 0xffeb0000, s97
    v_add_u32 v41, s97, v41
    s_add_u32 m0, s62, 0
    s_waitcnt vmcnt(8) lgkmcnt(6)
    v_mfma_f32_32x32x16_bf16 v[96:111], v[88:91], v[224:227], v[96:111]
    buffer_load_dwordx4 v41, s[20:23], 0 offen offset:0 lds
    ds_read_b64_tr_b16 v[84:85], v52 offset:4096
    ds_read_b64_tr_b16 v[86:87], v52 offset:6144
    v_mov_b32 v4, v5
    s_waitcnt lgkmcnt(6)
    v_mfma_f32_32x32x16_bf16 v[112:127], v[92:95], v[224:227], v[112:127]
    ds_read_b64_tr_b16 v[88:89], v53 offset:4096
    ds_read_b64_tr_b16 v[90:91], v53 offset:6144
    v_mul_f32 v58, s12, v4
    v_mul_f32 v59, v4, v4
    s_waitcnt vmcnt(8) lgkmcnt(6)
    v_mfma_f32_32x32x16_bf16 v[96:111], v[76:79], v[228:231], v[96:111]
    buffer_load_dwordx4 v41, s[20:23], s92 offen offset:1024 lds
    ds_read_b64_tr_b16 v[92:93], v52 offset:5120
    ds_read_b64_tr_b16 v[94:95], v52 offset:7168
    v_mul_f32 v59, v59, v58
    s_waitcnt lgkmcnt(6)
    v_mfma_f32_32x32x16_bf16 v[112:127], v[80:83], v[228:231], v[112:127]
    ds_read_b64_tr_b16 v[76:77], v53 offset:5120
    ds_read_b64_tr_b16 v[78:79], v53 offset:7168
    v_mul_f32 v59, 0x3d372713, v59
    s_lshl_b32 s88, s95, 12
    s_waitcnt vmcnt(8) lgkmcnt(6)
    v_mfma_f32_32x32x16_bf16 v[96:111], v[84:87], v[232:235], v[96:111]
    buffer_load_dwordx4 v41, s[20:23], s93 offen offset:2048 lds
    ds_read_b64_tr_b16 v[80:81], v52 offset:8192
    ds_read_b64_tr_b16 v[82:83], v52 offset:10240
    s_add_u32 s88, s88, 262144
    s_waitcnt lgkmcnt(6)
    v_mfma_f32_32x32x16_bf16 v[112:127], v[88:91], v[232:235], v[112:127]
    ds_read_b64_tr_b16 v[84:85], v53 offset:8192
    ds_read_b64_tr_b16 v[86:87], v53 offset:10240
    v_and_b32 v1, 31, v0
    v_lshl_add_u32 v48, v1, 4, s88
    s_waitcnt vmcnt(8) lgkmcnt(6)
    v_mfma_f32_32x32x16_bf16 v[96:111], v[92:95], v[236:239], v[96:111]
    buffer_load_dwordx4 v41, s[20:23], s94 offen offset:3072 lds
    ds_read_b64_tr_b16 v[88:89], v52 offset:9216
    ds_read_b64_tr_b16 v[90:91], v52 offset:11264
    v_lshrrev_b32 v1, 5, v0
    s_waitcnt lgkmcnt(6)
    v_mfma_f32_32x32x16_bf16 v[112:127], v[76:79], v[236:239], v[112:127]
    ds_read_b64_tr_b16 v[92:93], v53 offset:9216
    ds_read_b64_tr_b16 v[94:95], v53 offset:11264
    s_mov_b32 s97, 0x70000
    s_cmp_eq_u32 s86, 3
    s_cselect_b32 s97, 0xffeb0000, s97
    v_add_u32 v41, s97, v41
    s_add_u32 m0, s62, 16384
    s_waitcnt vmcnt(8) lgkmcnt(6)
    v_mfma_f32_32x32x16_bf16 v[96:111], v[80:83], v[240:243], v[96:111]
    buffer_load_dwordx4 v41, s[20:23], 0 offen offset:0 lds
    ds_read_b64_tr_b16 v[76:77], v52 offset:12288
    ds_read_b64_tr_b16 v[78:79], v52 offset:14336
    v_lshl_add_u32 v48, v1, 11, v48
    s_waitcnt lgkmcnt(6)
    v_mfma_f32_32x32x16_bf16 v[112:127], v[84:87], v[240:243], v[112:127]
    ds_read_b64_tr_b16 v[80:81], v53 offset:12288
    ds_read_b64_tr_b16 v[82:83], v53 offset:14336
    v_add_f32 v62, v62, v63
    v_add_f32 v64, v64, v65
    s_waitcnt vmcnt(8) lgkmcnt(6)
    v_mfma_f32_32x32x16_bf16 v[96:111], v[88:91], v[244:247], v[96:111]
    buffer_load_dwordx4 v41, s[20:23], s92 offen offset:1024 lds
    ds_read_b64_tr_b16 v[84:85], v52 offset:13312
    ds_read_b64_tr_b16 v[86:87], v52 offset:15360
    v_add_f32 v62, v62, v64
    s_waitcnt lgkmcnt(6)
    v_mfma_f32_32x32x16_bf16 v[112:127], v[92:95], v[244:247], v[112:127]
    ds_read_b64_tr_b16 v[88:89], v53 offset:13312
    ds_read_b64_tr_b16 v[90:91], v53 offset:15360
    v_cvt_pk_bf16_f32 v63, v62, 0
    v_lshlrev_b32 v64, 16, v63
    s_waitcnt vmcnt(8) lgkmcnt(6)
    v_mfma_f32_32x32x16_bf16 v[96:111], v[76:79], v[248:251], v[96:111]
    buffer_load_dwordx4 v41, s[20:23], s93 offen offset:2048 lds
    v_sub_f32 v64, v62, v64
    v_cvt_pk_bf16_f32 v62, v62, v64
    v_mov_b32 v64, 0
    s_waitcnt lgkmcnt(4)
    v_mfma_f32_32x32x16_bf16 v[112:127], v[80:83], v[248:251], v[112:127]
    v_mov_b32 v65, 0
    v_add_f32 v66, v66, v67
    v_add_f32 v68, v68, v69
    v_add_f32 v66, v66, v68
    s_waitcnt vmcnt(8) lgkmcnt(2)
    v_mfma_f32_32x32x16_bf16 v[96:111], v[84:87], v[252:255], v[96:111]
    buffer_load_dwordx4 v41, s[20:23], s94 offen offset:3072 lds
    v_cvt_pk_bf16_f32 v67, v66, 0
    v_lshlrev_b32 v68, 16, v67
    v_sub_f32 v68, v66, v68
    s_waitcnt lgkmcnt(0)
    v_mfma_f32_32x32x16_bf16 v[112:127], v[88:91], v[252:255], v[112:127]
    s_mov_b32 s97, 0x70000
    s_cmp_eq_u32 s86, 2
    s_cselect_b32 s97, 0xffeb0000, s97
    v_add_u32 v41, s97, v41
    s_add_u32 m0, s62, 32768
    v_cvt_pk_bf16_f32 v66, v66, v68
    v_mov_b32 v68, 0
    v_mov_b32 v69, 0
    v_mfma_f32_32x32x16_bf16 v[96:111], v[62:65], v[54:57], v[96:111]
    s_nop 0
    v_mfma_f32_32x32x16_bf16 v[112:127], v[66:69], v[54:57], v[112:127]
    s_add_u32 s60, s60, 16384
    s_and_b32 s60, s60, 0xffff
    s_barrier
    buffer_load_dwordx4 v41, s[20:23], 0 offen offset:0 lds
    s_nop 5
    v_pk_mul_f32 v[80:81], v[96:97], v[96:97]
    v_pk_mul_f32 v[82:83], v[98:99], v[98:99]
    v_pk_mul_f32 v[84:85], v[100:101], v[100:101]
    v_pk_mul_f32 v[86:87], v[102:103], v[102:103]
    v_pk_mul_f32 v[88:89], v[104:105], v[104:105]
    v_pk_mul_f32 v[90:91], v[106:107], v[106:107]
    v_pk_mul_f32 v[92:93], v[108:109], v[108:109]
    v_pk_mul_f32 v[94:95], v[110:111], v[110:111]
    buffer_load_dwordx4 v41, s[20:23], s92 offen offset:1024 lds
    v_pk_fma_f32 v[80:81], v[80:81], v[58:59], v[58:59] op_sel:[0,1,0] op_sel_hi:[1,1,0]
    v_pk_fma_f32 v[82:83], v[82:83], v[58:59], v[58:59] op_sel:[0,1,0] op_sel_hi:[1,1,0]
    v_pk_fma_f32 v[84:85], v[84:85], v[58:59], v[58:59] op_sel:[0,1,0] op_sel_hi:[1,1,0]
    v_pk_fma_f32 v[86:87], v[86:87], v[58:59], v[58:59] op_sel:[0,1,0] op_sel_hi:[1,1,0]
    v_pk_fma_f32 v[88:89], v[88:89], v[58:59], v[58:59] op_sel:[0,1,0] op_sel_hi:[1,1,0]
    v_pk_fma_f32 v[90:91], v[90:91], v[58:59], v[58:59] op_sel:[0,1,0] op_sel_hi:[1,1,0]
    v_pk_fma_f32 v[92:93], v[92:93], v[58:59], v[58:59] op_sel:[0,1,0] op_sel_hi:[1,1,0]
    v_pk_fma_f32 v[94:95], v[94:95], v[58:59], v[58:59] op_sel:[0,1,0] op_sel_hi:[1,1,0]
    v_pk_mul_f32 v[80:81], v[80:81], v[96:97]
    v_pk_mul_f32 v[82:83], v[82:83], v[98:99]
    v_pk_mul_f32 v[84:85], v[84:85], v[100:101]
    v_pk_mul_f32 v[86:87], v[86:87], v[102:103]
    v_pk_mul_f32 v[88:89], v[88:89], v[104:105]
    v_pk_mul_f32 v[90:91], v[90:91], v[106:107]
    v_pk_mul_f32 v[92:93], v[92:93], v[108:109]
    v_pk_mul_f32 v[94:95], v[94:95], v[110:111]
    buffer_load_dwordx4 v41, s[20:23], s93 offen offset:2048 lds
    v_exp_f32 v80, v80
    v_exp_f32 v81, v81
    v_exp_f32 v82, v82
    v_exp_f32 v83, v83
    v_exp_f32 v84, v84
    v_exp_f32 v85, v85
    v_exp_f32 v86, v86
    v_exp_f32 v87, v87
    buffer_load_dwordx4 v41, s[20:23], s94 offen offset:3072 lds
    v_exp_f32 v88, v88
    v_exp_f32 v89, v89
    v_exp_f32 v90, v90
    v_exp_f32 v91, v91
    v_exp_f32 v92, v92
    v_exp_f32 v93, v93
    v_exp_f32 v94, v94
    v_exp_f32 v95, v95
    s_add_u32 m0, s62, 81920
    s_mov_b32 s92, 15360
    s_mov_b32 s93, 63488
    s_mov_b32 s94, 78848
    buffer_load_dwordx4 v34, s[24:27], 0 offen offset:0 lds
    v_pk_add_f32 v[80:81], v[80:81], 1.0 op_sel_hi:[1,0]
    v_pk_add_f32 v[82:83], v[82:83], 1.0 op_sel_hi:[1,0]
    v_pk_add_f32 v[84:85], v[84:85], 1.0 op_sel_hi:[1,0]
    v_pk_add_f32 v[86:87], v[86:87], 1.0 op_sel_hi:[1,0]
    v_pk_add_f32 v[88:89], v[88:89], 1.0 op_sel_hi:[1,0]
    v_pk_add_f32 v[90:91], v[90:91], 1.0 op_sel_hi:[1,0]
    v_pk_add_f32 v[92:93], v[92:93], 1.0 op_sel_hi:[1,0]
    v_pk_add_f32 v[94:95], v[94:95], 1.0 op_sel_hi:[1,0]
    v_rcp_f32 v80, v80
    v_rcp_f32 v81, v81
    v_rcp_f32 v82, v82
    v_rcp_f32 v83, v83
    buffer_load_dwordx4 v35, s[24:27], s92 offen offset:1024 lds
    v_rcp_f32 v84, v84
    v_rcp_f32 v85, v85
    v_rcp_f32 v86, v86
    v_rcp_f32 v87, v87
    v_rcp_f32 v88, v88
    v_rcp_f32 v89, v89
    v_rcp_f32 v90, v90
    v_rcp_f32 v91, v91
    buffer_load_dwordx4 v34, s[24:27], s93 offen offset:2048 lds
    v_rcp_f32 v92, v92
    v_rcp_f32 v93, v93
    v_rcp_f32 v94, v94
    v_rcp_f32 v95, v95
    v_pk_mul_f32 v[96:97], v[96:97], v[80:81]
    v_pk_mul_f32 v[98:99], v[98:99], v[82:83]
    v_pk_mul_f32 v[100:101], v[100:101], v[84:85]
    v_pk_mul_f32 v[102:103], v[102:103], v[86:87]
    v_pk_mul_f32 v[104:105], v[104:105], v[88:89]
    v_pk_mul_f32 v[106:107], v[106:107], v[90:91]
    v_pk_mul_f32 v[108:109], v[108:109], v[92:93]
    v_pk_mul_f32 v[110:111], v[110:111], v[94:95]
    buffer_load_dwordx4 v35, s[24:27], s94 offen offset:3072 lds
    v_pk_mul_f32 v[80:81], v[112:113], v[112:113]
    v_pk_mul_f32 v[82:83], v[114:115], v[114:115]
    v_pk_mul_f32 v[84:85], v[116:117], v[116:117]
    v_pk_mul_f32 v[86:87], v[118:119], v[118:119]
    v_pk_mul_f32 v[88:89], v[120:121], v[120:121]
    v_pk_mul_f32 v[90:91], v[122:123], v[122:123]
    v_pk_mul_f32 v[92:93], v[124:125], v[124:125]
    v_pk_mul_f32 v[94:95], v[126:127], v[126:127]
    v_add_u32 v34, 128, v34
    v_xor_b32 v35, 64, v34
    s_add_u32 m0, s62, 98304
    s_nop 0
    buffer_load_dwordx4 v34, s[24:27], 0 offen offset:0 lds
    v_pk_fma_f32 v[80:81], v[80:81], v[58:59], v[58:59] op_sel:[0,1,0] op_sel_hi:[1,1,0]
    v_pk_fma_f32 v[82:83], v[82:83], v[58:59], v[58:59] op_sel:[0,1,0] op_sel_hi:[1,1,0]
    v_pk_fma_f32 v[84:85], v[84:85], v[58:59], v[58:59] op_sel:[0,1,0] op_sel_hi:[1,1,0]
    v_pk_fma_f32 v[86:87], v[86:87], v[58:59], v[58:59] op_sel:[0,1,0] op_sel_hi:[1,1,0]
    v_pk_fma_f32 v[88:89], v[88:89], v[58:59], v[58:59] op_sel:[0,1,0] op_sel_hi:[1,1,0]
    v_pk_fma_f32 v[90:91], v[90:91], v[58:59], v[58:59] op_sel:[0,1,0] op_sel_hi:[1,1,0]
    v_pk_fma_f32 v[92:93], v[92:93], v[58:59], v[58:59] op_sel:[0,1,0] op_sel_hi:[1,1,0]
    v_pk_fma_f32 v[94:95], v[94:95], v[58:59], v[58:59] op_sel:[0,1,0] op_sel_hi:[1,1,0]
    v_pk_mul_f32 v[80:81], v[80:81], v[112:113]
    v_pk_mul_f32 v[82:83], v[82:83], v[114:115]
    v_pk_mul_f32 v[84:85], v[84:85], v[116:117]
    v_pk_mul_f32 v[86:87], v[86:87], v[118:119]
    v_pk_mul_f32 v[88:89], v[88:89], v[120:121]
    v_pk_mul_f32 v[90:91], v[90:91], v[122:123]
    v_pk_mul_f32 v[92:93], v[92:93], v[124:125]
    v_pk_mul_f32 v[94:95], v[94:95], v[126:127]
    buffer_load_dwordx4 v35, s[24:27], s92 offen offset:1024 lds
    v_exp_f32 v80, v80
    v_exp_f32 v81, v81
    v_exp_f32 v82, v82
    v_exp_f32 v83, v83
    v_exp_f32 v84, v84
    v_exp_f32 v85, v85
    v_exp_f32 v86, v86
    v_exp_f32 v87, v87
    buffer_load_dwordx4 v34, s[24:27], s93 offen offset:2048 lds
    v_exp_f32 v88, v88
    v_exp_f32 v89, v89
    v_exp_f32 v90, v90
    v_exp_f32 v91, v91
    v_exp_f32 v92, v92
    v_exp_f32 v93, v93
    v_exp_f32 v94, v94
    v_exp_f32 v95, v95
    buffer_load_dwordx4 v35, s[24:27], s94 offen offset:3072 lds
    v_pk_add_f32 v[80:81], v[80:81], 1.0 op_sel_hi:[1,0]
    v_pk_add_f32 v[82:83], v[82:83], 1.0 op_sel_hi:[1,0]
    v_pk_add_f32 v[84:85], v[84:85], 1.0 op_sel_hi:[1,0]
    v_pk_add_f32 v[86:87], v[86:87], 1.0 op_sel_hi:[1,0]
    v_pk_add_f32 v[88:89], v[88:89], 1.0 op_sel_hi:[1,0]
    v_pk_add_f32 v[90:91], v[90:91], 1.0 op_sel_hi:[1,0]
    v_pk_add_f32 v[92:93], v[92:93], 1.0 op_sel_hi:[1,0]
    v_pk_add_f32 v[94:95], v[94:95], 1.0 op_sel_hi:[1,0]
    v_rcp_f32 v80, v80
    v_rcp_f32 v81, v81
    v_rcp_f32 v82, v82
    v_rcp_f32 v83, v83
    v_add_u32 v34, 128, v34
    v_xor_b32 v35, 64, v34
    s_add_u32 m0, s62, 114688
    s_nop 0
    buffer_load_dwordx4 v34, s[24:27], 0 offen offset:0 lds
    v_rcp_f32 v84, v84
    v_rcp_f32 v85, v85
    v_rcp_f32 v86, v86
    v_rcp_f32 v87, v87
    v_rcp_f32 v88, v88
    v_rcp_f32 v89, v89
    v_rcp_f32 v90, v90
    v_rcp_f32 v91, v91
    buffer_load_dwordx4 v35, s[24:27], s92 offen offset:1024 lds
    v_rcp_f32 v92, v92
    v_rcp_f32 v93, v93
    v_rcp_f32 v94, v94
    v_rcp_f32 v95, v95
    v_pk_mul_f32 v[112:113], v[112:113], v[80:81]
    v_pk_mul_f32 v[114:115], v[114:115], v[82:83]
    v_pk_mul_f32 v[116:117], v[116:117], v[84:85]
    v_pk_mul_f32 v[118:119], v[118:119], v[86:87]
    v_pk_mul_f32 v[120:121], v[120:121], v[88:89]
    v_pk_mul_f32 v[122:123], v[122:123], v[90:91]
    v_pk_mul_f32 v[124:125], v[124:125], v[92:93]
    v_pk_mul_f32 v[126:127], v[126:127], v[94:95]
    v_pk_add_f32 v[80:81], v[96:97], v[98:99]
    v_pk_mul_f32 v[82:83], v[96:97], v[96:97]
    v_pk_fma_f32 v[82:83], v[98:99], v[98:99], v[82:83]
    v_pk_add_f32 v[80:81], v[80:81], v[100:101]
    v_pk_fma_f32 v[82:83], v[100:101], v[100:101], v[82:83]
    v_pk_add_f32 v[80:81], v[80:81], v[102:103]
    v_pk_fma_f32 v[82:83], v[102:103], v[102:103], v[82:83]
    v_pk_add_f32 v[80:81], v[80:81], v[104:105]
    v_pk_fma_f32 v[82:83], v[104:105], v[104:105], v[82:83]
    v_pk_add_f32 v[80:81], v[80:81], v[106:107]
    v_pk_fma_f32 v[82:83], v[106:107], v[106:107], v[82:83]
    v_pk_add_f32 v[80:81], v[80:81], v[108:109]
    v_pk_fma_f32 v[82:83], v[108:109], v[108:109], v[82:83]
    v_pk_add_f32 v[80:81], v[80:81], v[110:111]
    v_pk_fma_f32 v[82:83], v[110:111], v[110:111], v[82:83]
    v_pk_add_f32 v[80:81], v[80:81], v[112:113]
    v_pk_fma_f32 v[82:83], v[112:113], v[112:113], v[82:83]
    v_pk_add_f32 v[80:81], v[80:81], v[114:115]
    v_pk_fma_f32 v[82:83], v[114:115], v[114:115], v[82:83]
    v_pk_add_f32 v[80:81], v[80:81], v[116:117]
    v_pk_fma_f32 v[82:83], v[116:117], v[116:117], v[82:83]
    v_pk_add_f32 v[80:81], v[80:81], v[118:119]
    v_pk_fma_f32 v[82:83], v[118:119], v[118:119], v[82:83]
    v_pk_add_f32 v[80:81], v[80:81], v[120:121]
    v_pk_fma_f32 v[82:83], v[120:121], v[120:121], v[82:83]
    v_pk_add_f32 v[80:81], v[80:81], v[122:123]
    v_pk_fma_f32 v[82:83], v[122:123], v[122:123], v[82:83]
    v_pk_add_f32 v[80:81], v[80:81], v[124:125]
    v_pk_fma_f32 v[82:83], v[124:125], v[124:125], v[82:83]
    v_pk_add_f32 v[80:81], v[80:81], v[126:127]
    v_pk_fma_f32 v[82:83], v[126:127], v[126:127], v[82:83]
    v_add_f32 v80, v80, v81
    v_add_f32 v82, v82, v83
    s_nop 1
    v_permlane32_swap_b32 v80, v82
    v_add_f32 v80, v80, v82
    buffer_store_dword v80, v42, s[40:43], 0 offen
    s_waitcnt vmcnt(7)
    v_add_u32 v30, 0x14000, v30
    v_add_u32 v31, 0x14000, v31
    v_add_u32 v32, 0x14000, v32
    v_add_u32 v33, 0x14000, v33
    ds_read_b128 a[128:131], v30 offset:0
    buffer_load_dwordx4 v34, s[24:27], s93 offen offset:2048 lds
    ds_read_b128 a[132:135], v31 offset:0
    buffer_load_dwordx4 v35, s[24:27], s94 offen offset:3072 lds
    v_mov_b32 v38, v48
    v_cmp_gt_u32 vcc, 32, v0
    s_nop 1
    v_cndmask_b32 v38, v39, v38, vcc
    s_and_b32 s88, s48, 14
    s_lshl_b32 s88, s88, 11
    s_lshl_b32 s91, s51, 11
    s_add_u32 s88, s88, s91
    s_lshl_b32 s91, s99, 10
    s_add_u32 s88, s88, s91
    s_lshl_b32 s91, s52, 9
    s_add_u32 s88, s88, s91
    s_add_u32 s88, s88, 73728
    v_and_b32 v1, 3, v0
    v_lshl_add_u32 v62, v1, 7, s88
    s_lshl_b32 s90, s50, 4
    s_add_u32 s90, s90, s48
    s_lshl_b32 s88, s90, 7
    s_lshl2_add_u32 s88, s44, s88
    s_add_u32 s88, s88, 40960
    v_mov_b32 v49, s88
    s_lshl_b32 s88, s48, 11
    s_lshl_b32 s91, s50, 7
    s_add_u32 s88, s88, s91
    s_add_u32 s88, s88, 73728
    v_lshl_add_u32 v42, v0, 2, s88
    v_lshl_or_b32 v37, s44, 6, v0
    v_cmp_gt_u32 vcc, 32, v37
    s_nop 1
    v_cndmask_b32 v42, v39, v42, vcc
    s_lshl_b32 s59, s48, 18
    s_lshl_b32 s91, s95, 12
    s_add_u32 s59, s59, s91
    s_add_u32 s59, s59, 8388608
    buffer_load_dwordx4 v[80:83], v48, s[40:43], 0 offen offset:0 sc1
    buffer_load_dwordx4 v[84:87], v48, s[40:43], 0 offen offset:512 sc1
    buffer_load_dwordx4 v[88:91], v48, s[40:43], 0 offen offset:1024 sc1
    buffer_load_dwordx4 v[92:95], v38, s[40:43], 0 offen offset:1536 sc1
    ds_read_b128 a[136:139], v32 offset:0
    v_add_u32 v34, 128, v34
    v_xor_b32 v35, 64, v34
    s_add_u32 m0, s62, 131072
    s_nop 0
    buffer_load_dwordx4 v34, s[24:27], 0 offen offset:0 lds
    ds_read_b128 a[140:143], v33 offset:0
    buffer_load_dwordx4 v35, s[24:27], s92 offen offset:1024 lds
    s_waitcnt vmcnt(11)
    ds_read_b128 a[144:147], v30 offset:16384
    buffer_load_dwordx4 v34, s[24:27], s93 offen offset:2048 lds
    ds_read_b128 a[148:151], v31 offset:16384
    buffer_load_dwordx4 v35, s[24:27], s94 offen offset:3072 lds
    ds_read_b128 a[152:155], v32 offset:16384
    v_add_u32 v34, 128, v34
    v_xor_b32 v35, 64, v34
    s_add_u32 m0, s62, 65536
    s_nop 0
    buffer_load_dwordx4 v34, s[24:27], 0 offen offset:0 lds
    ds_read_b128 a[156:159], v33 offset:16384
    buffer_load_dwordx4 v35, s[24:27], s92 offen offset:1024 lds
    s_mov_b32 s61, 0
    s_branch L_got_20
L_again_21:
    buffer_load_dwordx4 v[80:83], v48, s[40:43], 0 offen offset:0 sc1
    buffer_load_dwordx4 v[84:87], v48, s[40:43], 0 offen offset:512 sc1
    buffer_load_dwordx4 v[88:91], v48, s[40:43], 0 offen offset:1024 sc1
    buffer_load_dwordx4 v[92:95], v38, s[40:43], 0 offen offset:1536 sc1
    s_addk_i32 s61, 1
    s_cmp_gt_u32 s61, 0x80000
    s_cbranch_scc1 L_abort
    s_waitcnt vmcnt(0)
L_got_20:
    s_waitcnt vmcnt(6)
    v_pk_add_f32 v[80:81], v[80:81], v[82:83]
    v_pk_add_f32 v[84:85], v[84:85], v[86:87]
    v_pk_add_f32 v[88:89], v[88:89], v[90:91]
    v_pk_add_f32 v[92:93], v[92:93], v[94:95]
    v_pk_add_f32 v[80:81], v[80:81], v[92:93]
    v_pk_add_f32 v[84:85], v[84:85], v[88:89]
    v_pk_add_f32 v[80:81], v[80:81], v[84:85]
    v_cmp_u_f32 vcc, v80, v81
    s_cbranch_vccnz L_again_21
    v_permlane32_swap_b32 v80, v81
    v_add_f32 v80, v80, v81
    v_mov_b32 v81, v80
    ds_read_b128 a[160:163], v30 offset:32768
    buffer_load_dwordx4 v34, s[24:27], s93 offen offset:2048 lds
    v_permlane32_swap_b32 v80, v81
    v_mul_f32 v80, 0x3a924925, v80
    v_mul_f32 v37, v80, v80
    v_fmamk_f32 v81, v81, 0xba924925, v37
    v_min_f32 v81, 0, v81
    v_sub_f32 v81, v60, v81
    v_rsq_f32 v81, v81
    ds_read_b128 a[164:167], v31 offset:32768
    buffer_load_dwordx4 v35, s[24:27], s94 offen offset:3072 lds
    v_mul_f32 v80, v80, v81
    v_pk_fma_f32 v[96:97], v[96:97], v[80:81], v[80:81] op_sel:[0,1,0] op_sel_hi:[1,1,0] neg_lo:[0,0,1] neg_hi:[0,0,1]
    v_pk_fma_f32 v[98:99], v[98:99], v[80:81], v[80:81] op_sel:[0,1,0] op_sel_hi:[1,1,0] neg_lo:[0,0,1] neg_hi:[0,0,1]
    v_pk_fma_f32 v[100:101], v[100:101], v[80:81], v[80:81] op_sel:[0,1,0] op_sel_hi:[1,1,0] neg_lo:[0,0,1] neg_hi:[0,0,1]
    v_pk_fma_f32 v[102:103], v[102:103], v[80:81], v[80:81] op_sel:[0,1,0] op_sel_hi:[1,1,0] neg_lo:[0,0,1] neg_hi:[0,0,1]
    v_pk_fma_f32 v[104:105], v[104:105], v[80:81], v[80:81] op_sel:[0,1,0] op_sel_hi:[1,1,0] neg_lo:[0,0,1] neg_hi:[0,0,1]
    v_pk_fma_f32 v[106:107], v[106:107], v[80:81], v[80:81] op_sel:[0,1,0] op_sel_hi:[1,1,0] neg_lo:[0,0,1] neg_hi:[0,0,1]
    v_pk_fma_f32 v[108:109], v[108:109], v[80:81], v[80:81] op_sel:[0,1,0] op_sel_hi:[1,1,0] neg_lo:[0,0,1] neg_hi:[0,0,1]
    v_pk_fma_f32 v[110:111], v[110:111], v[80:81], v[80:81] op_sel:[0,1,0] op_sel_hi:[1,1,0] neg_lo:[0,0,1] neg_hi:[0,0,1]
    v_pk_fma_f32 v[112:113], v[112:113], v[80:81], v[80:81] op_sel:[0,1,0] op_sel_hi:[1,1,0] neg_lo:[0,0,1] neg_hi:[0,0,1]
    v_pk_fma_f32 v[114:115], v[114:115], v[80:81], v[80:81] op_sel:[0,1,0] op_sel_hi:[1,1,0] neg_lo:[0,0,1] neg_hi:[0,0,1]
    v_pk_fma_f32 v[116:117], v[116:117], v[80:81], v[80:81] op_sel:[0,1,0] op_sel_hi:[1,1,0] neg_lo:[0,0,1] neg_hi:[0,0,1]
    v_pk_fma_f32 v[118:119], v[118:119], v[80:81], v[80:81] op_sel:[0,1,0] op_sel_hi:[1,1,0] neg_lo:[0,0,1] neg_hi:[0,0,1]
    v_pk_fma_f32 v[120:121], v[120:121], v[80:81], v[80:81] op_sel:[0,1,0] op_sel_hi:[1,1,0] neg_lo:[0,0,1] neg_hi:[0,0,1]
    v_pk_fma_f32 v[122:123], v[122:123], v[80:81], v[80:81] op_sel:[0,1,0] op_sel_hi:[1,1,0] neg_lo:[0,0,1] neg_hi:[0,0,1]
    v_pk_fma_f32 v[124:125], v[124:125], v[80:81], v[80:81] op_sel:[0,1,0] op_sel_hi:[1,1,0] neg_lo:[0,0,1] neg_hi:[0,0,1]
    v_pk_fma_f32 v[126:127], v[126:127], v[80:81], v[80:81] op_sel:[0,1,0] op_sel_hi:[1,1,0] neg_lo:[0,0,1] neg_hi:[0,0,1]
    v_cvt_pk_bf16_f32 v64, v96, v97
    v_cvt_pk_bf16_f32 v65, v98, v99
    v_cvt_pk_bf16_f32 v66, v100, v101
    v_cvt_pk_bf16_f32 v67, v102, v103
    v_cvt_pk_bf16_f32 v68, v104, v105
    v_cvt_pk_bf16_f32 v69, v106, v107
    v_cvt_pk_bf16_f32 v70, v108, v109
    v_cvt_pk_bf16_f32 v71, v110, v111
    v_mfma_f32_32x32x16_bf16 v[96:111], v[64:67], v[6:9], 0
    ds_read_b128 a[168:171], v32 offset:32768
    s_waitcnt lgkmcnt(7)
    v_add_u32 v34, 128, v34
    v_xor_b32 v35, 64, v34
    s_add_u32 m0, s62, 81920
    s_nop 0
    buffer_load_dwordx4 v34, s[24:27], 0 offen offset:0 lds
    v_mfma_f32_32x32x16_bf16 v[96:111], v[68:71], v[10:13], v[96:111]
    v_cvt_pk_bf16_f32 v72, v112, v113
    v_cvt_pk_bf16_f32 v73, v114, v115
    v_cvt_pk_bf16_f32 v74, v116, v117
    v_cvt_pk_bf16_f32 v75, v118, v119
    v_cvt_pk_bf16_f32 v76, v120, v121
    v_cvt_pk_bf16_f32 v77, v122, v123
    v_cvt_pk_bf16_f32 v78, v124, v125
    v_cvt_pk_bf16_f32 v79, v126, v127
    v_mfma_f32_32x32x16_bf16 v[112:127], v[72:75], v[6:9], 0
    ds_read_b128 a[172:175], v33 offset:32768
    buffer_load_dwordx4 v35, s[24:27], s92 offen offset:1024 lds
    v_mfma_f32_32x32x16_bf16 v[112:127], v[76:79], v[10:13], v[112:127]
    s_barrier
    v_cvt_pk_bf16_f32 v64, v96, v97
    v_cvt_pk_bf16_f32 v65, v98, v99
    v_cvt_pk_bf16_f32 v66, v100, v101
    v_cvt_pk_bf16_f32 v67, v102, v103
    v_cvt_pk_bf16_f32 v68, v104, v105
    v_cvt_pk_bf16_f32 v69, v106, v107
    v_cvt_pk_bf16_f32 v70, v108, v109
    v_cvt_pk_bf16_f32 v71, v110, v111
    buffer_store_dwordx4 v[64:67], v36, s[40:43], s59 offen offset:0 sc1
    buffer_store_dwordx4 v[68:71], v36, s[40:43], s59 offen offset:2048 sc1
    s_nop 0
    v_cvt_pk_bf16_f32 v72, v112, v113
    v_cvt_pk_bf16_f32 v73, v114, v115
    v_cvt_pk_bf16_f32 v74, v116, v117
    v_cvt_pk_bf16_f32 v75, v118, v119
    v_cvt_pk_bf16_f32 v76, v120, v121
    v_cvt_pk_bf16_f32 v77, v122, v123
    v_cvt_pk_bf16_f32 v78, v124, v125
    v_cvt_pk_bf16_f32 v79, v126, v127
    buffer_store_dwordx4 v[72:75], v36, s[40:43], s59 offen offset:1024 sc1
    buffer_store_dwordx4 v[76:79], v36, s[40:43], s59 offen offset:3072 sc1
    s_nop 0
    s_add_u32 s97, s60, 0
    v_add_u32 v52, s97, v43
    v_xor_b32 v53, 64, v52
    ds_read_b64_tr_b16 v[76:77], v52 offset:0
    ds_read_b64_tr_b16 v[78:79], v52 offset:2048
    ds_read_b64_tr_b16 v[80:81], v53 offset:0
    ds_read_b64_tr_b16 v[82:83], v53 offset:2048
    ds_read_b64_tr_b16 v[84:85], v52 offset:1024
    ds_read_b64_tr_b16 v[86:87], v52 offset:3072
    ds_read_b64_tr_b16 v[88:89], v53 offset:1024
    ds_read_b64_tr_b16 v[90:91], v53 offset:3072
    s_waitcnt lgkmcnt(6)
    v_mfma_f32_32x32x16_bf16 v[96:111], v[76:79], v[128:131], 0
    s_branch L_page5
    .p2align 12
L_pad5:
    s_setpc_b64 s[0:1]
    s_nop 0
L_page5:
    s_waitcnt vmcnt(10)
    ds_read_b128 a[176:179], v30 offset:49152
    buffer_load_dwordx4 v34, s[24:27], s93 offen offset:2048 lds
    ds_read_b64_tr_b16 v[92:93], v52 offset:4096
    ds_read_b64_tr_b16 v[94:95], v52 offset:6144
    v_mfma_f32_16x16x32_bf16 v[6:9], v[14:17], v[76:79], 0
    s_waitcnt lgkmcnt(7)
    v_mfma_f32_32x32x16_bf16 v[112:127], v[80:83], v[128:131], 0
    ds_read_b128 a[180:183], v31 offset:49152
    buffer_load_dwordx4 v35, s[24:27], s94 offen offset:3072 lds
    ds_read_b64_tr_b16 v[76:77], v53 offset:4096
    ds_read_b64_tr_b16 v[78:79], v53 offset:6144
    v_mfma_f32_16x16x32_bf16 v[10:13], v[14:17], v[80:83], 0
    v_add_u32 v34, 128, v34
    v_xor_b32 v35, 64, v34
    s_add_u32 m0, s62, 98304
    s_waitcnt lgkmcnt(8)
    v_mfma_f32_32x32x16_bf16 v[96:111], v[84:87], v[132:135], v[96:111]
    ds_read_b128 a[184:187], v32 offset:49152
    buffer_load_dwordx4 v34, s[24:27], 0 offen offset:0 lds
    ds_read_b64_tr_b16 v[80:81], v52 offset:5120
    ds_read_b64_tr_b16 v[82:83], v52 offset:7168
    v_mfma_f32_16x16x32_bf16 v[6:9], v[14:17], v[84:87], v[6:9]
    s_waitcnt lgkmcnt(9)
    v_mfma_f32_32x32x16_bf16 v[112:127], v[88:91], v[132:135], v[112:127]
    ds_read_b128 a[188:191], v33 offset:49152
    buffer_load_dwordx4 v35, s[24:27], s92 offen offset:1024 lds
    ds_read_b64_tr_b16 v[84:85], v53 offset:5120
    ds_read_b64_tr_b16 v[86:87], v53 offset:7168
    v_mfma_f32_16x16x32_bf16 v[10:13], v[14:17], v[88:91], v[10:13]
    s_waitcnt lgkmcnt(9)
    v_mfma_f32_32x32x16_bf16 v[96:111], v[92:95], v[136:139], v[96:111]
    s_waitcnt vmcnt(10)
    v_add_u32 v30, 0xffffc000, v30
    v_add_u32 v31, 0xffffc000, v31
    v_add_u32 v32, 0xffffc000, v32
    v_add_u32 v33, 0xffffc000, v33
    ds_read_b128 a[192:195], v30 offset:0
    buffer_load_dwordx4 v34, s[24:27], s93 offen offset:2048 lds
    ds_read_b64_tr_b16 v[88:89], v52 offset:8192
    ds_read_b64_tr_b16 v[90:91], v52 offset:10240
    v_mfma_f32_16x16x32_bf16 v[6:9], v[14:17], v[92:95], v[6:9]
    s_waitcnt lgkmcnt(9)
    v_mfma_f32_32x32x16_bf16 v[112:127], v[76:79], v[136:139], v[112:127]
    ds_read_b128 a[196:199], v31 offset:0
    buffer_load_dwordx4 v35, s[24:27], s94 offen offset:3072 lds
    ds_read_b64_tr_b16 v[92:93], v53 offset:8192
    ds_read_b64_tr_b16 v[94:95], v53 offset:10240
    v_mfma_f32_16x16x32_bf16 v[10:13], v[14:17], v[76:79], v[10:13]
    v_add_u32 v34, 128, v34
    v_xor_b32 v35, 64, v34
    s_add_u32 m0, s62, 114688
    s_waitcnt lgkmcnt(9)
    v_mfma_f32_32x32x16_bf16 v[96:111], v[80:83], v[140:143], v[96:111]
    ds_read_b128 a[200:203], v32 offset:0
    buffer_load_dwordx4 v34, s[24:27], 0 offen offset:0 lds
    ds_read_b64_tr_b16 v[76:77], v52 offset:9216
    ds_read_b64_tr_b16 v[78:79], v52 offset:11264
    v_mfma_f32_16x16x32_bf16 v[6:9], v[14:17], v[80:83], v[6:9]
    s_waitcnt lgkmcnt(9)
    v_mfma_f32_32x32x16_bf16 v[112:127], v[84:87], v[140:143], v[112:127]
    ds_read_b64_tr_b16 v[80:81], v53 offset:9216
    ds_read_b64_tr_b16 v[82:83], v53 offset:11264
    v_mfma_f32_16x16x32_bf16 v[10:13], v[14:17], v[84:87], v[10:13]
    s_waitcnt lgkmcnt(8)
    v_mfma_f32_32x32x16_bf16 v[96:111], v[88:91], v[144:147], v[96:111]
    ds_read_b64_tr_b16 v[84:85], v52 offset:12288
    ds_read_b64_tr_b16 v[86:87], v52 offset:14336
    v_mfma_f32_16x16x32_bf16 v[6:9], v[14:17], v[88:91], v[6:9]
    s_waitcnt lgkmcnt(7)
    v_mfma_f32_32x32x16_bf16 v[112:127], v[92:95], v[144:147], v[112:127]
    ds_read_b64_tr_b16 v[88:89], v53 offset:12288
    ds_read_b64_tr_b16 v[90:91], v53 offset:14336
    v_mfma_f32_16x16x32_bf16 v[10:13], v[14:17], v[92:95], v[10:13]
    s_waitcnt lgkmcnt(6)
    v_mfma_f32_32x32x16_bf16 v[96:111], v[76:79], v[148:151], v[96:111]
    ds_read_b64_tr_b16 v[92:93], v52 offset:13312
    ds_read_b64_tr_b16 v[94:95], v52 offset:15360
    v_mfma_f32_16x16x32_bf16 v[6:9], v[14:17], v[76:79], v[6:9]
    s_waitcnt lgkmcnt(6)
    v_mfma_f32_32x32x16_bf16 v[112:127], v[80:83], v[148:151], v[112:127]
    ds_read_b64_tr_b16 v[76:77], v53 offset:13312
    ds_read_b64_tr_b16 v[78:79], v53 offset:15360
    v_mfma_f32_16x16x32_bf16 v[10:13], v[14:17], v[80:83], v[10:13]
    s_waitcnt lgkmcnt(6)
    v_mfma_f32_32x32x16_bf16 v[96:111], v[84:87], v[152:155], v[96:111]
    s_add_u32 s60, s60, 16384
    s_and_b32 s60, s60, 0xffff
    s_add_u32 s97, s60, 0
    v_add_u32 v52, s97, v43
    v_xor_b32 v53, 64, v52
    ds_read_b64_tr_b16 v[80:81], v52 offset:0
    ds_read_b64_tr_b16 v[82:83], v52 offset:2048
    v_mfma_f32_16x16x32_bf16 v[6:9], v[14:17], v[84:87], v[6:9]
    s_waitcnt lgkmcnt(6)
    v_mfma_f32_32x32x16_bf16 v[112:127], v[88:91], v[152:155], v[112:127]
    ds_read_b64_tr_b16 v[84:85], v53 offset:0
    ds_read_b64_tr_b16 v[86:87], v53 offset:2048
    v_mfma_f32_16x16x32_bf16 v[10:13], v[14:17], v[88:91], v[10:13]
    s_waitcnt lgkmcnt(6)
    v_mfma_f32_32x32x16_bf16 v[96:111], v[92:95], v[156:159], v[96:111]
    ds_read_b64_tr_b16 v[88:89], v52 offset:1024
    ds_read_b64_tr_b16 v[90:91], v52 offset:3072
    v_mfma_f32_16x16x32_bf16 v[6:9], v[14:17], v[92:95], v[6:9]
    s_waitcnt lgkmcnt(6)
    v_mfma_f32_32x32x16_bf16 v[112:127], v[76:79], v[156:159], v[112:127]
    ds_read_b64_tr_b16 v[92:93], v53 offset:1024
    ds_read_b64_tr_b16 v[94:95], v53 offset:3072
    v_mfma_f32_16x16x32_bf16 v[10:13], v[14:17], v[76:79], v[10:13]
    s_waitcnt lgkmcnt(6)
    v_mfma_f32_32x32x16_bf16 v[96:111], v[80:83], v[160:163], v[96:111]
    ds_read_b64_tr_b16 v[76:77], v52 offset:4096
    ds_read_b64_tr_b16 v[78:79], v52 offset:6144
    s_lshl_b32 s59, s44, 11
    s_lshl_b32 s9, s48, 18
    s_waitcnt lgkmcnt(6)
    v_mfma_f32_32x32x16_bf16 v[112:127], v[84:87], v[160:163], v[112:127]
    ds_read_b64_tr_b16 v[80:81], v53 offset:4096
    ds_read_b64_tr_b16 v[82:83], v53 offset:6144
    s_lshl_b32 s91, s99, 17
    s_add_u32 s9, s9, s91
    s_waitcnt lgkmcnt(6)
    v_mfma_f32_32x32x16_bf16 v[96:111], v[88:91], v[164:167], v[96:111]
    ds_read_b64_tr_b16 v[84:85], v52 offset:5120
    ds_read_b64_tr_b16 v[86:87], v52 offset:7168
    s_lshl2_add_u32 s97, s44, 155648
    v_add_u32 v38, s97, v36
    s_waitcnt lgkmcnt(6)
    v_mfma_f32_32x32x16_bf16 v[112:127], v[92:95], v[164:167], v[112:127]
    ds_read_b64_tr_b16 v[88:89], v53 offset:5120
    ds_read_b64_tr_b16 v[90:91], v53 offset:7168
    s_add_u32 s9, s9, s59
    s_add_u32 s9, s9, 8388608
    s_waitcnt lgkmcnt(6)
    v_mfma_f32_32x32x16_bf16 v[96:111], v[76:79], v[168:171], v[96:111]
    s_waitcnt vmcnt(7)
    s_barrier
    buffer_store_dword v45, v42, s[40:43], 0 offen sc1
    ds_read_b64_tr_b16 v[92:93], v52 offset:8192
    ds_read_b64_tr_b16 v[94:95], v52 offset:10240
    ds_write_b32 v38, v6 offset:2048
    s_waitcnt lgkmcnt(7)
    v_mfma_f32_32x32x16_bf16 v[112:127], v[80:83], v[168:171], v[112:127]
    ds_read_b64_tr_b16 v[76:77], v53 offset:8192
    ds_read_b64_tr_b16 v[78:79], v53 offset:10240
    ds_write_b32 v38, v10 offset:3072
    s_xor_b32 s8, s9, 262144
    s_waitcnt lgkmcnt(8)
    v_mfma_f32_32x32x16_bf16 v[96:111], v[84:87], v[172:175], v[96:111]
    ds_read_b128 a[204:207], v33 offset:0
    buffer_load_dwordx4 v35, s[24:27], s92 offen offset:1024 lds
    ds_read_b64_tr_b16 v[80:81], v52 offset:9216
    ds_read_b64_tr_b16 v[82:83], v52 offset:11264
    s_waitcnt lgkmcnt(9)
    v_mfma_f32_32x32x16_bf16 v[112:127], v[88:91], v[172:175], v[112:127]
    ds_read_b64_tr_b16 v[84:85], v53 offset:9216
    ds_read_b64_tr_b16 v[86:87], v53 offset:11264
    v_lshlrev_b32 v51, 16, v51
    s_waitcnt lgkmcnt(9)
    v_mfma_f32_32x32x16_bf16 v[96:111], v[92:95], v[176:179], v[96:111]
    s_waitcnt vmcnt(7)
    ds_read_b128 a[208:211], v30 offset:16384
    buffer_load_dwordx4 v34, s[24:27], s93 offen offset:2048 lds
    ds_read_b64_tr_b16 v[88:89], v52 offset:12288
    ds_read_b64_tr_b16 v[90:91], v52 offset:14336
    v_add_u32 v38, 155648, v36
    s_waitcnt lgkmcnt(9)
    v_mfma_f32_32x32x16_bf16 v[112:127], v[76:79], v[176:179], v[112:127]
    ds_read_b64_tr_b16 v[92:93], v53 offset:12288
    ds_read_b64_tr_b16 v[94:95], v53 offset:14336
    s_waitcnt lgkmcnt(7)
    v_mfma_f32_32x32x16_bf16 v[96:111], v[80:83], v[180:183], v[96:111]
    ds_read_b128 a[212:215], v31 offset:16384
    buffer_load_dwordx4 v35, s[24:27], s94 offen offset:3072 lds
    ds_read_b64_tr_b16 v[76:77], v52 offset:13312
    ds_read_b64_tr_b16 v[78:79], v52 offset:15360
    s_waitcnt lgkmcnt(8)
    v_mfma_f32_32x32x16_bf16 v[112:127], v[84:87], v[180:183], v[112:127]
    ds_read_b64_tr_b16 v[80:81], v53 offset:13312
    ds_read_b64_tr_b16 v[82:83], v53 offset:15360
    v_add_u32 v34, 128, v34
    v_xor_b32 v35, 64, v34
    s_add_u32 m0, s62, 131072
    s_waitcnt lgkmcnt(7)
    v_mfma_f32_32x32x16_bf16 v[96:111], v[88:91], v[184:187], v[96:111]
    ds_read_b128 a[216:219], v32 offset:16384
    buffer_load_dwordx4 v34, s[24:27], 0 offen offset:0 lds
    s_add_u32 s60, s60, 16384
    s_and_b32 s60, s60, 0xffff
    s_add_u32 s97, s60, 0
    v_add_u32 v52, s97, v43
    v_xor_b32 v53, 64, v52
    ds_read_b64_tr_b16 v[84:85], v52 offset:0
    ds_read_b64_tr_b16 v[86:87], v52 offset:2048
    s_waitcnt lgkmcnt(8)
    v_mfma_f32_32x32x16_bf16 v[112:127], v[92:95], v[184:187], v[112:127]
    ds_read_b64_tr_b16 v[88:89], v53 offset:0
    ds_read_b64_tr_b16 v[90:91], v53 offset:2048
    s_waitcnt lgkmcnt(7)
    v_mfma_f32_32x32x16_bf16 v[96:111], v[76:79], v[188:191], v[96:111]
    ds_read_b128 a[220:223], v33 offset:16384
    buffer_load_dwordx4 v35, s[24:27], s92 offen offset:1024 lds
    ds_read_b64_tr_b16 v[92:93], v52 offset:1024
    ds_read_b64_tr_b16 v[94:95], v52 offset:3072
    s_waitcnt lgkmcnt(8)
    v_mfma_f32_32x32x16_bf16 v[112:127], v[80:83], v[188:191], v[112:127]
    ds_read_b64_tr_b16 v[76:77], v53 offset:1024
    ds_read_b64_tr_b16 v[78:79], v53 offset:3072
    s_waitcnt lgkmcnt(7)
    v_mfma_f32_32x32x16_bf16 v[96:111], v[84:87], v[192:195], v[96:111]
    s_waitcnt vmcnt(7)
    ds_read_b128 a[224:227], v30 offset:32768
    buffer_load_dwordx4 v34, s[24:27], s93 offen offset:2048 lds
    ds_read_b64_tr_b16 v[80:81], v52 offset:4096
    ds_read_b64_tr_b16 v[82:83], v52 offset:6144
    s_barrier
    s_waitcnt lgkmcnt(8)
    v_mfma_f32_32x32x16_bf16 v[112:127], v[88:91], v[192:195], v[112:127]
    ds_read_b64_tr_b16 v[84:85], v53 offset:4096
    ds_read_b64_tr_b16 v[86:87], v53 offset:6144
    s_waitcnt lgkmcnt(7)
    v_mfma_f32_32x32x16_bf16 v[96:111], v[92:95], v[196:199], v[96:111]
    ds_read_b128 a[228:231], v31 offset:32768
    buffer_load_dwordx4 v35, s[24:27], s94 offen offset:3072 lds
    ds_read_b64_tr_b16 v[88:89], v52 offset:5120
    ds_read_b64_tr_b16 v[90:91], v52 offset:7168
    ds_read_b128 v[6:9], v38 offset:2048
    s_waitcnt lgkmcnt(9)
    v_mfma_f32_32x32x16_bf16 v[112:127], v[76:79], v[196:199], v[112:127]
    ds_read_b64_tr_b16 v[92:93], v53 offset:5120
    ds_read_b64_tr_b16 v[94:95], v53 offset:7168
    ds_read_b128 v[10:13], v38 offset:3072
    v_add_u32 v34, 128, v34
    v_xor_b32 v35, 64, v34
    s_add_u32 m0, s62, 65536
    s_waitcnt lgkmcnt(9)
    v_mfma_f32_32x32x16_bf16 v[96:111], v[80:83], v[200:203], v[96:111]
    ds_read_b128 a[232:235], v32 offset:32768
    buffer_load_dwordx4 v34, s[24:27], 0 offen offset:0 lds
    ds_read_b64_tr_b16 v[76:77], v52 offset:8192
    ds_read_b64_tr_b16 v[78:79], v52 offset:10240
    s_waitcnt lgkmcnt(10)
    v_mfma_f32_32x32x16_bf16 v[112:127], v[84:87], v[200:203], v[112:127]
    ds_read_b64_tr_b16 v[80:81], v53 offset:8192
    ds_read_b64_tr_b16 v[82:83], v53 offset:10240
    s_waitcnt lgkmcnt(9)
    v_mfma_f32_32x32x16_bf16 v[96:111], v[88:91], v[204:207], v[96:111]
    ds_read_b128 a[236:239], v33 offset:32768
    buffer_load_dwordx4 v35, s[24:27], s92 offen offset:1024 lds
    ds_read_b64_tr_b16 v[84:85], v52 offset:9216
    ds_read_b64_tr_b16 v[86:87], v52 offset:11264
    s_waitcnt lgkmcnt(9)
    v_mfma_f32_32x32x16_bf16 v[112:127], v[92:95], v[204:207], v[112:127]
    ds_read_b64_tr_b16 v[88:89], v53 offset:9216
    ds_read_b64_tr_b16 v[90:91], v53 offset:11264
    s_waitcnt lgkmcnt(7)
    v_mfma_f32_32x32x16_bf16 v[96:111], v[76:79], v[208:211], v[96:111]
    s_waitcnt vmcnt(6)
    ds_read_b128 a[240:243], v30 offset:49152
    buffer_load_dwordx4 v34, s[24:27], s93 offen offset:2048 lds
    ds_read_b64_tr_b16 v[92:93], v52 offset:12288
    ds_read_b64_tr_b16 v[94:95], v52 offset:14336
    s_waitcnt lgkmcnt(8)
    v_mfma_f32_32x32x16_bf16 v[112:127], v[80:83], v[208:211], v[112:127]
    ds_read_b64_tr_b16 v[76:77], v53 offset:12288
    ds_read_b64_tr_b16 v[78:79], v53 offset:14336
    s_waitcnt lgkmcnt(7)
    v_mfma_f32_32x32x16_bf16 v[96:111], v[84:87], v[212:215], v[96:111]
    buffer_load_dword v47, v62, s[40:43], 0 offen sc1
    ds_read_b64_tr_b16 v[80:81], v52 offset:13312
    ds_read_b64_tr_b16 v[82:83], v52 offset:15360
    v_add_f32 v6, v6, v7
    s_waitcnt lgkmcnt(7)
    v_mfma_f32_32x32x16_bf16 v[112:127], v[88:91], v[212:215], v[112:127]
    ds_read_b64_tr_b16 v[84:85], v53 offset:13312
    ds_read_b64_tr_b16 v[86:87], v53 offset:15360
    v_add_f32 v8, v8, v9
    v_add_f32 v6, v6, v8
    s_waitcnt lgkmcnt(6)
    v_mfma_f32_32x32x16_bf16 v[96:111], v[92:95], v[216:219], v[96:111]
    ds_read_b128 a[244:247], v31 offset:49152
    buffer_load_dwordx4 v35, s[24:27], s94 offen offset:3072 lds
    s_add_u32 s60, s60, 16384
    s_and_b32 s60, s60, 0xffff
    s_add_u32 s97, s60, 0
    v_add_u32 v52, s97, v43
    v_xor_b32 v53, 64, v52
    ds_read_b64_tr_b16 v[88:89], v52 offset:0
    ds_read_b64_tr_b16 v[90:91], v52 offset:2048
    s_waitcnt lgkmcnt(7)
    v_mfma_f32_32x32x16_bf16 v[112:127], v[76:79], v[216:219], v[112:127]
    ds_read_b64_tr_b16 v[92:93], v53 offset:0
    ds_read_b64_tr_b16 v[94:95], v53 offset:2048
    v_add_u32 v34, 128, v34
    v_xor_b32 v35, 64, v34
    s_waitcnt lgkmcnt(7)
    v_mfma_f32_32x32x16_bf16 v[96:111], v[80:83], v[220:223], v[96:111]
    ds_read_b128 a[248:251], v32 offset:49152
    ds_read_b128 a[252:255], v33 offset:49152
    ds_read_b64_tr_b16 v[76:77], v52 offset:1024
    ds_read_b64_tr_b16 v[78:79], v52 offset:3072
    s_waitcnt lgkmcnt(9)
    v_mfma_f32_32x32x16_bf16 v[112:127], v[84:87], v[220:223], v[112:127]
    ds_read_b64_tr_b16 v[80:81], v53 offset:1024
    ds_read_b64_tr_b16 v[82:83], v53 offset:3072
    v_cvt_pk_bf16_f32 v7, v6, 0
    v_lshlrev_b32 v8, 16, v7
    s_waitcnt lgkmcnt(8)
    v_mfma_f32_32x32x16_bf16 v[96:111], v[88:91], v[224:227], v[96:111]
    s_waitcnt vmcnt(5)
    v_add_u32 v30, 0x8000, v30
    v_add_u32 v31, 0x8000, v31
    v_add_u32 v32, 0x8000, v32
    v_add_u32 v33, 0x8000, v33
    ds_read_b128 a[0:3], v30 offset:32768
    ds_read_b128 a[4:7], v31 offset:32768
    ds_read_b64_tr_b16 v[84:85], v52 offset:4096
    ds_read_b64_tr_b16 v[86:87], v52 offset:6144
    s_waitcnt lgkmcnt(10)
    v_mfma_f32_32x32x16_bf16 v[112:127], v[92:95], v[224:227], v[112:127]
    ds_read_b64_tr_b16 v[88:89], v53 offset:4096
    ds_read_b64_tr_b16 v[90:91], v53 offset:6144
    v_sub_f32 v8, v6, v8
    v_cvt_pk_bf16_f32 v6, v6, v8
    s_waitcnt lgkmcnt(8)
    v_mfma_f32_32x32x16_bf16 v[96:111], v[76:79], v[228:231], v[96:111]
    ds_read_b128 a[8:11], v32 offset:32768
    ds_read_b128 a[12:15], v33 offset:32768
    ds_read_b64_tr_b16 v[92:93], v52 offset:5120
    ds_read_b64_tr_b16 v[94:95], v52 offset:7168
    s_waitcnt lgkmcnt(10)
    v_mfma_f32_32x32x16_bf16 v[112:127], v[80:83], v[228:231], v[112:127]
    ds_read_b64_tr_b16 v[76:77], v53 offset:5120
    ds_read_b64_tr_b16 v[78:79], v53 offset:7168
    s_add_u32 m0, s62, 131072
    v_mov_b32 v8, 0
    s_waitcnt lgkmcnt(8)
    v_mfma_f32_32x32x16_bf16 v[96:111], v[84:87], v[232:235], v[96:111]
    s_waitcnt lgkmcnt(4)
    buffer_load_dwordx4 v34, s[24:27], 0 offen offset:0 lds
    ds_read_b64_tr_b16 v[80:81], v52 offset:8192
    ds_read_b64_tr_b16 v[82:83], v52 offset:10240
    v_mfma_f32_32x32x16_bf16 v[112:127], v[88:91], v[232:235], v[112:127]
    ds_read_b64_tr_b16 v[84:85], v53 offset:8192
    ds_read_b64_tr_b16 v[86:87], v53 offset:10240
    v_mov_b32 v9, 0
    v_add_f32 v10, v10, v11
    s_waitcnt lgkmcnt(6)
    v_mfma_f32_32x32x16_bf16 v[96:111], v[92:95], v[236:239], v[96:111]
    buffer_load_dwordx4 v35, s[24:27], s92 offen offset:1024 lds
    ds_read_b64_tr_b16 v[88:89], v52 offset:9216
    ds_read_b64_tr_b16 v[90:91], v52 offset:11264
    v_add_f32 v12, v12, v13
    s_waitcnt lgkmcnt(6)
    v_mfma_f32_32x32x16_bf16 v[112:127], v[76:79], v[236:239], v[112:127]
    ds_read_b64_tr_b16 v[92:93], v53 offset:9216
    ds_read_b64_tr_b16 v[94:95], v53 offset:11264
    v_add_f32 v10, v10, v12
    v_cvt_pk_bf16_f32 v11, v10, 0
    s_waitcnt lgkmcnt(6)
    v_mfma_f32_32x32x16_bf16 v[96:111], v[80:83], v[240:243], v[96:111]
    buffer_load_dwordx4 v34, s[24:27], s93 offen offset:2048 lds
    ds_read_b64_tr_b16 v[76:77], v52 offset:12288
    ds_read_b64_tr_b16 v[78:79], v52 offset:14336
    v_lshlrev_b32 v12, 16, v11
    s_waitcnt lgkmcnt(6)
    v_mfma_f32_32x32x16_bf16 v[112:127], v[84:87], v[240:243], v[112:127]
    ds_read_b64_tr_b16 v[80:81], v53 offset:12288
    ds_read_b64_tr_b16 v[82:83], v53 offset:14336
    v_sub_f32 v12, v10, v12
    v_cvt_pk_bf16_f32 v10, v10, v12
    s_waitcnt lgkmcnt(6)
    v_mfma_f32_32x32x16_bf16 v[96:111], v[88:91], v[244:247], v[96:111]
    buffer_load_dwordx4 v35, s[24:27], s94 offen offset:3072 lds
    ds_read_b64_tr_b16 v[84:85], v52 offset:13312
    ds_read_b64_tr_b16 v[86:87], v52 offset:15360
    v_mov_b32 v12, 0
    s_waitcnt lgkmcnt(6)
    v_mfma_f32_32x32x16_bf16 v[112:127], v[92:95], v[244:247], v[112:127]
    ds_read_b64_tr_b16 v[88:89], v53 offset:13312
    ds_read_b64_tr_b16 v[90:91], v53 offset:15360
    v_add_u32 v34, 128, v34
    v_xor_b32 v35, 64, v34
    s_waitcnt lgkmcnt(6)
    v_mfma_f32_32x32x16_bf16 v[96:111], v[76:79], v[248:251], v[96:111]
    s_waitcnt vmcnt(5)
    v_cmp_ne_u32 vcc, s53, v47
    s_cbranch_vccnz L_retry_22
L_got_23:
    s_barrier
    v_mov_b32 v13, 0
    s_waitcnt lgkmcnt(4)
    v_mfma_f32_32x32x16_bf16 v[112:127], v[80:83], v[248:251], v[112:127]
    s_add_u32 m0, s59, 81920
    s_add_u32 s58, s8, 0
    buffer_load_dwordx4 v36, s[40:43], s58 offen offset:0 sc1 lds
    s_waitcnt lgkmcnt(2)
    v_mfma_f32_32x32x16_bf16 v[96:111], v[84:87], v[252:255], v[96:111]
    buffer_load_dwordx4 v36, s[40:43], s58 offen offset:1024 sc1 lds
    s_waitcnt lgkmcnt(0)
    v_mfma_f32_32x32x16_bf16 v[112:127], v[88:91], v[252:255], v[112:127]
    s_add_u32 m0, s59, 90112
    s_add_u32 s58, s8, 8192
    buffer_load_dwordx4 v36, s[40:43], s58 offen offset:0 sc1 lds
    v_mfma_f32_32x32x16_bf16 v[96:111], v[6:9], v[54:57], v[96:111]
    v_mfma_f32_32x32x16_bf16 v[112:127], v[10:13], v[54:57], v[112:127]
    s_add_u32 s60, s60, 16384
    s_and_b32 s60, s60, 0xffff
    s_barrier
    v_add_u32 v6, 81920, v36
    buffer_load_dwordx4 v36, s[40:43], s58 offen offset:1024 sc1 lds
    s_nop 5
    v_pk_mul_f32 v[96:97], v[96:97], v[4:5]
    v_pk_mul_f32 v[98:99], v[98:99], v[4:5]
    v_pk_mul_f32 v[100:101], v[100:101], v[4:5]
    v_pk_mul_f32 v[102:103], v[102:103], v[4:5]
    v_pk_mul_f32 v[104:105], v[104:105], v[4:5]
    v_pk_mul_f32 v[106:107], v[106:107], v[4:5]
    v_pk_mul_f32 v[108:109], v[108:109], v[4:5]
    v_pk_mul_f32 v[110:111], v[110:111], v[4:5]
    v_pk_mul_f32 v[64:65], v[96:97], v[96:97]
    v_pk_mul_f32 v[66:67], v[98:99], v[98:99]
    v_pk_mul_f32 v[68:69], v[100:101], v[100:101]
    v_pk_mul_f32 v[70:71], v[102:103], v[102:103]
    v_pk_mul_f32 v[72:73], v[104:105], v[104:105]
    v_pk_mul_f32 v[74:75], v[106:107], v[106:107]
    v_pk_mul_f32 v[76:77], v[108:109], v[108:109]
    v_pk_mul_f32 v[78:79], v[110:111], v[110:111]
    v_pk_fma_f32 v[64:65], v[64:65], s[12:13], s[12:13] op_sel:[0,1,0] op_sel_hi:[1,1,0]
    v_pk_fma_f32 v[66:67], v[66:67], s[12:13], s[12:13] op_sel:[0,1,0] op_sel_hi:[1,1,0]
    v_pk_fma_f32 v[68:69], v[68:69], s[12:13], s[12:13] op_sel:[0,1,0] op_sel_hi:[1,1,0]
    v_pk_fma_f32 v[70:71], v[70:71], s[12:13], s[12:13] op_sel:[0,1,0] op_sel_hi:[1,1,0]
    v_pk_fma_f32 v[72:73], v[72:73], s[12:13], s[12:13] op_sel:[0,1,0] op_sel_hi:[1,1,0]
    v_pk_fma_f32 v[74:75], v[74:75], s[12:13], s[12:13] op_sel:[0,1,0] op_sel_hi:[1,1,0]
    v_pk_fma_f32 v[76:77], v[76:77], s[12:13], s[12:13] op_sel:[0,1,0] op_sel_hi:[1,1,0]
    v_pk_fma_f32 v[78:79], v[78:79], s[12:13], s[12:13] op_sel:[0,1,0] op_sel_hi:[1,1,0]
    v_pk_mul_f32 v[64:65], v[64:65], v[96:97]
    v_pk_mul_f32 v[66:67], v[66:67], v[98:99]
    v_pk_mul_f32 v[68:69], v[68:69], v[100:101]
    v_pk_mul_f32 v[70:71], v[70:71], v[102:103]
    v_pk_mul_f32 v[72:73], v[72:73], v[104:105]
    v_pk_mul_f32 v[74:75], v[74:75], v[106:107]
    v_pk_mul_f32 v[76:77], v[76:77], v[108:109]
    v_pk_mul_f32 v[78:79], v[78:79], v[110:111]
    s_add_u32 m0, s59, 98304
    s_add_u32 s58, s8, 16384
    buffer_load_dwordx4 v36, s[40:43], s58 offen offset:0 sc1 lds
    v_exp_f32 v64, v64
    v_exp_f32 v65, v65
    v_exp_f32 v66, v66
    v_exp_f32 v67, v67
    v_exp_f32 v68, v68
    v_exp_f32 v69, v69
    v_exp_f32 v70, v70
    v_exp_f32 v71, v71
    s_waitcnt vmcnt(9)
    v_add_u32 v30, 0xfffec000, v30
    v_add_u32 v31, 0xfffec000, v31
    v_add_u32 v32, 0xfffec000, v32
    v_add_u32 v33, 0xfffec000, v33
    ds_read_b128 a[16:19], v30 offset:49152
    s_add_u32 m0, s62, 147456
    s_nop 0
    buffer_load_dwordx4 v34, s[24:27], 0 offen offset:0 lds
    v_exp_f32 v72, v72
    v_exp_f32 v73, v73
    v_exp_f32 v74, v74
    v_exp_f32 v75, v75
    v_exp_f32 v76, v76
    v_exp_f32 v77, v77
    v_exp_f32 v78, v78
    v_exp_f32 v79, v79
    s_add_u32 m0, s59, 98304
    s_nop 0
    buffer_load_dwordx4 v36, s[40:43], s58 offen offset:1024 sc1 lds
    v_pk_add_f32 v[64:65], v[64:65], 1.0 op_sel_hi:[1,0]
    v_pk_add_f32 v[66:67], v[66:67], 1.0 op_sel_hi:[1,0]
    v_pk_add_f32 v[68:69], v[68:69], 1.0 op_sel_hi:[1,0]
    v_pk_add_f32 v[70:71], v[70:71], 1.0 op_sel_hi:[1,0]
    v_pk_add_f32 v[72:73], v[72:73], 1.0 op_sel_hi:[1,0]
    v_pk_add_f32 v[74:75], v[74:75], 1.0 op_sel_hi:[1,0]
    v_pk_add_f32 v[76:77], v[76:77], 1.0 op_sel_hi:[1,0]
    v_pk_add_f32 v[78:79], v[78:79], 1.0 op_sel_hi:[1,0]
    v_rcp_f32 v64, v64
    v_rcp_f32 v65, v65
    v_rcp_f32 v66, v66
    v_rcp_f32 v67, v67
    ds_read_b128 a[20:23], v31 offset:49152
    s_add_u32 m0, s62, 147456
    s_nop 0
    buffer_load_dwordx4 v35, s[24:27], s92 offen offset:1024 lds
    v_rcp_f32 v68, v68
    v_rcp_f32 v69, v69
    v_rcp_f32 v70, v70
    v_rcp_f32 v71, v71
    v_rcp_f32 v72, v72
    v_rcp_f32 v73, v73
    v_rcp_f32 v74, v74
    v_rcp_f32 v75, v75
    s_add_u32 m0, s59, 106496
    s_add_u32 s58, s8, 24576
    buffer_load_dwordx4 v36, s[40:43], s58 offen offset:0 sc1 lds
    v_rcp_f32 v76, v76
    v_rcp_f32 v77, v77
    v_rcp_f32 v78, v78
    v_rcp_f32 v79, v79
    v_pk_mul_f32 v[96:97], v[96:97], v[64:65]
    v_pk_mul_f32 v[98:99], v[98:99], v[66:67]
    v_pk_mul_f32 v[100:101], v[100:101], v[68:69]
    v_pk_mul_f32 v[102:103], v[102:103], v[70:71]
    v_pk_mul_f32 v[104:105], v[104:105], v[72:73]
    v_pk_mul_f32 v[106:107], v[106:107], v[74:75]
    v_pk_mul_f32 v[108:109], v[108:109], v[76:77]
    v_pk_mul_f32 v[110:111], v[110:111], v[78:79]
    ds_read_b128 a[24:27], v32 offset:49152
    s_add_u32 m0, s62, 147456
    s_nop 0
    buffer_load_dwordx4 v34, s[24:27], s93 offen offset:2048 lds
    s_add_u32 m0, s59, 106496
    s_nop 0
    buffer_load_dwordx4 v36, s[40:43], s58 offen offset:1024 sc1 lds
    ds_read_b128 a[28:31], v33 offset:49152
    s_add_u32 m0, s62, 147456
    s_nop 0
    buffer_load_dwordx4 v35, s[24:27], s94 offen offset:3072 lds
    v_mov_b32 v224, v51
    v_mov_b32 v225, v51
    v_mov_b32 v226, v51
    v_mov_b32 v227, v51
    v_mov_b32 v228, v51
    v_mov_b32 v229, v51
    v_mov_b32 v230, v51
    v_mov_b32 v231, v51
    v_mov_b32 v232, v51
    v_mov_b32 v233, v51
    v_mov_b32 v234, v51
    v_mov_b32 v235, v51
    v_mov_b32 v236, v51
    v_mov_b32 v237, v51
    v_mov_b32 v238, v51
    v_mov_b32 v239, v51
    v_mov_b32 v240, v51
    v_mov_b32 v241, v51
    v_mov_b32 v242, v51
    v_mov_b32 v243, v51
    v_mov_b32 v244, v51
    v_mov_b32 v245, v51
    v_mov_b32 v246, v51
    v_mov_b32 v247, v51
    s_waitcnt vmcnt(10)
    s_barrier
    ds_read_b128 v[160:163], v6 offset:0
    ds_read_b128 v[164:167], v6 offset:1024
    ds_read_b128 v[168:171], v6 offset:2048
    ds_read_b128 v[172:175], v6 offset:3072
    ds_read_b128 v[176:179], v6 offset:4096
    ds_read_b128 v[180:183], v6 offset:5120
    ds_read_b128 v[184:187], v6 offset:6144
    ds_read_b128 v[188:191], v6 offset:7168
    s_waitcnt vmcnt(8) lgkmcnt(0)
    s_barrier
    v_mfma_f32_32x32x16_bf16 v[128:143], v[160:163], a[128:131], 0
    ds_read_b128 v[192:195], v6 offset:8192
    ds_read_b128 v[196:199], v6 offset:9216
    v_mov_b32 v248, v51
    v_mov_b32 v249, v51
    v_mfma_f32_32x32x16_bf16 v[144:159], v[164:167], a[128:131], 0
    ds_read_b128 v[200:203], v6 offset:10240
    ds_read_b128 v[204:207], v6 offset:11264
    v_mov_b32 v250, v51
    v_mov_b32 v251, v51
    v_mfma_f32_32x32x16_bf16 v[128:143], v[168:171], a[132:135], v[128:143]
    ds_read_b128 v[208:211], v6 offset:12288
    ds_read_b128 v[212:215], v6 offset:13312
    v_mov_b32 v252, v51
    v_mov_b32 v253, v51
    v_mfma_f32_32x32x16_bf16 v[144:159], v[172:175], a[132:135], v[144:159]
    s_branch L_page6
    .p2align 12
L_pad6:
    s_setpc_b64 s[0:1]
    s_nop 0
L_page6:
    ds_read_b128 v[216:219], v6 offset:14336
    ds_read_b128 v[220:223], v6 offset:15360
    s_add_u32 m0, s59, 114688
    s_add_u32 s58, s8, 32768
    v_mfma_f32_32x32x16_bf16 v[128:143], v[176:179], a[136:139], v[128:143]
    v_add_u32 v30, 0x14000, v30
    v_add_u32 v31, 0x14000, v31
    v_add_u32 v32, 0x14000, v32
    v_add_u32 v33, 0x14000, v33
    ds_read_b128 a[32:35], v30 offset:32768
    ds_read_b128 a[36:39], v31 offset:32768
    buffer_load_dwordx4 v36, s[40:43], s58 offen offset:0 sc1 lds
    v_mfma_f32_32x32x16_bf16 v[144:159], v[180:183], a[136:139], v[144:159]
    ds_read_b128 a[40:43], v32 offset:32768
    ds_read_b128 a[44:47], v33 offset:32768
    buffer_load_dwordx4 v36, s[40:43], s58 offen offset:1024 sc1 lds
    v_add_u32 v34, 128, v34
    v_xor_b32 v35, 64, v34
    s_add_u32 m0, s62, 131072
    v_mfma_f32_32x32x16_bf16 v[128:143], v[184:187], a[140:143], v[128:143]
    s_waitcnt lgkmcnt(0)
    buffer_load_dwordx4 v34, s[24:27], 0 offen offset:0 lds
    s_add_u32 m0, s59, 122880
    s_add_u32 s58, s9, 0
    v_mfma_f32_32x32x16_bf16 v[144:159], v[188:191], a[140:143], v[144:159]
    buffer_load_dwordx4 v36, s[40:43], s58 offen offset:0 sc1 lds
    s_waitcnt vmcnt(9)
    s_barrier
    v_mfma_f32_32x32x16_bf16 v[128:143], v[192:195], a[144:147], v[128:143]
    ds_read_b128 v[160:163], v6 offset:16384
    ds_read_b128 v[164:167], v6 offset:17408
    v_mov_b32 v254, v51
    v_mov_b32 v255, v51
    v_mfma_f32_32x32x16_bf16 v[144:159], v[196:199], a[144:147], v[144:159]
    ds_read_b128 v[168:171], v6 offset:18432
    ds_read_b128 v[172:175], v6 offset:19456
    s_lshl_b32 s88, s95, 7
    s_lshl2_add_u32 s88, s48, s88
    v_mfma_f32_32x32x16_bf16 v[128:143], v[200:203], a[148:151], v[128:143]
    ds_read_b128 v[176:179], v6 offset:20480
    ds_read_b128 v[180:183], v6 offset:21504
    s_add_u32 s88, s88, 32768
    v_cmp_eq_u32 vcc, 0, v0
    v_mfma_f32_32x32x16_bf16 v[144:159], v[204:207], a[148:151], v[144:159]
    ds_read_b128 v[184:187], v6 offset:22528
    ds_read_b128 v[188:191], v6 offset:23552
    v_mov_b32 v38, s88
    v_xor_b32 v37, 128, v49
    v_mfma_f32_32x32x16_bf16 v[128:143], v[208:211], a[152:155], v[128:143]
    buffer_load_dwordx4 v36, s[40:43], s58 offen offset:1024 sc1 lds
    s_add_u32 m0, s59, 81920
    s_add_u32 s58, s9, 8192
    v_cndmask_b32 v62, v39, v38, vcc
    v_mfma_f32_32x32x16_bf16 v[144:159], v[212:215], a[152:155], v[144:159]
    buffer_load_dwordx4 v36, s[40:43], s58 offen offset:0 sc1 lds
    s_add_u32 m0, s62, 131072
    v_cndmask_b32 v37, v39, v37, vcc
    v_xor_b32 v46, 2048, v50
    v_mfma_f32_32x32x16_bf16 v[128:143], v[216:219], a[156:159], v[128:143]
    buffer_load_dwordx4 v35, s[24:27], s92 offen offset:1024 lds
    v_mov_b32 v11, s13
    v_mul_f32 v112, v112, v4
    v_mul_f32 v113, v113, v4
    v_mfma_f32_32x32x16_bf16 v[144:159], v[220:223], a[156:159], v[144:159]
    buffer_load_dwordx4 v34, s[24:27], s93 offen offset:2048 lds
    s_waitcnt vmcnt(9) lgkmcnt(0)
    s_barrier
    v_mfma_f32_32x32x16_bf16 v[128:143], v[160:163], a[160:163], v[128:143]
    ds_read_b128 v[192:195], v6 offset:24576
    ds_read_b128 v[196:199], v6 offset:25600
    v_mul_f32 v114, v114, v4
    v_mul_f32 v115, v115, v4
    v_mfma_f32_32x32x16_bf16 v[144:159], v[164:167], a[160:163], v[144:159]
    ds_read_b128 v[200:203], v6 offset:26624
    ds_read_b128 v[204:207], v6 offset:27648
    v_mul_f32 v7, v112, v112
    v_mul_f32 v8, v113, v113
    v_mfma_f32_32x32x16_bf16 v[128:143], v[168:171], a[164:167], v[128:143]
    ds_read_b128 v[208:211], v6 offset:28672
    ds_read_b128 v[212:215], v6 offset:29696
    v_mul_f32 v9, v114, v114
    v_mul_f32 v10, v115, v115
    v_mfma_f32_32x32x16_bf16 v[144:159], v[172:175], a[164:167], v[144:159]
    ds_read_b128 v[216:219], v6 offset:30720
    ds_read_b128 v[220:223], v6 offset:31744
    s_add_u32 m0, s59, 81920
    v_fmaak_f32 v7, v11, v7, 0xc0135761
    v_mfma_f32_32x32x16_bf16 v[128:143], v[176:179], a[168:171], v[128:143]
    s_waitcnt vmcnt(8)
    ds_read_b128 a[48:51], v30 offset:49152
    ds_read_b128 a[52:55], v31 offset:49152
    buffer_load_dwordx4 v36, s[40:43], s58 offen offset:1024 sc1 lds
    s_add_u32 m0, s59, 90112
    s_add_u32 s58, s9, 16384
    v_mfma_f32_32x32x16_bf16 v[144:159], v[180:183], a[168:171], v[144:159]
    ds_read_b128 a[56:59], v32 offset:49152
    ds_read_b128 a[60:63], v33 offset:49152
    buffer_load_dwordx4 v36, s[40:43], s58 offen offset:0 sc1 lds
    s_add_u32 m0, s62, 131072
    v_mfma_f32_32x32x16_bf16 v[128:143], v[184:187], a[172:175], v[128:143]
    buffer_load_dwordx4 v35, s[24:27], s94 offen offset:3072 lds
    v_fmaak_f32 v8, v11, v8, 0xc0135761
    v_fmaak_f32 v9, v11, v9, 0xc0135761
    v_fmaak_f32 v10, v11, v10, 0xc0135761
    v_mfma_f32_32x32x16_bf16 v[144:159], v[188:191], a[172:175], v[144:159]
    v_mul_f32 v7, v7, v112
    s_waitcnt vmcnt(9) lgkmcnt(0)
    s_barrier
    v_mfma_f32_32x32x16_bf16 v[128:143], v[192:195], a[176:179], v[128:143]
    ds_read_b128 v[160:163], v6 offset:32768
    ds_read_b128 v[164:167], v6 offset:33792
    v_mul_f32 v8, v8, v113
    v_mul_f32 v9, v9, v114
    v_mfma_f32_32x32x16_bf16 v[144:159], v[196:199], a[176:179], v[144:159]
    ds_read_b128 v[168:171], v6 offset:34816
    ds_read_b128 v[172:175], v6 offset:35840
    v_mul_f32 v10, v10, v115
    v_mfma_f32_32x32x16_bf16 v[128:143], v[200:203], a[180:183], v[128:143]
    ds_read_b128 v[176:179], v6 offset:36864
    ds_read_b128 v[180:183], v6 offset:37888
    v_exp_f32 v7, v7
    v_mfma_f32_32x32x16_bf16 v[144:159], v[204:207], a[180:183], v[144:159]
    ds_read_b128 v[184:187], v6 offset:38912
    ds_read_b128 v[188:191], v6 offset:39936
    s_add_u32 m0, s59, 90112
    v_mfma_f32_32x32x16_bf16 v[128:143], v[208:211], a[184:187], v[128:143]
    buffer_load_dwordx4 v36, s[40:43], s58 offen offset:1024 sc1 lds
    s_add_u32 m0, s59, 98304
    s_add_u32 s58, s9, 24576
    v_mfma_f32_32x32x16_bf16 v[144:159], v[212:215], a[184:187], v[144:159]
    buffer_load_dwordx4 v36, s[40:43], s58 offen offset:0 sc1 lds
    v_add_u32 v34, 128, v34
    v_xor_b32 v35, 64, v34
    s_add_u32 m0, s62, 65536
    v_mfma_f32_32x32x16_bf16 v[128:143], v[216:219], a[188:191], v[128:143]
    buffer_load_dwordx4 v34, s[24:27], 0 offen offset:0 lds
    v_exp_f32 v8, v8
    v_mfma_f32_32x32x16_bf16 v[144:159], v[220:223], a[188:191], v[144:159]
    buffer_load_dwordx4 v35, s[24:27], s92 offen offset:1024 lds
    s_waitcnt vmcnt(10) lgkmcnt(0)
    s_barrier
    v_mfma_f32_32x32x16_bf16 v[128:143], v[160:163], a[192:195], v[128:143]
    ds_read_b128 v[192:195], v6 offset:40960
    ds_read_b128 v[196:199], v6 offset:41984
    v_exp_f32 v9, v9
    v_mfma_f32_32x32x16_bf16 v[144:159], v[164:167], a[192:195], v[144:159]
    ds_read_b128 v[200:203], v6 offset:43008
    ds_read_b128 v[204:207], v6 offset:44032
    v_exp_f32 v10, v10
    v_mfma_f32_32x32x16_bf16 v[128:143], v[168:171], a[196:199], v[128:143]
    ds_read_b128 v[208:211], v6 offset:45056
    ds_read_b128 v[212:215], v6 offset:46080
    v_add_f32 v7, 1.0, v7
    v_add_f32 v8, 1.0, v8
    v_mfma_f32_32x32x16_bf16 v[144:159], v[172:175], a[196:199], v[144:159]
    ds_read_b128 v[216:219], v6 offset:47104
    ds_read_b128 v[220:223], v6 offset:48128
    s_add_u32 m0, s59, 98304
    v_add_f32 v9, 1.0, v9
    v_mfma_f32_32x32x16_bf16 v[128:143], v[176:179], a[200:203], v[128:143]
    buffer_load_dwordx4 v36, s[40:43], s58 offen offset:1024 sc1 lds
    s_add_u32 m0, s59, 106496
    s_add_u32 s58, s9, 32768
    v_add_f32 v10, 1.0, v10
    v_mfma_f32_32x32x16_bf16 v[144:159], v[180:183], a[200:203], v[144:159]
    buffer_load_dwordx4 v36, s[40:43], s58 offen offset:0 sc1 lds
    s_add_u32 m0, s62, 65536
    v_rcp_f32 v7, v7
    v_mfma_f32_32x32x16_bf16 v[128:143], v[184:187], a[204:207], v[128:143]
    buffer_load_dwordx4 v34, s[24:27], s93 offen offset:2048 lds
    v_rcp_f32 v8, v8
    v_mfma_f32_32x32x16_bf16 v[144:159], v[188:191], a[204:207], v[144:159]
    s_waitcnt vmcnt(9) lgkmcnt(0)
    s_barrier
    v_mfma_f32_32x32x16_bf16 v[224:239], v[192:195], a[128:131], v[224:239]
    ds_read_b128 v[160:163], v6 offset:0
    ds_read_b128 v[164:167], v6 offset:1024
    v_rcp_f32 v9, v9
    v_mfma_f32_32x32x16_bf16 v[240:255], v[196:199], a[128:131], v[240:255]
    ds_read_b128 v[168:171], v6 offset:2048
    ds_read_b128 v[172:175], v6 offset:3072
    v_rcp_f32 v10, v10
    v_mfma_f32_32x32x16_bf16 v[224:239], v[200:203], a[132:135], v[224:239]
    ds_read_b128 v[176:179], v6 offset:4096
    ds_read_b128 v[180:183], v6 offset:5120
    v_mul_f32 v112, v112, v7
    v_mul_f32 v113, v113, v8
    v_mfma_f32_32x32x16_bf16 v[240:255], v[204:207], a[132:135], v[240:255]
    ds_read_b128 v[184:187], v6 offset:6144
    ds_read_b128 v[188:191], v6 offset:7168
    s_add_u32 m0, s59, 106496
    v_mul_f32 v114, v114, v9
    v_mfma_f32_32x32x16_bf16 v[224:239], v[208:211], a[136:139], v[224:239]
    buffer_load_dwordx4 v36, s[40:43], s58 offen offset:1024 sc1 lds
    s_add_u32 m0, s59, 114688
    s_add_u32 s58, s8, 40960
    v_mul_f32 v115, v115, v10
    v_mfma_f32_32x32x16_bf16 v[240:255], v[212:215], a[136:139], v[240:255]
    s_waitcnt vmcnt(8)
    ds_read_b128 a[64:67], v30 offset:32768
    ds_read_b128 a[68:71], v31 offset:32768
    buffer_load_dwordx4 v36, s[40:43], s58 offen offset:0 sc1 lds
    s_add_u32 m0, s62, 65536
    v_mfma_f32_32x32x16_bf16 v[224:239], v[216:219], a[140:143], v[224:239]
    buffer_load_dwordx4 v35, s[24:27], s94 offen offset:3072 lds
    v_add_u32 v34, 128, v34
    v_xor_b32 v35, 64, v34
    s_add_u32 m0, s62, 49152
    v_mfma_f32_32x32x16_bf16 v[240:255], v[220:223], a[140:143], v[240:255]
    buffer_load_dwordx4 v34, s[24:27], 0 offen offset:0 lds
    s_waitcnt vmcnt(10) lgkmcnt(0)
    s_barrier
    v_mfma_f32_32x32x16_bf16 v[224:239], v[160:163], a[144:147], v[224:239]
    ds_read_b128 v[192:195], v6 offset:8192
    ds_read_b128 v[196:199], v6 offset:9216
    v_mul_f32 v116, v116, v4
    v_mul_f32 v117, v117, v4
    v_mfma_f32_32x32x16_bf16 v[240:255], v[164:167], a[144:147], v[240:255]
    ds_read_b128 v[200:203], v6 offset:10240
    ds_read_b128 v[204:207], v6 offset:11264
    v_mul_f32 v118, v118, v4
    v_mul_f32 v119, v119, v4
    v_mfma_f32_32x32x16_bf16 v[224:239], v[168:171], a[148:151], v[224:239]
    ds_read_b128 v[208:211], v6 offset:12288
    ds_read_b128 v[212:215], v6 offset:13312
    v_mul_f32 v7, v116, v116
    v_mul_f32 v8, v117, v117
    v_mfma_f32_32x32x16_bf16 v[240:255], v[172:175], a[148:151], v[240:255]
    ds_read_b128 v[216:219], v6 offset:14336
    ds_read_b128 v[220:223], v6 offset:15360
    s_add_u32 m0, s59, 114688
    v_mul_f32 v9, v118, v118
    v_mfma_f32_32x32x16_bf16 v[224:239], v[176:179], a[152:155], v[224:239]
    ds_read_b128 a[72:75], v32 offset:32768
    ds_read_b128 a[76:79], v33 offset:32768
    buffer_load_dwordx4 v36, s[40:43], s58 offen offset:1024 sc1 lds
    s_add_u32 m0, s59, 122880
    s_add_u32 s58, s8, 49152
    v_mfma_f32_32x32x16_bf16 v[240:255], v[180:183], a[152:155], v[240:255]
    buffer_load_dwordx4 v36, s[40:43], s58 offen offset:0 sc1 lds
    s_add_u32 m0, s62, 49152
    v_mul_f32 v10, v119, v119
    v_fmaak_f32 v7, v11, v7, 0xc0135761
    v_mfma_f32_32x32x16_bf16 v[224:239], v[184:187], a[156:159], v[224:239]
    buffer_load_dwordx4 v35, s[24:27], s92 offen offset:1024 lds
    v_fmaak_f32 v8, v11, v8, 0xc0135761
    v_fmaak_f32 v9, v11, v9, 0xc0135761
    v_fmaak_f32 v10, v11, v10, 0xc0135761
    v_mfma_f32_32x32x16_bf16 v[240:255], v[188:191], a[156:159], v[240:255]
    v_mul_f32 v7, v7, v116
    s_waitcnt vmcnt(9) lgkmcnt(0)
    s_barrier
    v_mfma_f32_32x32x16_bf16 v[224:239], v[192:195], a[160:163], v[224:239]
    ds_read_b128 v[160:163], v6 offset:16384
    ds_read_b128 v[164:167], v6 offset:17408
    v_mul_f32 v8, v8, v117
    v_mul_f32 v9, v9, v118
    v_mfma_f32_32x32x16_bf16 v[240:255], v[196:199], a[160:163], v[240:255]
    ds_read_b128 v[168:171], v6 offset:18432
    ds_read_b128 v[172:175], v6 offset:19456
    v_mul_f32 v10, v10, v119
    v_mfma_f32_32x32x16_bf16 v[224:239], v[200:203], a[164:167], v[224:239]
    ds_read_b128 v[176:179], v6 offset:20480
    ds_read_b128 v[180:183], v6 offset:21504
    v_exp_f32 v7, v7
    v_mfma_f32_32x32x16_bf16 v[240:255], v[204:207], a[164:167], v[240:255]
    ds_read_b128 v[184:187], v6 offset:22528
    ds_read_b128 v[188:191], v6 offset:23552
    s_add_u32 m0, s59, 122880
    v_mfma_f32_32x32x16_bf16 v[224:239], v[208:211], a[168:171], v[224:239]
    buffer_load_dwordx4 v36, s[40:43], s58 offen offset:1024 sc1 lds
    s_add_u32 m0, s59, 81920
    s_add_u32 s58, s8, 57344
    v_mfma_f32_32x32x16_bf16 v[240:255], v[212:215], a[168:171], v[240:255]
    buffer_load_dwordx4 v36, s[40:43], s58 offen offset:0 sc1 lds
    s_add_u32 m0, s62, 49152
    v_exp_f32 v8, v8
    v_mfma_f32_32x32x16_bf16 v[224:239], v[216:219], a[172:175], v[224:239]
    buffer_load_dwordx4 v34, s[24:27], s93 offen offset:2048 lds
    v_exp_f32 v9, v9
    v_mfma_f32_32x32x16_bf16 v[240:255], v[220:223], a[172:175], v[240:255]
    buffer_load_dwordx4 v35, s[24:27], s94 offen offset:3072 lds
    s_waitcnt vmcnt(10) lgkmcnt(0)
    s_barrier
    v_mfma_f32_32x32x16_bf16 v[224:239], v[160:163], a[176:179], v[224:239]
    ds_read_b128 v[192:195], v6 offset:24576
    ds_read_b128 v[196:199], v6 offset:25600
    v_exp_f32 v10, v10
    v_mfma_f32_32x32x16_bf16 v[240:255], v[164:167], a[176:179], v[240:255]
    ds_read_b128 v[200:203], v6 offset:26624
    ds_read_b128 v[204:207], v6 offset:27648
    v_add_f32 v7, 1.0, v7
    v_add_f32 v8, 1.0, v8
    v_mfma_f32_32x32x16_bf16 v[224:239], v[168:171], a[180:183], v[224:239]
    ds_read_b128 v[208:211], v6 offset:28672
    ds_read_b128 v[212:215], v6 offset:29696
    v_add_f32 v9, 1.0, v9
    v_add_f32 v10, 1.0, v10
    v_mfma_f32_32x32x16_bf16 v[240:255], v[172:175], a[180:183], v[240:255]
    ds_read_b128 v[216:219], v6 offset:30720
    ds_read_b128 v[220:223], v6 offset:31744
    s_add_u32 m0, s59, 81920
    v_mfma_f32_32x32x16_bf16 v[224:239], v[176:179], a[184:187], v[224:239]
    s_waitcnt vmcnt(8)
    v_add_u32 v30, 0xfffec000, v30
    v_add_u32 v31, 0xfffec000, v31
    v_add_u32 v32, 0xfffec000, v32
    v_add_u32 v33, 0xfffec000, v33
    ds_read_b128 a[80:83], v30 offset:49152
    ds_read_b128 a[84:87], v31 offset:49152
    buffer_load_dwordx4 v36, s[40:43], s58 offen offset:1024 sc1 lds
    s_add_u32 m0, s59, 90112
    s_add_u32 s58, s8, 65536
    v_mfma_f32_32x32x16_bf16 v[240:255], v[180:183], a[184:187], v[240:255]
    ds_read_b128 a[88:91], v32 offset:49152
    ds_read_b128 a[92:95], v33 offset:49152
    buffer_load_dwordx4 v36, s[40:43], s58 offen offset:0 sc1 lds
    v_add_u32 v34, 128, v34
    v_xor_b32 v35, 64, v34
    s_add_u32 m0, s62, 32768
    v_mfma_f32_32x32x16_bf16 v[224:239], v[184:187], a[188:191], v[224:239]
    buffer_load_dwordx4 v34, s[24:27], 0 offen offset:0 lds
    v_rcp_f32 v7, v7
    v_mfma_f32_32x32x16_bf16 v[240:255], v[188:191], a[188:191], v[240:255]
    s_waitcnt vmcnt(9) lgkmcnt(0)
    s_barrier
    v_mfma_f32_32x32x16_bf16 v[224:239], v[192:195], a[192:195], v[224:239]
    ds_read_b128 v[160:163], v6 offset:32768
    ds_read_b128 v[164:167], v6 offset:33792
    v_rcp_f32 v8, v8
    v_mfma_f32_32x32x16_bf16 v[240:255], v[196:199], a[192:195], v[240:255]
    ds_read_b128 v[168:171], v6 offset:34816
    ds_read_b128 v[172:175], v6 offset:35840
    v_rcp_f32 v9, v9
    v_mfma_f32_32x32x16_bf16 v[224:239], v[200:203], a[196:199], v[224:239]
    ds_read_b128 v[176:179], v6 offset:36864
    ds_read_b128 v[180:183], v6 offset:37888
    v_rcp_f32 v10, v10
    v_mfma_f32_32x32x16_bf16 v[240:255], v[204:207], a[196:199], v[240:255]
    ds_read_b128 v[184:187], v6 offset:38912
    ds_read_b128 v[188:191], v6 offset:39936
    s_add_u32 m0, s59, 90112
    v_mul_f32 v116, v116, v7
    v_mfma_f32_32x32x16_bf16 v[224:239], v[208:211], a[200:203], v[224:239]
    buffer_load_dwordx4 v36, s[40:43], s58 offen offset:1024 sc1 lds
    s_add_u32 m0, s59, 98304
    s_add_u32 s58, s8, 73728
    v_mul_f32 v117, v117, v8
    v_mfma_f32_32x32x16_bf16 v[240:255], v[212:215], a[200:203], v[240:255]
    buffer_load_dwordx4 v36, s[40:43], s58 offen offset:0 sc1 lds
    s_add_u32 m0, s62, 32768
    v_mul_f32 v118, v118, v9
    v_mul_f32 v119, v119, v10
    v_mfma_f32_32x32x16_bf16 v[224:239], v[216:219], a[204:207], v[224:239]
    buffer_load_dwordx4 v35, s[24:27], s92 offen offset:1024 lds
    v_mul_f32 v120, v120, v4
    v_mul_f32 v121, v121, v4
    v_mul_f32 v122, v122, v4
    v_mfma_f32_32x32x16_bf16 v[240:255], v[220:223], a[204:207], v[240:255]
    buffer_load_dwordx4 v34, s[24:27], s93 offen offset:2048 lds
    s_waitcnt vmcnt(10) lgkmcnt(0)
    s_barrier
    v_mfma_f32_32x32x16_bf16 v[128:143], v[160:163], a[208:211], v[128:143]
    ds_read_b128 v[192:195], v6 offset:40960
    ds_read_b128 v[196:199], v6 offset:41984
    v_mul_f32 v123, v123, v4
    v_mul_f32 v7, v120, v120
    v_mfma_f32_32x32x16_bf16 v[144:159], v[164:167], a[208:211], v[144:159]
    ds_read_b128 v[200:203], v6 offset:43008
    ds_read_b128 v[204:207], v6 offset:44032
    v_mul_f32 v8, v121, v121
    v_mul_f32 v9, v122, v122
    v_mfma_f32_32x32x16_bf16 v[128:143], v[168:171], a[212:215], v[128:143]
    ds_read_b128 v[208:211], v6 offset:45056
    ds_read_b128 v[212:215], v6 offset:46080
    v_mul_f32 v10, v123, v123
    v_fmaak_f32 v7, v11, v7, 0xc0135761
    v_mfma_f32_32x32x16_bf16 v[144:159], v[172:175], a[212:215], v[144:159]
    ds_read_b128 v[216:219], v6 offset:47104
    ds_read_b128 v[220:223], v6 offset:48128
    s_add_u32 m0, s59, 98304
    v_fmaak_f32 v8, v11, v8, 0xc0135761
    v_mfma_f32_32x32x16_bf16 v[128:143], v[176:179], a[216:219], v[128:143]
    buffer_load_dwordx4 v36, s[40:43], s58 offen offset:1024 sc1 lds
    s_add_u32 m0, s59, 106496
    s_add_u32 s58, s8, 81920
    v_fmaak_f32 v9, v11, v9, 0xc0135761
    v_mfma_f32_32x32x16_bf16 v[144:159], v[180:183], a[216:219], v[144:159]
    s_waitcnt vmcnt(8)
    ds_read_b128 a[96:99], v30 offset:32768
    ds_read_b128 a[100:103], v31 offset:32768
    buffer_load_dwordx4 v36, s[40:43], s58 offen offset:0 sc1 lds
    s_add_u32 m0, s62, 32768
    v_mfma_f32_32x32x16_bf16 v[128:143], v[184:187], a[220:223], v[128:143]
    buffer_load_dwordx4 v35, s[24:27], s94 offen offset:3072 lds
    v_fmaak_f32 v10, v11, v10, 0xc0135761
    v_mul_f32 v7, v7, v120
    v_mul_f32 v8, v8, v121
    v_mfma_f32_32x32x16_bf16 v[144:159], v[188:191], a[220:223], v[144:159]
    v_mul_f32 v9, v9, v122
    s_waitcnt vmcnt(9) lgkmcnt(0)
    s_barrier
    v_mfma_f32_32x32x16_bf16 v[128:143], v[192:195], a[224:227], v[128:143]
    ds_read_b128 v[160:163], v6 offset:0
    ds_read_b128 v[164:167], v6 offset:1024
    v_mul_f32 v10, v10, v123
    v_mfma_f32_32x32x16_bf16 v[144:159], v[196:199], a[224:227], v[144:159]
    ds_read_b128 v[168:171], v6 offset:2048
    ds_read_b128 v[172:175], v6 offset:3072
    v_exp_f32 v7, v7
    v_mfma_f32_32x32x16_bf16 v[128:143], v[200:203], a[228:231], v[128:143]
    ds_read_b128 v[176:179], v6 offset:4096
    ds_read_b128 v[180:183], v6 offset:5120
    v_exp_f32 v8, v8
    v_mfma_f32_32x32x16_bf16 v[144:159], v[204:207], a[228:231], v[144:159]
    ds_read_b128 v[184:187], v6 offset:6144
    ds_read_b128 v[188:191], v6 offset:7168
    s_add_u32 m0, s59, 106496
    v_mfma_f32_32x32x16_bf16 v[128:143], v[208:211], a[232:235], v[128:143]
    ds_read_b128 a[104:107], v32 offset:32768
    ds_read_b128 a[108:111], v33 offset:32768
    buffer_load_dwordx4 v36, s[40:43], s58 offen offset:1024 sc1 lds
    s_add_u32 m0, s59, 114688
    s_add_u32 s58, s8, 90112
    v_mfma_f32_32x32x16_bf16 v[144:159], v[212:215], a[232:235], v[144:159]
    buffer_load_dwordx4 v36, s[40:43], s58 offen offset:0 sc1 lds
    s_add_u32 m0, s62, 0
    s_mov_b32 s92, 3072
    s_mov_b32 s93, 14336
    s_mov_b32 s94, 17408
    v_mfma_f32_32x32x16_bf16 v[128:143], v[216:219], a[236:239], v[128:143]
    buffer_load_dwordx4 v40, s[32:35], 0 offen offset:0 lds
    v_exp_f32 v9, v9
    v_mfma_f32_32x32x16_bf16 v[144:159], v[220:223], a[236:239], v[144:159]
    buffer_load_dwordx4 v40, s[32:35], s92 offen offset:1024 lds
    s_waitcnt vmcnt(10) lgkmcnt(0)
    s_barrier
    v_mfma_f32_32x32x16_bf16 v[128:143], v[160:163], a[240:243], v[128:143]
    ds_read_b128 v[192:195], v6 offset:8192
    ds_read_b128 v[196:199], v6 offset:9216
    v_exp_f32 v10, v10
    v_mfma_f32_32x32x16_bf16 v[144:159], v[164:167], a[240:243], v[144:159]
    ds_read_b128 v[200:203], v6 offset:10240
    ds_read_b128 v[204:207], v6 offset:11264
    v_add_f32 v7, 1.0, v7
    v_add_f32 v8, 1.0, v8
    v_mfma_f32_32x32x16_bf16 v[128:143], v[168:171], a[244:247], v[128:143]
    ds_read_b128 v[208:211], v6 offset:12288
    ds_read_b128 v[212:215], v6 offset:13312
    v_add_f32 v9, 1.0, v9
    v_add_f32 v10, 1.0, v10
    v_mfma_f32_32x32x16_bf16 v[144:159], v[172:175], a[244:247], v[144:159]
    ds_read_b128 v[216:219], v6 offset:14336
    ds_read_b128 v[220:223], v6 offset:15360
    s_add_u32 m0, s59, 114688
    v_mfma_f32_32x32x16_bf16 v[128:143], v[176:179], a[248:251], v[128:143]
    buffer_load_dwordx4 v36, s[40:43], s58 offen offset:1024 sc1 lds
    s_add_u32 m0, s59, 122880
    s_add_u32 s58, s8, 98304
    v_mfma_f32_32x32x16_bf16 v[144:159], v[180:183], a[248:251], v[144:159]
    buffer_load_dwordx4 v36, s[40:43], s58 offen offset:0 sc1 lds
    s_add_u32 m0, s62, 0
    v_rcp_f32 v7, v7
    v_mfma_f32_32x32x16_bf16 v[128:143], v[184:187], a[252:255], v[128:143]
    buffer_load_dwordx4 v40, s[32:35], s93 offen offset:2048 lds
    v_rcp_f32 v8, v8
    v_mfma_f32_32x32x16_bf16 v[144:159], v[188:191], a[252:255], v[144:159]
    s_waitcnt vmcnt(9) lgkmcnt(0)
    s_barrier
    v_mfma_f32_32x32x16_bf16 v[128:143], v[192:195], a[0:3], v[128:143]
    ds_read_b128 v[160:163], v6 offset:16384
    ds_read_b128 v[164:167], v6 offset:17408
    v_rcp_f32 v9, v9
    v_mfma_f32_32x32x16_bf16 v[144:159], v[196:199], a[0:3], v[144:159]
    ds_read_b128 v[168:171], v6 offset:18432
    ds_read_b128 v[172:175], v6 offset:19456
    v_rcp_f32 v10, v10
    v_mfma_f32_32x32x16_bf16 v[128:143], v[200:203], a[4:7], v[128:143]
    ds_read_b128 v[176:179], v6 offset:20480
    ds_read_b128 v[180:183], v6 offset:21504
    v_mul_f32 v120, v120, v7
    v_mul_f32 v121, v121, v8
    v_mfma_f32_32x32x16_bf16 v[144:159], v[204:207], a[4:7], v[144:159]
    ds_read_b128 v[184:187], v6 offset:22528
    ds_read_b128 v[188:191], v6 offset:23552
    s_add_u32 m0, s59, 122880
    v_mul_f32 v122, v122, v9
    v_mfma_f32_32x32x16_bf16 v[128:143], v[208:211], a[8:11], v[128:143]
    buffer_load_dwordx4 v36, s[40:43], s58 offen offset:1024 sc1 lds
    s_add_u32 m0, s59, 81920
    s_add_u32 s58, s8, 106496
    v_mul_f32 v123, v123, v10
    v_mfma_f32_32x32x16_bf16 v[144:159], v[212:215], a[8:11], v[144:159]
    s_waitcnt vmcnt(8)
    ds_read_b128 a[112:115], v30 offset:16384
    ds_read_b128 a[116:119], v31 offset:16384
    buffer_load_dwordx4 v36, s[40:43], s58 offen offset:0 sc1 lds
    s_add_u32 m0, s62, 0
    v_mfma_f32_32x32x16_bf16 v[128:143], v[216:219], a[12:15], v[128:143]
    buffer_load_dwordx4 v40, s[32:35], s94 offen offset:3072 lds
    v_add_u32 v40, 0x20000, v40
    s_add_u32 m0, s62, 16384
    v_mul_f32 v124, v124, v4
    v_mfma_f32_32x32x16_bf16 v[144:159], v[220:223], a[12:15], v[144:159]
    buffer_load_dwordx4 v40, s[32:35], 0 offen offset:0 lds
    s_waitcnt vmcnt(10) lgkmcnt(0)
    s_barrier
    v_mfma_f32_32x32x16_bf16 v[128:143], v[160:163], a[16:19], v[128:143]
    ds_read_b128 v[192:195], v6 offset:24576
    ds_read_b128 v[196:199], v6 offset:25600
    v_mul_f32 v125, v125, v4
    v_mul_f32 v126, v126, v4
    v_mfma_f32_32x32x16_bf16 v[144:159], v[164:167], a[16:19], v[144:159]
    ds_read_b128 v[200:203], v6 offset:26624
    ds_read_b128 v[204:207], v6 offset:27648
    v_mul_f32 v127, v127, v4
    v_mul_f32 v7, v124, v124
    v_mfma_f32_32x32x16_bf16 v[128:143], v[168:171], a[20:23], v[128:143]
    ds_read_b128 v[208:211], v6 offset:28672
    ds_read_b128 v[212:215], v6 offset:29696
    v_mul_f32 v8, v125, v125
    v_mul_f32 v9, v126, v126
    v_mfma_f32_32x32x16_bf16 v[144:159], v[172:175], a[20:23], v[144:159]
    ds_read_b128 v[216:219], v6 offset:30720
    ds_read_b128 v[220:223], v6 offset:31744
    s_add_u32 m0, s59, 81920
    v_mul_f32 v10, v127, v127
    v_mfma_f32_32x32x16_bf16 v[128:143], v[176:179], a[24:27], v[128:143]
    ds_read_b128 a[120:123], v32 offset:16384
    ds_read_b128 a[124:127], v33 offset:16384
    buffer_load_dwordx4 v36, s[40:43], s58 offen offset:1024 sc1 lds
    s_add_u32 m0, s59, 90112
    s_add_u32 s58, s8, 114688
    v_mfma_f32_32x32x16_bf16 v[144:159], v[180:183], a[24:27], v[144:159]
    buffer_load_dwordx4 v36, s[40:43], s58 offen offset:0 sc1 lds
    s_add_u32 m0, s62, 16384
    v_fmaak_f32 v7, v11, v7, 0xc0135761
    v_fmaak_f32 v8, v11, v8, 0xc0135761
    v_mfma_f32_32x32x16_bf16 v[128:143], v[184:187], a[28:31], v[128:143]
    buffer_load_dwordx4 v40, s[32:35], s92 offen offset:1024 lds
    v_fmaak_f32 v9, v11, v9, 0xc0135761
    v_fmaak_f32 v10, v11, v10, 0xc0135761
    v_mul_f32 v7, v7, v124
    v_mfma_f32_32x32x16_bf16 v[144:159], v[188:191], a[28:31], v[144:159]
    v_mul_f32 v8, v8, v125
    s_waitcnt vmcnt(9) lgkmcnt(0)
    s_barrier
    v_mfma_f32_32x32x16_bf16 v[128:143], v[192:195], a[32:35], v[128:143]
    ds_read_b128 v[160:163], v6 offset:32768
    ds_read_b128 v[164:167], v6 offset:33792
    v_mul_f32 v9, v9, v126
    v_mul_f32 v10, v10, v127
    v_mfma_f32_32x32x16_bf16 v[144:159], v[196:199], a[32:35], v[144:159]
    ds_read_b128 v[168:171], v6 offset:34816
    ds_read_b128 v[172:175], v6 offset:35840
    v_exp_f32 v7, v7
    v_mfma_f32_32x32x16_bf16 v[128:143], v[200:203], a[36:39], v[128:143]
    ds_read_b128 v[176:179], v6 offset:36864
    ds_read_b128 v[180:183], v6 offset:37888
    v_exp_f32 v8, v8
    v_mfma_f32_32x32x16_bf16 v[144:159], v[204:207], a[36:39], v[144:159]
    ds_read_b128 v[184:187], v6 offset:38912
    ds_read_b128 v[188:191], v6 offset:39936
    s_add_u32 m0, s59, 90112
    v_mfma_f32_32x32x16_bf16 v[128:143], v[208:211], a[40:43], v[128:143]
    buffer_load_dwordx4 v36, s[40:43], s58 offen offset:1024 sc1 lds
    s_add_u32 m0, s59, 98304
    s_add_u32 s58, s8, 122880
    v_mfma_f32_32x32x16_bf16 v[144:159], v[212:215], a[40:43], v[144:159]
    s_branch L_page7
    .p2align 12
L_pad7:
    s_setpc_b64 s[0:1]
    s_nop 0
L_page7:
    buffer_load_dwordx4 v36, s[40:43], s58 offen offset:0 sc1 lds
    s_add_u32 m0, s62, 16384
    v_exp_f32 v9, v9
    v_mfma_f32_32x32x16_bf16 v[128:143], v[216:219], a[44:47], v[128:143]
    buffer_load_dwordx4 v40, s[32:35], s93 offen offset:2048 lds
    v_exp_f32 v10, v10
    v_add_f32 v7, 1.0, v7
    v_mfma_f32_32x32x16_bf16 v[144:159], v[220:223], a[44:47], v[144:159]
    buffer_load_dwordx4 v40, s[32:35], s94 offen offset:3072 lds
    s_waitcnt vmcnt(10) lgkmcnt(0)
    s_barrier
    v_mfma_f32_32x32x16_bf16 v[128:143], v[160:163], a[48:51], v[128:143]
    ds_read_b128 v[192:195], v6 offset:40960
    ds_read_b128 v[196:199], v6 offset:41984
    v_add_f32 v8, 1.0, v8
    v_add_f32 v9, 1.0, v9
    v_mfma_f32_32x32x16_bf16 v[144:159], v[164:167], a[48:51], v[144:159]
    ds_read_b128 v[200:203], v6 offset:43008
    ds_read_b128 v[204:207], v6 offset:44032
    v_add_f32 v10, 1.0, v10
    v_mfma_f32_32x32x16_bf16 v[128:143], v[168:171], a[52:55], v[128:143]
    ds_read_b128 v[208:211], v6 offset:45056
    ds_read_b128 v[212:215], v6 offset:46080
    v_rcp_f32 v7, v7
    v_mfma_f32_32x32x16_bf16 v[144:159], v[172:175], a[52:55], v[144:159]
    ds_read_b128 v[216:219], v6 offset:47104
    ds_read_b128 v[220:223], v6 offset:48128
    s_add_u32 m0, s59, 98304
    v_mfma_f32_32x32x16_bf16 v[128:143], v[176:179], a[56:59], v[128:143]
    buffer_load_dwordx4 v36, s[40:43], s58 offen offset:1024 sc1 lds
    s_add_u32 m0, s59, 106496
    s_add_u32 s58, s9, 40960
    v_mfma_f32_32x32x16_bf16 v[144:159], v[180:183], a[56:59], v[144:159]
    buffer_load_dwordx4 v36, s[40:43], s58 offen offset:0 sc1 lds
    v_add_u32 v40, 0x20000, v40
    s_add_u32 m0, s62, 32768
    v_mfma_f32_32x32x16_bf16 v[128:143], v[184:187], a[60:63], v[128:143]
    buffer_load_dwordx4 v40, s[32:35], 0 offen offset:0 lds
    v_rcp_f32 v8, v8
    v_mfma_f32_32x32x16_bf16 v[144:159], v[188:191], a[60:63], v[144:159]
    s_waitcnt vmcnt(9) lgkmcnt(0)
    s_barrier
    v_mfma_f32_32x32x16_bf16 v[128:143], v[192:195], a[64:67], v[128:143]
    ds_read_b128 v[160:163], v6 offset:0
    ds_read_b128 v[164:167], v6 offset:1024
    v_rcp_f32 v9, v9
    v_mfma_f32_32x32x16_bf16 v[144:159], v[196:199], a[64:67], v[144:159]
    ds_read_b128 v[168:171], v6 offset:2048
    ds_read_b128 v[172:175], v6 offset:3072
    v_rcp_f32 v10, v10
    v_mfma_f32_32x32x16_bf16 v[128:143], v[200:203], a[68:71], v[128:143]
    ds_read_b128 v[176:179], v6 offset:4096
    ds_read_b128 v[180:183], v6 offset:5120
    v_mul_f32 v124, v124, v7
    v_mul_f32 v125, v125, v8
    v_mfma_f32_32x32x16_bf16 v[144:159], v[204:207], a[68:71], v[144:159]
    ds_read_b128 v[184:187], v6 offset:6144
    ds_read_b128 v[188:191], v6 offset:7168
    s_add_u32 m0, s59, 106496
    v_mul_f32 v126, v126, v9
    v_mfma_f32_32x32x16_bf16 v[128:143], v[208:211], a[72:75], v[128:143]
    buffer_load_dwordx4 v36, s[40:43], s58 offen offset:1024 sc1 lds
    s_add_u32 m0, s59, 114688
    s_add_u32 s58, s9, 49152
    v_mul_f32 v127, v127, v10
    v_mfma_f32_32x32x16_bf16 v[144:159], v[212:215], a[72:75], v[144:159]
    buffer_load_dwordx4 v36, s[40:43], s58 offen offset:0 sc1 lds
    s_add_u32 m0, s62, 32768
    v_mfma_f32_32x32x16_bf16 v[128:143], v[216:219], a[76:79], v[128:143]
    buffer_load_dwordx4 v40, s[32:35], s92 offen offset:1024 lds
    v_mfma_f32_32x32x16_bf16 v[144:159], v[220:223], a[76:79], v[144:159]
    buffer_load_dwordx4 v40, s[32:35], s93 offen offset:2048 lds
    s_waitcnt vmcnt(10) lgkmcnt(0)
    s_barrier
    v_mfma_f32_32x32x16_bf16 v[128:143], v[160:163], a[80:83], v[128:143]
    ds_read_b128 v[192:195], v6 offset:8192
    ds_read_b128 v[196:199], v6 offset:9216
    v_mfma_f32_32x32x16_bf16 v[144:159], v[164:167], a[80:83], v[144:159]
    ds_read_b128 v[200:203], v6 offset:10240
    ds_read_b128 v[204:207], v6 offset:11264
    v_mfma_f32_32x32x16_bf16 v[128:143], v[168:171], a[84:87], v[128:143]
    ds_read_b128 v[208:211], v6 offset:12288
    ds_read_b128 v[212:215], v6 offset:13312
    v_mfma_f32_32x32x16_bf16 v[144:159], v[172:175], a[84:87], v[144:159]
    ds_read_b128 v[216:219], v6 offset:14336
    ds_read_b128 v[220:223], v6 offset:15360
    s_add_u32 m0, s59, 114688
    v_mfma_f32_32x32x16_bf16 v[128:143], v[176:179], a[88:91], v[128:143]
    buffer_load_dwordx4 v36, s[40:43], s58 offen offset:1024 sc1 lds
    s_add_u32 m0, s59, 122880
    s_add_u32 s58, s9, 57344
    v_mfma_f32_32x32x16_bf16 v[144:159], v[180:183], a[88:91], v[144:159]
    buffer_load_dwordx4 v36, s[40:43], s58 offen offset:0 sc1 lds
    s_add_u32 m0, s62, 32768
    v_mfma_f32_32x32x16_bf16 v[128:143], v[184:187], a[92:95], v[128:143]
    buffer_load_dwordx4 v40, s[32:35], s94 offen offset:3072 lds
    v_mfma_f32_32x32x16_bf16 v[144:159], v[188:191], a[92:95], v[144:159]
    s_waitcnt vmcnt(9) lgkmcnt(0)
    s_barrier
    v_mfma_f32_32x32x16_bf16 v[128:143], v[192:195], a[96:99], v[128:143]
    ds_read_b128 v[160:163], v6 offset:16384
    ds_read_b128 v[164:167], v6 offset:17408
    v_mfma_f32_32x32x16_bf16 v[144:159], v[196:199], a[96:99], v[144:159]
    ds_read_b128 v[168:171], v6 offset:18432
    ds_read_b128 v[172:175], v6 offset:19456
    v_mfma_f32_32x32x16_bf16 v[128:143], v[200:203], a[100:103], v[128:143]
    ds_read_b128 v[176:179], v6 offset:20480
    ds_read_b128 v[180:183], v6 offset:21504
    v_mfma_f32_32x32x16_bf16 v[144:159], v[204:207], a[100:103], v[144:159]
    ds_read_b128 v[184:187], v6 offset:22528
    ds_read_b128 v[188:191], v6 offset:23552
    s_add_u32 m0, s59, 122880
    v_mfma_f32_32x32x16_bf16 v[128:143], v[208:211], a[104:107], v[128:143]
    buffer_load_dwordx4 v36, s[40:43], s58 offen offset:1024 sc1 lds
    s_add_u32 m0, s59, 81920
    s_add_u32 s58, s9, 65536
    v_mfma_f32_32x32x16_bf16 v[144:159], v[212:215], a[104:107], v[144:159]
    buffer_load_dwordx4 v36, s[40:43], s58 offen offset:0 sc1 lds
    v_add_u32 v40, 0x20000, v40
    s_add_u32 m0, s62, 49152
    v_mfma_f32_32x32x16_bf16 v[128:143], v[216:219], a[108:111], v[128:143]
    buffer_load_dwordx4 v40, s[32:35], 0 offen offset:0 lds
    v_mfma_f32_32x32x16_bf16 v[144:159], v[220:223], a[108:111], v[144:159]
    buffer_load_dwordx4 v40, s[32:35], s92 offen offset:1024 lds
    s_waitcnt vmcnt(10) lgkmcnt(0)
    s_barrier
    v_mfma_f32_32x32x16_bf16 v[128:143], v[160:163], a[112:115], v[128:143]
    ds_read_b128 v[192:195], v6 offset:24576
    ds_read_b128 v[196:199], v6 offset:25600
    v_mfma_f32_32x32x16_bf16 v[144:159], v[164:167], a[112:115], v[144:159]
    ds_read_b128 v[200:203], v6 offset:26624
    ds_read_b128 v[204:207], v6 offset:27648
    v_mfma_f32_32x32x16_bf16 v[128:143], v[168:171], a[116:119], v[128:143]
    ds_read_b128 v[208:211], v6 offset:28672
    ds_read_b128 v[212:215], v6 offset:29696
    v_mfma_f32_32x32x16_bf16 v[144:159], v[172:175], a[116:119], v[144:159]
    ds_read_b128 v[216:219], v6 offset:30720
    ds_read_b128 v[220:223], v6 offset:31744
    s_add_u32 m0, s59, 81920
    v_mfma_f32_32x32x16_bf16 v[128:143], v[176:179], a[120:123], v[128:143]
    buffer_load_dwordx4 v36, s[40:43], s58 offen offset:1024 sc1 lds
    s_add_u32 m0, s59, 90112
    s_add_u32 s58, s9, 73728
    v_mfma_f32_32x32x16_bf16 v[144:159], v[180:183], a[120:123], v[144:159]
    buffer_load_dwordx4 v36, s[40:43], s58 offen offset:0 sc1 lds
    s_add_u32 m0, s62, 49152
    v_mfma_f32_32x32x16_bf16 v[128:143], v[184:187], a[124:127], v[128:143]
    buffer_load_dwordx4 v40, s[32:35], s93 offen offset:2048 lds
    v_mfma_f32_32x32x16_bf16 v[144:159], v[188:191], a[124:127], v[144:159]
    s_waitcnt vmcnt(9) lgkmcnt(0)
    s_barrier
    v_mfma_f32_32x32x16_bf16 v[224:239], v[192:195], a[208:211], v[224:239]
    ds_read_b128 v[160:163], v6 offset:32768
    ds_read_b128 v[164:167], v6 offset:33792
    v_mfma_f32_32x32x16_bf16 v[240:255], v[196:199], a[208:211], v[240:255]
    ds_read_b128 v[168:171], v6 offset:34816
    ds_read_b128 v[172:175], v6 offset:35840
    s_nop 1
    v_cvt_pk_bf16_f32 v80, v128, v129
    v_cvt_pk_bf16_f32 v81, v130, v131
    v_mfma_f32_32x32x16_bf16 v[224:239], v[200:203], a[212:215], v[224:239]
    ds_read_b128 v[176:179], v6 offset:36864
    ds_read_b128 v[180:183], v6 offset:37888
    v_cvt_pk_bf16_f32 v82, v132, v133
    v_cvt_pk_bf16_f32 v83, v134, v135
    v_mfma_f32_32x32x16_bf16 v[240:255], v[204:207], a[212:215], v[240:255]
    ds_read_b128 v[184:187], v6 offset:38912
    ds_read_b128 v[188:191], v6 offset:39936
    s_add_u32 m0, s59, 90112
    v_cvt_pk_bf16_f32 v84, v136, v137
    v_mfma_f32_32x32x16_bf16 v[224:239], v[208:211], a[216:219], v[224:239]
    buffer_load_dwordx4 v36, s[40:43], s58 offen offset:1024 sc1 lds
    s_add_u32 m0, s59, 98304
    s_add_u32 s58, s9, 81920
    v_cvt_pk_bf16_f32 v85, v138, v139
    v_mfma_f32_32x32x16_bf16 v[240:255], v[212:215], a[216:219], v[240:255]
    buffer_load_dwordx4 v36, s[40:43], s58 offen offset:0 sc1 lds
    v_cvt_pk_bf16_f32 v86, v140, v141
    v_cvt_pk_bf16_f32 v87, v142, v143
    v_cvt_pk_bf16_f32 v88, v144, v145
    v_mfma_f32_32x32x16_bf16 v[224:239], v[216:219], a[220:223], v[224:239]
    buffer_store_dwordx4 v[80:83], v46, s[40:43], 0 offen offset:0
    v_mfma_f32_32x32x16_bf16 v[240:255], v[220:223], a[220:223], v[240:255]
    buffer_store_dwordx4 v[84:87], v46, s[40:43], 0 offen offset:512
    s_waitcnt vmcnt(10) lgkmcnt(0)
    s_barrier
    v_mfma_f32_32x32x16_bf16 v[224:239], v[160:163], a[224:227], v[224:239]
    ds_read_b128 v[192:195], v6 offset:40960
    ds_read_b128 v[196:199], v6 offset:41984
    v_cvt_pk_bf16_f32 v89, v146, v147
    v_cvt_pk_bf16_f32 v90, v148, v149
    v_mfma_f32_32x32x16_bf16 v[240:255], v[164:167], a[224:227], v[240:255]
    ds_read_b128 v[200:203], v6 offset:43008
    ds_read_b128 v[204:207], v6 offset:44032
    v_cvt_pk_bf16_f32 v91, v150, v151
    v_cvt_pk_bf16_f32 v92, v152, v153
    v_mfma_f32_32x32x16_bf16 v[224:239], v[168:171], a[228:231], v[224:239]
    ds_read_b128 v[208:211], v6 offset:45056
    ds_read_b128 v[212:215], v6 offset:46080
    v_cvt_pk_bf16_f32 v93, v154, v155
    v_cvt_pk_bf16_f32 v94, v156, v157
    v_mfma_f32_32x32x16_bf16 v[240:255], v[172:175], a[228:231], v[240:255]
    ds_read_b128 v[216:219], v6 offset:47104
    ds_read_b128 v[220:223], v6 offset:48128
    v_cvt_pk_bf16_f32 v95, v158, v159
    v_mfma_f32_32x32x16_bf16 v[224:239], v[176:179], a[232:235], v[224:239]
    buffer_load_dwordx4 v36, s[40:43], s58 offen offset:1024 sc1 lds
    s_add_u32 m0, s59, 106496
    s_add_u32 s58, s9, 90112
    v_mfma_f32_32x32x16_bf16 v[240:255], v[180:183], a[232:235], v[240:255]
    buffer_load_dwordx4 v36, s[40:43], s58 offen offset:0 sc1 lds
    v_mfma_f32_32x32x16_bf16 v[224:239], v[184:187], a[236:239], v[224:239]
    buffer_store_dwordx4 v[88:91], v46, s[40:43], 0 offen offset:1024
    v_mfma_f32_32x32x16_bf16 v[240:255], v[188:191], a[236:239], v[240:255]
    buffer_store_dwordx4 v[92:95], v46, s[40:43], 0 offen offset:1536
    s_waitcnt vmcnt(10) lgkmcnt(0)
    s_barrier
    v_mfma_f32_32x32x16_bf16 v[224:239], v[192:195], a[240:243], v[224:239]
    ds_read_b128 v[160:163], v6 offset:0
    ds_read_b128 v[164:167], v6 offset:1024
    v_mfma_f32_32x32x16_bf16 v[240:255], v[196:199], a[240:243], v[240:255]
    ds_read_b128 v[168:171], v6 offset:2048
    ds_read_b128 v[172:175], v6 offset:3072
    v_mfma_f32_32x32x16_bf16 v[224:239], v[200:203], a[244:247], v[224:239]
    ds_read_b128 v[176:179], v6 offset:4096
    ds_read_b128 v[180:183], v6 offset:5120
    v_mfma_f32_32x32x16_bf16 v[240:255], v[204:207], a[244:247], v[240:255]
    ds_read_b128 v[184:187], v6 offset:6144
    ds_read_b128 v[188:191], v6 offset:7168
    v_mfma_f32_32x32x16_bf16 v[224:239], v[208:211], a[248:251], v[224:239]
    buffer_load_dwordx4 v36, s[40:43], s58 offen offset:1024 sc1 lds
    s_add_u32 m0, s59, 114688
    s_add_u32 s58, s9, 98304
    v_mfma_f32_32x32x16_bf16 v[240:255], v[212:215], a[248:251], v[240:255]
    buffer_load_dwordx4 v36, s[40:43], s58 offen offset:0 sc1 lds
    v_mfma_f32_32x32x16_bf16 v[224:239], v[216:219], a[252:255], v[224:239]
    v_mfma_f32_32x32x16_bf16 v[240:255], v[220:223], a[252:255], v[240:255]
    s_waitcnt vmcnt(9) lgkmcnt(0)
    s_barrier
    v_mfma_f32_32x32x16_bf16 v[224:239], v[160:163], a[0:3], v[224:239]
    ds_read_b128 v[192:195], v6 offset:8192
    ds_read_b128 v[196:199], v6 offset:9216
    v_mfma_f32_32x32x16_bf16 v[240:255], v[164:167], a[0:3], v[240:255]
    ds_read_b128 v[200:203], v6 offset:10240
    ds_read_b128 v[204:207], v6 offset:11264
    v_mfma_f32_32x32x16_bf16 v[224:239], v[168:171], a[4:7], v[224:239]
    ds_read_b128 v[208:211], v6 offset:12288
    ds_read_b128 v[212:215], v6 offset:13312
    v_mfma_f32_32x32x16_bf16 v[240:255], v[172:175], a[4:7], v[240:255]
    ds_read_b128 v[216:219], v6 offset:14336
    ds_read_b128 v[220:223], v6 offset:15360
    v_mfma_f32_32x32x16_bf16 v[224:239], v[176:179], a[8:11], v[224:239]
    buffer_load_dwordx4 v36, s[40:43], s58 offen offset:1024 sc1 lds
    s_add_u32 m0, s59, 122880
    s_add_u32 s58, s9, 106496
    v_mfma_f32_32x32x16_bf16 v[240:255], v[180:183], a[8:11], v[240:255]
    buffer_load_dwordx4 v36, s[40:43], s58 offen offset:0 sc1 lds
    s_add_u32 m0, s62, 49152
    v_mfma_f32_32x32x16_bf16 v[224:239], v[184:187], a[12:15], v[224:239]
    buffer_load_dwordx4 v40, s[32:35], s94 offen offset:3072 lds
    v_mfma_f32_32x32x16_bf16 v[240:255], v[188:191], a[12:15], v[240:255]
    s_waitcnt vmcnt(8) lgkmcnt(0)
    s_barrier
    v_mfma_f32_32x32x16_bf16 v[224:239], v[192:195], a[16:19], v[224:239]
    ds_read_b128 v[160:163], v6 offset:16384
    ds_read_b128 v[164:167], v6 offset:17408
    v_mfma_f32_32x32x16_bf16 v[240:255], v[196:199], a[16:19], v[240:255]
    ds_read_b128 v[168:171], v6 offset:18432
    ds_read_b128 v[172:175], v6 offset:19456
    v_mfma_f32_32x32x16_bf16 v[224:239], v[200:203], a[20:23], v[224:239]
    ds_read_b128 v[176:179], v6 offset:20480
    ds_read_b128 v[180:183], v6 offset:21504
    v_mfma_f32_32x32x16_bf16 v[240:255], v[204:207], a[20:23], v[240:255]
    ds_read_b128 v[184:187], v6 offset:22528
    ds_read_b128 v[188:191], v6 offset:23552
    s_waitcnt vmcnt(5)
    buffer_store_dword v45, v37, s[40:43], 0 offen
    s_add_u32 m0, s59, 122880
    v_mfma_f32_32x32x16_bf16 v[224:239], v[208:211], a[24:27], v[224:239]
    buffer_load_dwordx4 v36, s[40:43], s58 offen offset:1024 sc1 lds
    s_add_u32 m0, s59, 81920
    s_add_u32 s58, s9, 114688
    v_mfma_f32_32x32x16_bf16 v[240:255], v[212:215], a[24:27], v[240:255]
    buffer_load_dwordx4 v36, s[40:43], s58 offen offset:0 sc1 lds
    v_add_u32 v40, 0x20000, v40
    s_add_u32 m0, s62, 65536
    v_mfma_f32_32x32x16_bf16 v[224:239], v[216:219], a[28:31], v[224:239]
    buffer_load_dwordx4 v40, s[32:35], 0 offen offset:0 lds
    v_mfma_f32_32x32x16_bf16 v[240:255], v[220:223], a[28:31], v[240:255]
    s_waitcnt vmcnt(8) lgkmcnt(0)
    s_barrier
    v_mfma_f32_32x32x16_bf16 v[224:239], v[160:163], a[32:35], v[224:239]
    ds_read_b128 v[192:195], v6 offset:24576
    ds_read_b128 v[196:199], v6 offset:25600
    v_mfma_f32_32x32x16_bf16 v[240:255], v[164:167], a[32:35], v[240:255]
    ds_read_b128 v[200:203], v6 offset:26624
    ds_read_b128 v[204:207], v6 offset:27648
    v_mfma_f32_32x32x16_bf16 v[224:239], v[168:171], a[36:39], v[224:239]
    ds_read_b128 v[208:211], v6 offset:28672
    ds_read_b128 v[212:215], v6 offset:29696
    v_mfma_f32_32x32x16_bf16 v[240:255], v[172:175], a[36:39], v[240:255]
    ds_read_b128 v[216:219], v6 offset:30720
    ds_read_b128 v[220:223], v6 offset:31744
    buffer_load_dword v47, v49, s[40:43], 0 offen sc1
    s_add_u32 m0, s59, 81920
    v_mfma_f32_32x32x16_bf16 v[224:239], v[176:179], a[40:43], v[224:239]
    buffer_load_dwordx4 v36, s[40:43], s58 offen offset:1024 sc1 lds
    s_add_u32 m0, s59, 90112
    s_add_u32 s58, s9, 122880
    v_mfma_f32_32x32x16_bf16 v[240:255], v[180:183], a[40:43], v[240:255]
    buffer_load_dwordx4 v36, s[40:43], s58 offen offset:0 sc1 lds
    s_add_u32 m0, s62, 65536
    v_mfma_f32_32x32x16_bf16 v[224:239], v[184:187], a[44:47], v[224:239]
    buffer_load_dwordx4 v40, s[32:35], s92 offen offset:1024 lds
    v_mfma_f32_32x32x16_bf16 v[240:255], v[188:191], a[44:47], v[240:255]
    s_waitcnt vmcnt(10) lgkmcnt(0)
    s_barrier
    v_mfma_f32_32x32x16_bf16 v[224:239], v[192:195], a[48:51], v[224:239]
    ds_read_b128 v[160:163], v6 offset:32768
    ds_read_b128 v[164:167], v6 offset:33792
    v_mfma_f32_32x32x16_bf16 v[240:255], v[196:199], a[48:51], v[240:255]
    ds_read_b128 v[168:171], v6 offset:34816
    ds_read_b128 v[172:175], v6 offset:35840
    v_mfma_f32_32x32x16_bf16 v[224:239], v[200:203], a[52:55], v[224:239]
    ds_read_b128 v[176:179], v6 offset:36864
    ds_read_b128 v[180:183], v6 offset:37888
    v_mfma_f32_32x32x16_bf16 v[240:255], v[204:207], a[52:55], v[240:255]
    ds_read_b128 v[184:187], v6 offset:38912
    ds_read_b128 v[188:191], v6 offset:39936
    s_add_u32 m0, s59, 90112
    v_mfma_f32_32x32x16_bf16 v[224:239], v[208:211], a[56:59], v[224:239]
    buffer_load_dwordx4 v36, s[40:43], s58 offen offset:1024 sc1 lds
    s_add_u32 m0, s62, 65536
    v_mfma_f32_32x32x16_bf16 v[240:255], v[212:215], a[56:59], v[240:255]
    buffer_load_dwordx4 v40, s[32:35], s93 offen offset:2048 lds
    v_mfma_f32_32x32x16_bf16 v[224:239], v[216:219], a[60:63], v[224:239]
    v_mfma_f32_32x32x16_bf16 v[240:255], v[220:223], a[60:63], v[240:255]
    s_waitcnt vmcnt(8) lgkmcnt(0)
    s_barrier
    v_mfma_f32_32x32x16_bf16 v[224:239], v[160:163], a[64:67], v[224:239]
    ds_read_b128 v[192:195], v6 offset:40960
    ds_read_b128 v[196:199], v6 offset:41984
    v_mfma_f32_32x32x16_bf16 v[240:255], v[164:167], a[64:67], v[240:255]
    ds_read_b128 v[200:203], v6 offset:43008
    ds_read_b128 v[204:207], v6 offset:44032
    v_mfma_f32_32x32x16_bf16 v[224:239], v[168:171], a[68:71], v[224:239]
    ds_read_b128 v[208:211], v6 offset:45056
    ds_read_b128 v[212:215], v6 offset:46080
    v_mfma_f32_32x32x16_bf16 v[240:255], v[172:175], a[68:71], v[240:255]
    ds_read_b128 v[216:219], v6 offset:47104
    ds_read_b128 v[220:223], v6 offset:48128
    s_waitcnt vmcnt(5)
    v_cmp_ne_u32 vcc, s53, v47
    s_cbranch_vccnz L_retry_25
L_got_26:
    v_mfma_f32_32x32x16_bf16 v[224:239], v[176:179], a[72:75], v[224:239]
    buffer_load_dwordx4 v[80:83], v50, s[40:43], 0 offen offset:0 sc1
    v_mfma_f32_32x32x16_bf16 v[240:255], v[180:183], a[72:75], v[240:255]
    buffer_load_dwordx4 v[84:87], v50, s[40:43], 0 offen offset:512 sc1
    v_mfma_f32_32x32x16_bf16 v[224:239], v[184:187], a[76:79], v[224:239]
    buffer_load_dwordx4 v[88:91], v50, s[40:43], 0 offen offset:1024 sc1
    v_mfma_f32_32x32x16_bf16 v[240:255], v[188:191], a[76:79], v[240:255]
    buffer_load_dwordx4 v[92:95], v50, s[40:43], 0 offen offset:1536 sc1
    s_waitcnt vmcnt(8) lgkmcnt(0)
    s_barrier
    v_mfma_f32_32x32x16_bf16 v[224:239], v[192:195], a[80:83], v[224:239]
    ds_read_b128 v[160:163], v6 offset:0
    ds_read_b128 v[164:167], v6 offset:1024
    v_mfma_f32_32x32x16_bf16 v[240:255], v[196:199], a[80:83], v[240:255]
    ds_read_b128 v[168:171], v6 offset:2048
    ds_read_b128 v[172:175], v6 offset:3072
    v_mfma_f32_32x32x16_bf16 v[224:239], v[200:203], a[84:87], v[224:239]
    ds_read_b128 v[176:179], v6 offset:4096
    ds_read_b128 v[180:183], v6 offset:5120
    v_mfma_f32_32x32x16_bf16 v[240:255], v[204:207], a[84:87], v[240:255]
    ds_read_b128 v[184:187], v6 offset:6144
    ds_read_b128 v[188:191], v6 offset:7168
    v_mfma_f32_32x32x16_bf16 v[224:239], v[208:211], a[88:91], v[224:239]
    buffer_load_dwordx4 v40, s[32:35], s94 offen offset:3072 lds
    v_add_u32 v40, 0x20000, v40
    s_add_u32 m0, s62, 131072
    v_mfma_f32_32x32x16_bf16 v[240:255], v[212:215], a[88:91], v[240:255]
    buffer_load_dwordx4 v40, s[32:35], 0 offen offset:0 lds
    v_mfma_f32_32x32x16_bf16 v[224:239], v[216:219], a[92:95], v[224:239]
    buffer_load_dwordx4 v40, s[32:35], s92 offen offset:1024 lds
    v_mfma_f32_32x32x16_bf16 v[240:255], v[220:223], a[92:95], v[240:255]
    buffer_load_dwordx4 v40, s[32:35], s93 offen offset:2048 lds
    s_waitcnt vmcnt(9) lgkmcnt(0)
    s_barrier
    v_mfma_f32_32x32x16_bf16 v[224:239], v[160:163], a[96:99], v[224:239]
    ds_read_b128 v[192:195], v6 offset:8192
    ds_read_b128 v[196:199], v6 offset:9216
    v_mfma_f32_32x32x16_bf16 v[240:255], v[164:167], a[96:99], v[240:255]
    ds_read_b128 v[200:203], v6 offset:10240
    ds_read_b128 v[204:207], v6 offset:11264
    v_mfma_f32_32x32x16_bf16 v[224:239], v[168:171], a[100:103], v[224:239]
    ds_read_b128 v[208:211], v6 offset:12288
    ds_read_b128 v[212:215], v6 offset:13312
    v_mfma_f32_32x32x16_bf16 v[240:255], v[172:175], a[100:103], v[240:255]
    ds_read_b128 v[216:219], v6 offset:14336
    ds_read_b128 v[220:223], v6 offset:15360
    v_mfma_f32_32x32x16_bf16 v[224:239], v[176:179], a[104:107], v[224:239]
    buffer_load_dwordx4 v40, s[32:35], s94 offen offset:3072 lds
    v_add_u32 v40, 0x20000, v40
    s_add_u32 m0, s62, 147456
    v_mfma_f32_32x32x16_bf16 v[240:255], v[180:183], a[104:107], v[240:255]
    buffer_load_dwordx4 v40, s[32:35], 0 offen offset:0 lds
    v_mfma_f32_32x32x16_bf16 v[224:239], v[184:187], a[108:111], v[224:239]
    buffer_load_dwordx4 v40, s[32:35], s92 offen offset:1024 lds
    v_mfma_f32_32x32x16_bf16 v[240:255], v[188:191], a[108:111], v[240:255]
    buffer_load_dwordx4 v40, s[32:35], s93 offen offset:2048 lds
    s_waitcnt lgkmcnt(0)
    s_barrier
    v_mfma_f32_32x32x16_bf16 v[224:239], v[192:195], a[112:115], v[224:239]
    s_waitcnt vmcnt(8)
    v_lshlrev_b32 v128, 16, v80
    v_and_b32 v129, 0xffff0000, v80
    v_lshlrev_b32 v130, 16, v81
    v_mfma_f32_32x32x16_bf16 v[240:255], v[196:199], a[112:115], v[240:255]
    v_and_b32 v131, 0xffff0000, v81
    v_lshlrev_b32 v132, 16, v82
    v_and_b32 v133, 0xffff0000, v82
    v_lshlrev_b32 v134, 16, v83
    v_mfma_f32_32x32x16_bf16 v[224:239], v[200:203], a[116:119], v[224:239]
    v_and_b32 v135, 0xffff0000, v83
    v_lshlrev_b32 v136, 16, v84
    v_and_b32 v137, 0xffff0000, v84
    v_lshlrev_b32 v138, 16, v85
    v_mfma_f32_32x32x16_bf16 v[240:255], v[204:207], a[116:119], v[240:255]
    v_and_b32 v139, 0xffff0000, v85
    v_lshlrev_b32 v140, 16, v86
    v_and_b32 v141, 0xffff0000, v86
    v_lshlrev_b32 v142, 16, v87
    v_mfma_f32_32x32x16_bf16 v[224:239], v[208:211], a[120:123], v[224:239]
    buffer_load_dwordx4 v40, s[32:35], s94 offen offset:3072 lds
    v_and_b32 v143, 0xffff0000, v87
    v_lshlrev_b32 v144, 16, v88
    v_and_b32 v145, 0xffff0000, v88
    v_mfma_f32_32x32x16_bf16 v[240:255], v[212:215], a[120:123], v[240:255]
    v_lshlrev_b32 v146, 16, v89
    v_and_b32 v147, 0xffff0000, v89
    v_lshlrev_b32 v148, 16, v90
    v_and_b32 v149, 0xffff0000, v90
    v_mfma_f32_32x32x16_bf16 v[224:239], v[216:219], a[124:127], v[224:239]
    v_lshlrev_b32 v150, 16, v91
    v_and_b32 v151, 0xffff0000, v91
    v_lshlrev_b32 v152, 16, v92
    v_and_b32 v153, 0xffff0000, v92
    v_mfma_f32_32x32x16_bf16 v[240:255], v[220:223], a[124:127], v[240:255]
    v_lshlrev_b32 v154, 16, v93
    v_and_b32 v155, 0xffff0000, v93
    v_lshlrev_b32 v156, 16, v94
    v_and_b32 v157, 0xffff0000, v94
    v_lshlrev_b32 v158, 16, v95
    v_and_b32 v159, 0xffff0000, v95
    v_mul_f32 v128, v128, v96
    v_mul_f32 v129, v129, v97
    v_mul_f32 v130, v130, v98
    v_mul_f32 v131, v131, v99
    v_mul_f32 v132, v132, v100
    v_mul_f32 v133, v133, v101
    v_mul_f32 v134, v134, v102
    v_mul_f32 v135, v135, v103
    v_mul_f32 v136, v136, v104
    v_mul_f32 v137, v137, v105
    v_mul_f32 v138, v138, v106
    v_mul_f32 v139, v139, v107
    v_mul_f32 v140, v140, v108
    v_mul_f32 v141, v141, v109
    v_mul_f32 v142, v142, v110
    v_mul_f32 v143, v143, v111
    v_mul_f32 v144, v144, v112
    v_mul_f32 v145, v145, v113
    v_mul_f32 v146, v146, v114
    v_mul_f32 v147, v147, v115
    v_mul_f32 v148, v148, v116
    v_mul_f32 v149, v149, v117
    v_mul_f32 v150, v150, v118
    v_mul_f32 v151, v151, v119
    v_mul_f32 v152, v152, v120
    v_mul_f32 v153, v153, v121
    v_mul_f32 v154, v154, v122
    v_mul_f32 v155, v155, v123
    v_mul_f32 v156, v156, v124
    v_mul_f32 v157, v157, v125
    v_mul_f32 v158, v158, v126
    v_mul_f32 v159, v159, v127
    v_pk_fma_f32 v[128:129], v[224:225], v[96:97], v[128:129]
    v_pk_fma_f32 v[130:131], v[226:227], v[98:99], v[130:131]
    v_pk_fma_f32 v[132:133], v[228:229], v[100:101], v[132:133]
    v_pk_fma_f32 v[134:135], v[230:231], v[102:103], v[134:135]
    v_pk_fma_f32 v[136:137], v[232:233], v[104:105], v[136:137]
    v_pk_fma_f32 v[138:139], v[234:235], v[106:107], v[138:139]
    v_pk_fma_f32 v[140:141], v[236:237], v[108:109], v[140:141]
    v_pk_fma_f32 v[142:143], v[238:239], v[110:111], v[142:143]
    v_cvt_pk_bf16_f32 v80, v128, v129
    v_cvt_pk_bf16_f32 v81, v130, v131
    v_cvt_pk_bf16_f32 v82, v132, v133
    v_cvt_pk_bf16_f32 v83, v134, v135
    v_cvt_pk_bf16_f32 v84, v136, v137
    v_cvt_pk_bf16_f32 v85, v138, v139
    v_cvt_pk_bf16_f32 v86, v140, v141
    v_cvt_pk_bf16_f32 v87, v142, v143
    buffer_store_dwordx4 v[80:83], v50, s[40:43], 0 offen offset:0
    buffer_store_dwordx4 v[84:87], v50, s[40:43], 0 offen offset:512
    v_pk_fma_f32 v[144:145], v[240:241], v[112:113], v[144:145]
    v_pk_fma_f32 v[146:147], v[242:243], v[114:115], v[146:147]
    v_pk_fma_f32 v[148:149], v[244:245], v[116:117], v[148:149]
    v_pk_fma_f32 v[150:151], v[246:247], v[118:119], v[150:151]
    v_pk_fma_f32 v[152:153], v[248:249], v[120:121], v[152:153]
    v_pk_fma_f32 v[154:155], v[250:251], v[122:123], v[154:155]
    v_pk_fma_f32 v[156:157], v[252:253], v[124:125], v[156:157]
    v_pk_fma_f32 v[158:159], v[254:255], v[126:127], v[158:159]
    v_cvt_pk_bf16_f32 v88, v144, v145
    v_cvt_pk_bf16_f32 v89, v146, v147
    v_cvt_pk_bf16_f32 v90, v148, v149
    v_cvt_pk_bf16_f32 v91, v150, v151
    v_cvt_pk_bf16_f32 v92, v152, v153
    v_cvt_pk_bf16_f32 v93, v154, v155
    v_cvt_pk_bf16_f32 v94, v156, v157
    v_cvt_pk_bf16_f32 v95, v158, v159
    buffer_store_dwordx4 v[88:91], v50, s[40:43], 0 offen offset:1024
    buffer_store_dwordx4 v[92:95], v50, s[40:43], 0 offen offset:1536
    v_mov_b32 v1, v62
L_s7:
    s_barrier
    ds_read_b64_tr_b16 a[0:1], v26 offset:0
    ds_read_b64_tr_b16 a[2:3], v26 offset:1024
    ds_read_b64_tr_b16 a[4:5], v27 offset:0
    ds_read_b64_tr_b16 a[6:7], v27 offset:1024
    ds_read_b64_tr_b16 a[8:9], v28 offset:0
    ds_read_b64_tr_b16 a[10:11], v28 offset:1024
    ds_read_b64_tr_b16 a[12:13], v29 offset:0
    ds_read_b64_tr_b16 a[14:15], v29 offset:1024
    ds_read_b64_tr_b16 a[16:17], v26 offset:4096
    ds_read_b64_tr_b16 a[18:19], v26 offset:5120
    ds_read_b64_tr_b16 a[20:21], v27 offset:4096
    ds_read_b64_tr_b16 a[22:23], v27 offset:5120
    ds_read_b64_tr_b16 a[24:25], v28 offset:4096
    ds_read_b64_tr_b16 a[26:27], v28 offset:5120
    ds_read_b64_tr_b16 a[28:29], v29 offset:4096
    ds_read_b64_tr_b16 a[30:31], v29 offset:5120
    ds_read_b64_tr_b16 a[32:33], v26 offset:8192
    ds_read_b64_tr_b16 a[34:35], v26 offset:9216
    ds_read_b64_tr_b16 a[36:37], v27 offset:8192
    ds_read_b64_tr_b16 a[38:39], v27 offset:9216
    ds_read_b64_tr_b16 a[40:41], v28 offset:8192
    ds_read_b64_tr_b16 a[42:43], v28 offset:9216
    ds_read_b64_tr_b16 a[44:45], v29 offset:8192
    ds_read_b64_tr_b16 a[46:47], v29 offset:9216
    s_branch L_page8
    .p2align 12
L_pad8:
    s_setpc_b64 s[0:1]
    s_nop 0
L_page8:
    s_waitcnt vmcnt(0)
    buffer_store_dword v45, v1, s[40:43], 0 offen
    ds_read_b64_tr_b16 a[48:49], v26 offset:12288
    ds_read_b64_tr_b16 a[50:51], v26 offset:13312
    ds_read_b64_tr_b16 a[52:53], v27 offset:12288
    ds_read_b64_tr_b16 a[54:55], v27 offset:13312
    ds_read_b64_tr_b16 a[56:57], v28 offset:12288
    ds_read_b64_tr_b16 a[58:59], v28 offset:13312
    ds_read_b64_tr_b16 a[60:61], v29 offset:12288
    ds_read_b64_tr_b16 a[62:63], v29 offset:13312
    ds_read_b64_tr_b16 a[64:65], v26 offset:16384
    ds_read_b64_tr_b16 a[66:67], v26 offset:17408
    ds_read_b64_tr_b16 a[68:69], v27 offset:16384
    ds_read_b64_tr_b16 a[70:71], v27 offset:17408
    ds_read_b64_tr_b16 a[72:73], v28 offset:16384
    ds_read_b64_tr_b16 a[74:75], v28 offset:17408
    ds_read_b64_tr_b16 a[76:77], v29 offset:16384
    ds_read_b64_tr_b16 a[78:79], v29 offset:17408
    v_and_b32 v37, 15, v0
    v_min_u32 v37, 13, v37
    v_and_b32 v44, 0xffffff80, v44
    v_lshl_add_u32 v44, v37, 2, v44
    s_mov_b32 s58, 32768
    s_lshl_b32 s60, s49, 2
    s_add_u32 s60, s60, s44
    s_and_b32 s59, s60, 7
    s_mul_i32 s59, s59, 28672
    s_add_u32 s59, s59, s3
    buffer_load_dword v47, v44, s[40:43], s58 offen sc1
    ds_read_b64_tr_b16 a[80:81], v26 offset:20480
    ds_read_b64_tr_b16 a[82:83], v26 offset:21504
    ds_read_b64_tr_b16 a[84:85], v27 offset:20480
    ds_read_b64_tr_b16 a[86:87], v27 offset:21504
    ds_read_b64_tr_b16 a[88:89], v28 offset:20480
    ds_read_b64_tr_b16 a[90:91], v28 offset:21504
    ds_read_b64_tr_b16 a[92:93], v29 offset:20480
    ds_read_b64_tr_b16 a[94:95], v29 offset:21504
    ds_read_b64_tr_b16 a[96:97], v26 offset:24576
    ds_read_b64_tr_b16 a[98:99], v26 offset:25600
    ds_read_b64_tr_b16 a[100:101], v27 offset:24576
    ds_read_b64_tr_b16 a[102:103], v27 offset:25600
    ds_read_b64_tr_b16 a[104:105], v28 offset:24576
    ds_read_b64_tr_b16 a[106:107], v28 offset:25600
    ds_read_b64_tr_b16 a[108:109], v29 offset:24576
    ds_read_b64_tr_b16 a[110:111], v29 offset:25600
    ds_read_b64_tr_b16 a[112:113], v26 offset:28672
    ds_read_b64_tr_b16 a[114:115], v26 offset:29696
    ds_read_b64_tr_b16 a[116:117], v27 offset:28672
    ds_read_b64_tr_b16 a[118:119], v27 offset:29696
    v_lshlrev_b32 v128, 16, v18
    v_and_b32 v129, 0xffff0000, v18
    v_lshlrev_b32 v130, 16, v19
    v_and_b32 v131, 0xffff0000, v19
    v_lshlrev_b32 v132, 16, v20
    v_and_b32 v133, 0xffff0000, v20
    v_lshlrev_b32 v134, 16, v21
    v_and_b32 v135, 0xffff0000, v21
    v_lshlrev_b32 v136, 16, v22
    v_and_b32 v137, 0xffff0000, v22
    v_lshlrev_b32 v138, 16, v23
    v_and_b32 v139, 0xffff0000, v23
    v_lshlrev_b32 v140, 16, v24
    v_and_b32 v141, 0xffff0000, v24
    v_lshlrev_b32 v142, 16, v25
    v_and_b32 v143, 0xffff0000, v25
    s_mov_b32 s61, 0
    s_branch L_got_30
L_again_31:
    buffer_load_dword v47, v44, s[40:43], s58 offen sc1
    s_addk_i32 s61, 1
    s_cmp_gt_u32 s61, 0x80000
    s_cbranch_scc1 L_abort
    s_waitcnt vmcnt(0)
L_got_30:
    s_waitcnt vmcnt(0)
    v_cmp_ne_u32 vcc, s53, v47
    s_cbranch_vccnz L_again_31
    s_barrier
    buffer_load_dwordx4 v[144:147], v36, s[40:43], s59 offen offset:0 sc1
    ds_read_b64_tr_b16 a[120:121], v28 offset:28672
    ds_read_b64_tr_b16 a[122:123], v28 offset:29696
    ds_read_b64_tr_b16 a[124:125], v29 offset:28672
    ds_read_b64_tr_b16 a[126:127], v29 offset:29696
    ds_read_b64_tr_b16 a[128:129], v26 offset:32768
    ds_read_b64_tr_b16 a[130:131], v26 offset:33792
    buffer_load_dwordx4 v[148:151], v36, s[40:43], s59 offen offset:1024 sc1
    ds_read_b64_tr_b16 a[132:133], v27 offset:32768
    ds_read_b64_tr_b16 a[134:135], v27 offset:33792
    ds_read_b64_tr_b16 a[136:137], v28 offset:32768
    ds_read_b64_tr_b16 a[138:139], v28 offset:33792
    ds_read_b64_tr_b16 a[140:141], v29 offset:32768
    ds_read_b64_tr_b16 a[142:143], v29 offset:33792
    buffer_load_dwordx4 v[152:155], v36, s[40:43], s59 offen offset:2048 sc1
    ds_read_b64_tr_b16 a[144:145], v26 offset:36864
    ds_read_b64_tr_b16 a[146:147], v26 offset:37888
    ds_read_b64_tr_b16 a[148:149], v27 offset:36864
    ds_read_b64_tr_b16 a[150:151], v27 offset:37888
    ds_read_b64_tr_b16 a[152:153], v28 offset:36864
    ds_read_b64_tr_b16 a[154:155], v28 offset:37888
    buffer_load_dwordx4 v[156:159], v36, s[40:43], s59 offen offset:3072 sc1
    ds_read_b64_tr_b16 a[156:157], v29 offset:36864
    ds_read_b64_tr_b16 a[158:159], v29 offset:37888
    ds_read_b64_tr_b16 a[160:161], v26 offset:40960
    ds_read_b64_tr_b16 a[162:163], v26 offset:41984
    ds_read_b64_tr_b16 a[164:165], v27 offset:40960
    ds_read_b64_tr_b16 a[166:167], v27 offset:41984
    s_add_u32 s59, s59, 4096
    buffer_load_dwordx4 v[160:163], v36, s[40:43], s59 offen offset:0 sc1
    ds_read_b64_tr_b16 a[168:169], v28 offset:40960
    ds_read_b64_tr_b16 a[170:171], v28 offset:41984
    ds_read_b64_tr_b16 a[172:173], v29 offset:40960
    ds_read_b64_tr_b16 a[174:175], v29 offset:41984
    ds_read_b64_tr_b16 a[176:177], v26 offset:45056
    ds_read_b64_tr_b16 a[178:179], v26 offset:46080
    buffer_load_dwordx4 v[164:167], v36, s[40:43], s59 offen offset:1024 sc1
    buffer_load_dwordx4 v[168:171], v36, s[40:43], s59 offen offset:2048 sc1
    buffer_load_dwordx4 v[172:175], v36, s[40:43], s59 offen offset:3072 sc1
    s_add_u32 s59, s59, 4096
    buffer_load_dwordx4 v[176:179], v36, s[40:43], s59 offen offset:0 sc1
    buffer_load_dwordx4 v[180:183], v36, s[40:43], s59 offen offset:1024 sc1
    buffer_load_dwordx4 v[184:187], v36, s[40:43], s59 offen offset:2048 sc1
    ds_read_b64_tr_b16 a[180:181], v27 offset:45056
    ds_read_b64_tr_b16 a[182:183], v27 offset:46080
    ds_read_b64_tr_b16 a[184:185], v28 offset:45056
    ds_read_b64_tr_b16 a[186:187], v28 offset:46080
    ds_read_b64_tr_b16 a[188:189], v29 offset:45056
    ds_read_b64_tr_b16 a[190:191], v29 offset:46080
    ds_read_b64_tr_b16 a[192:193], v26 offset:49152
    ds_read_b64_tr_b16 a[194:195], v26 offset:50176
    ds_read_b64_tr_b16 a[196:197], v27 offset:49152
    ds_read_b64_tr_b16 a[198:199], v27 offset:50176
    ds_read_b64_tr_b16 a[200:201], v28 offset:49152
    ds_read_b64_tr_b16 a[202:203], v28 offset:50176
    ds_read_b64_tr_b16 a[204:205], v29 offset:49152
    ds_read_b64_tr_b16 a[206:207], v29 offset:50176
    ds_read_b64_tr_b16 a[208:209], v26 offset:53248
    ds_read_b64_tr_b16 a[210:211], v26 offset:54272
    ds_read_b64_tr_b16 a[212:213], v27 offset:53248
    ds_read_b64_tr_b16 a[214:215], v27 offset:54272
    ds_read_b64_tr_b16 a[216:217], v28 offset:53248
    ds_read_b64_tr_b16 a[218:219], v28 offset:54272
    ds_read_b64_tr_b16 a[220:221], v29 offset:53248
    ds_read_b64_tr_b16 a[222:223], v29 offset:54272
    ds_read_b64_tr_b16 a[224:225], v26 offset:57344
    ds_read_b64_tr_b16 a[226:227], v26 offset:58368
    ds_read_b64_tr_b16 a[228:229], v27 offset:57344
    ds_read_b64_tr_b16 a[230:231], v27 offset:58368
    ds_read_b64_tr_b16 a[232:233], v28 offset:57344
    ds_read_b64_tr_b16 a[234:235], v28 offset:58368
    ds_read_b64_tr_b16 a[236:237], v29 offset:57344
    ds_read_b64_tr_b16 a[238:239], v29 offset:58368
    s_waitcnt vmcnt(10) lgkmcnt(15)
    v_mfma_f32_16x16x32_bf16 v[128:131], a[0:3], v[144:147], v[128:131]
    buffer_load_dwordx4 v[188:191], v36, s[40:43], s59 offen offset:3072 sc1
    ds_read_b64_tr_b16 a[240:241], v26 offset:61440
    v_mfma_f32_16x16x32_bf16 v[132:135], a[4:7], v[144:147], v[132:135]
    ds_read_b64_tr_b16 a[242:243], v26 offset:62464
    s_waitcnt lgkmcnt(15)
    v_mfma_f32_16x16x32_bf16 v[136:139], a[8:11], v[144:147], v[136:139]
    ds_read_b64_tr_b16 a[244:245], v27 offset:61440
    v_mfma_f32_16x16x32_bf16 v[140:143], a[12:15], v[144:147], v[140:143]
    ds_read_b64_tr_b16 a[246:247], v27 offset:62464
    s_waitcnt vmcnt(10) lgkmcnt(15)
    v_mfma_f32_16x16x32_bf16 v[128:131], a[16:19], v[148:151], v[128:131]
    ds_read_b64_tr_b16 a[248:249], v28 offset:61440
    s_add_u32 s59, s59, 4096
    buffer_load_dwordx4 v[192:195], v36, s[40:43], s59 offen offset:0 sc1
    v_mfma_f32_16x16x32_bf16 v[132:135], a[20:23], v[148:151], v[132:135]
    ds_read_b64_tr_b16 a[250:251], v28 offset:62464
    s_waitcnt lgkmcnt(15)
    v_mfma_f32_16x16x32_bf16 v[136:139], a[24:27], v[148:151], v[136:139]
    ds_read_b64_tr_b16 a[252:253], v29 offset:61440
    v_mfma_f32_16x16x32_bf16 v[140:143], a[28:31], v[148:151], v[140:143]
    ds_read_b64_tr_b16 a[254:255], v29 offset:62464
    s_waitcnt vmcnt(10) lgkmcnt(15)
    v_mfma_f32_16x16x32_bf16 v[128:131], a[32:35], v[152:155], v[128:131]
    v_add_u32 v26, 0x10000, v26
    v_add_u32 v27, 0x10000, v27
    v_add_u32 v28, 0x10000, v28
    v_add_u32 v29, 0x10000, v29
    ds_read_b64_tr_b16 a[0:1], v26 offset:0
    buffer_load_dwordx4 v[196:199], v36, s[40:43], s59 offen offset:1024 sc1
    v_mfma_f32_16x16x32_bf16 v[132:135], a[36:39], v[152:155], v[132:135]
    ds_read_b64_tr_b16 a[2:3], v26 offset:1024
    s_waitcnt lgkmcnt(15)
    v_mfma_f32_16x16x32_bf16 v[136:139], a[40:43], v[152:155], v[136:139]
    ds_read_b64_tr_b16 a[4:5], v27 offset:0
    v_mfma_f32_16x16x32_bf16 v[140:143], a[44:47], v[152:155], v[140:143]
    ds_read_b64_tr_b16 a[6:7], v27 offset:1024
    s_waitcnt vmcnt(10) lgkmcnt(15)
    v_mfma_f32_16x16x32_bf16 v[128:131], a[48:51], v[156:159], v[128:131]
    ds_read_b64_tr_b16 a[8:9], v28 offset:0
    buffer_load_dwordx4 v[200:203], v36, s[40:43], s59 offen offset:2048 sc1
    v_mfma_f32_16x16x32_bf16 v[132:135], a[52:55], v[156:159], v[132:135]
    ds_read_b64_tr_b16 a[10:11], v28 offset:1024
    s_waitcnt lgkmcnt(15)
    v_mfma_f32_16x16x32_bf16 v[136:139], a[56:59], v[156:159], v[136:139]
    ds_read_b64_tr_b16 a[12:13], v29 offset:0
    v_mfma_f32_16x16x32_bf16 v[140:143], a[60:63], v[156:159], v[140:143]
    ds_read_b64_tr_b16 a[14:15], v29 offset:1024
    s_waitcnt vmcnt(10) lgkmcnt(15)
    v_mfma_f32_16x16x32_bf16 v[128:131], a[64:67], v[160:163], v[128:131]
    ds_read_b64_tr_b16 a[16:17], v26 offset:4096
    buffer_load_dwordx4 v[204:207], v36, s[40:43], s59 offen offset:3072 sc1
    v_mfma_f32_16x16x32_bf16 v[132:135], a[68:71], v[160:163], v[132:135]
    ds_read_b64_tr_b16 a[18:19], v26 offset:5120
    s_waitcnt lgkmcnt(15)
    v_mfma_f32_16x16x32_bf16 v[136:139], a[72:75], v[160:163], v[136:139]
    ds_read_b64_tr_b16 a[20:21], v27 offset:4096
    v_mfma_f32_16x16x32_bf16 v[140:143], a[76:79], v[160:163], v[140:143]
    ds_read_b64_tr_b16 a[22:23], v27 offset:5120
    s_waitcnt vmcnt(10) lgkmcnt(15)
    v_mfma_f32_16x16x32_bf16 v[128:131], a[80:83], v[164:167], v[128:131]
    ds_read_b64_tr_b16 a[24:25], v28 offset:4096
    s_add_u32 s59, s59, 4096
    buffer_load_dwordx4 v[208:211], v36, s[40:43], s59 offen offset:0 sc1
    v_mfma_f32_16x16x32_bf16 v[132:135], a[84:87], v[164:167], v[132:135]
    ds_read_b64_tr_b16 a[26:27], v28 offset:5120
    s_waitcnt lgkmcnt(15)
    v_mfma_f32_16x16x32_bf16 v[136:139], a[88:91], v[164:167], v[136:139]
    ds_read_b64_tr_b16 a[28:29], v29 offset:4096
    v_mfma_f32_16x16x32_bf16 v[140:143], a[92:95], v[164:167], v[140:143]
    ds_read_b64_tr_b16 a[30:31], v29 offset:5120
    s_waitcnt vmcnt(10) lgkmcnt(15)
    v_mfma_f32_16x16x32_bf16 v[128:131], a[96:99], v[168:171], v[128:131]
    ds_read_b64_tr_b16 a[32:33], v26 offset:8192
    buffer_load_dwordx4 v[212:215], v36, s[40:43], s59 offen offset:1024 sc1
    v_mfma_f32_16x16x32_bf16 v[132:135], a[100:103], v[168:171], v[132:135]
    ds_read_b64_tr_b16 a[34:35], v26 offset:9216
    s_waitcnt lgkmcnt(15)
    v_mfma_f32_16x16x32_bf16 v[136:139], a[104:107], v[168:171], v[136:139]
    ds_read_b64_tr_b16 a[36:37], v27 offset:8192
    v_mfma_f32_16x16x32_bf16 v[140:143], a[108:111], v[168:171], v[140:143]
    ds_read_b64_tr_b16 a[38:39], v27 offset:9216
    s_waitcnt vmcnt(10) lgkmcnt(15)
    v_mfma_f32_16x16x32_bf16 v[128:131], a[112:115], v[172:175], v[128:131]
    ds_read_b64_tr_b16 a[40:41], v28 offset:8192
    buffer_load_dwordx4 v[216:219], v36, s[40:43], s59 offen offset:2048 sc1
    v_mfma_f32_16x16x32_bf16 v[132:135], a[116:119], v[172:175], v[132:135]
    ds_read_b64_tr_b16 a[42:43], v28 offset:9216
    s_waitcnt lgkmcnt(15)
    v_mfma_f32_16x16x32_bf16 v[136:139], a[120:123], v[172:175], v[136:139]
    ds_read_b64_tr_b16 a[44:45], v29 offset:8192
    v_mfma_f32_16x16x32_bf16 v[140:143], a[124:127], v[172:175], v[140:143]
    ds_read_b64_tr_b16 a[46:47], v29 offset:9216
    s_waitcnt vmcnt(10) lgkmcnt(15)
    v_mfma_f32_16x16x32_bf16 v[128:131], a[128:131], v[176:179], v[128:131]
    ds_read_b64_tr_b16 a[48:49], v26 offset:12288
    buffer_load_dwordx4 v[220:223], v36, s[40:43], s59 offen offset:3072 sc1
    v_mfma_f32_16x16x32_bf16 v[132:135], a[132:135], v[176:179], v[132:135]
    ds_read_b64_tr_b16 a[50:51], v26 offset:13312
    s_waitcnt lgkmcnt(15)
    v_mfma_f32_16x16x32_bf16 v[136:139], a[136:139], v[176:179], v[136:139]
    ds_read_b64_tr_b16 a[52:53], v27 offset:12288
    v_mfma_f32_16x16x32_bf16 v[140:143], a[140:143], v[176:179], v[140:143]
    ds_read_b64_tr_b16 a[54:55], v27 offset:13312
    s_waitcnt vmcnt(10) lgkmcnt(15)
    v_mfma_f32_16x16x32_bf16 v[128:131], a[144:147], v[180:183], v[128:131]
    ds_read_b64_tr_b16 a[56:57], v28 offset:12288
    s_add_u32 s59, s59, 4096
    buffer_load_dwordx4 v[224:227], v36, s[40:43], s59 offen offset:0 sc1
    v_mfma_f32_16x16x32_bf16 v[132:135], a[148:151], v[180:183], v[132:135]
    ds_read_b64_tr_b16 a[58:59], v28 offset:13312
    s_waitcnt lgkmcnt(15)
    v_mfma_f32_16x16x32_bf16 v[136:139], a[152:155], v[180:183], v[136:139]
    ds_read_b64_tr_b16 a[60:61], v29 offset:12288
    v_mfma_f32_16x16x32_bf16 v[140:143], a[156:159], v[180:183], v[140:143]
    ds_read_b64_tr_b16 a[62:63], v29 offset:13312
    s_waitcnt vmcnt(10) lgkmcnt(15)
    v_mfma_f32_16x16x32_bf16 v[128:131], a[160:163], v[184:187], v[128:131]
    v_add_u32 v26, 0x8000, v26
    v_add_u32 v27, 0x8000, v27
    v_add_u32 v28, 0x8000, v28
    v_add_u32 v29, 0x8000, v29
    ds_read_b64_tr_b16 a[64:65], v26 offset:32768
    buffer_load_dwordx4 v[228:231], v36, s[40:43], s59 offen offset:1024 sc1
    v_mfma_f32_16x16x32_bf16 v[132:135], a[164:167], v[184:187], v[132:135]
    ds_read_b64_tr_b16 a[66:67], v26 offset:33792
    s_waitcnt lgkmcnt(15)
    v_mfma_f32_16x16x32_bf16 v[136:139], a[168:171], v[184:187], v[136:139]
    ds_read_b64_tr_b16 a[68:69], v27 offset:32768
    v_mfma_f32_16x16x32_bf16 v[140:143], a[172:175], v[184:187], v[140:143]
    ds_read_b64_tr_b16 a[70:71], v27 offset:33792
    s_waitcnt vmcnt(10) lgkmcnt(15)
    v_mfma_f32_16x16x32_bf16 v[128:131], a[176:179], v[188:191], v[128:131]
    ds_read_b64_tr_b16 a[72:73], v28 offset:32768
    buffer_load_dwordx4 v[232:235], v36, s[40:43], s59 offen offset:2048 sc1
    v_mfma_f32_16x16x32_bf16 v[132:135], a[180:183], v[188:191], v[132:135]
    ds_read_b64_tr_b16 a[74:75], v28 offset:33792
    s_waitcnt lgkmcnt(15)
    v_mfma_f32_16x16x32_bf16 v[136:139], a[184:187], v[188:191], v[136:139]
    ds_read_b64_tr_b16 a[76:77], v29 offset:32768
    v_mfma_f32_16x16x32_bf16 v[140:143], a[188:191], v[188:191], v[140:143]
    ds_read_b64_tr_b16 a[78:79], v29 offset:33792
    s_waitcnt vmcnt(10) lgkmcnt(15)
    v_mfma_f32_16x16x32_bf16 v[128:131], a[192:195], v[192:195], v[128:131]
    ds_read_b64_tr_b16 a[80:81], v26 offset:36864
    buffer_load_dwordx4 v[236:239], v36, s[40:43], s59 offen offset:3072 sc1
    v_mfma_f32_16x16x32_bf16 v[132:135], a[196:199], v[192:195], v[132:135]
    ds_read_b64_tr_b16 a[82:83], v26 offset:37888
    s_waitcnt lgkmcnt(15)
    v_mfma_f32_16x16x32_bf16 v[136:139], a[200:203], v[192:195], v[136:139]
    ds_read_b64_tr_b16 a[84:85], v27 offset:36864
    v_mfma_f32_16x16x32_bf16 v[140:143], a[204:207], v[192:195], v[140:143]
    ds_read_b64_tr_b16 a[86:87], v27 offset:37888
    s_waitcnt vmcnt(10) lgkmcnt(15)
    v_mfma_f32_16x16x32_bf16 v[128:131], a[208:211], v[196:199], v[128:131]
    ds_read_b64_tr_b16 a[88:89], v28 offset:36864
    s_add_u32 s59, s59, 4096
    buffer_load_dwordx4 v[240:243], v36, s[40:43], s59 offen offset:0 sc1
    v_mfma_f32_16x16x32_bf16 v[132:135], a[212:215], v[196:199], v[132:135]
    ds_read_b64_tr_b16 a[90:91], v28 offset:37888
    s_waitcnt lgkmcnt(15)
    v_mfma_f32_16x16x32_bf16 v[136:139], a[216:219], v[196:199], v[136:139]
    ds_read_b64_tr_b16 a[92:93], v29 offset:36864
    v_mfma_f32_16x16x32_bf16 v[140:143], a[220:223], v[196:199], v[140:143]
    ds_read_b64_tr_b16 a[94:95], v29 offset:37888
    s_waitcnt vmcnt(10) lgkmcnt(15)
    v_mfma_f32_16x16x32_bf16 v[128:131], a[224:227], v[200:203], v[128:131]
    ds_read_b64_tr_b16 a[96:97], v26 offset:40960
    buffer_load_dwordx4 v[244:247], v36, s[40:43], s59 offen offset:1024 sc1
    v_mfma_f32_16x16x32_bf16 v[132:135], a[228:231], v[200:203], v[132:135]
    ds_read_b64_tr_b16 a[98:99], v26 offset:41984
    s_waitcnt lgkmcnt(15)
    v_mfma_f32_16x16x32_bf16 v[136:139], a[232:235], v[200:203], v[136:139]
    ds_read_b64_tr_b16 a[100:101], v27 offset:40960
    v_mfma_f32_16x16x32_bf16 v[140:143], a[236:239], v[200:203], v[140:143]
    ds_read_b64_tr_b16 a[102:103], v27 offset:41984
    s_waitcnt vmcnt(10) lgkmcnt(15)
    v_mfma_f32_16x16x32_bf16 v[128:131], a[240:243], v[204:207], v[128:131]
    ds_read_b64_tr_b16 a[104:105], v28 offset:40960
    buffer_load_dwordx4 v[248:251], v36, s[40:43], s59 offen offset:2048 sc1
    v_mfma_f32_16x16x32_bf16 v[132:135], a[244:247], v[204:207], v[132:135]
    ds_read_b64_tr_b16 a[106:107], v28 offset:41984
    s_waitcnt lgkmcnt(15)
    v_mfma_f32_16x16x32_bf16 v[136:139], a[248:251], v[204:207], v[136:139]
    ds_read_b64_tr_b16 a[108:109], v29 offset:40960
    v_mfma_f32_16x16x32_bf16 v[140:143], a[252:255], v[204:207], v[140:143]
    ds_read_b64_tr_b16 a[110:111], v29 offset:41984
    s_waitcnt vmcnt(10) lgkmcnt(15)
    v_mfma_f32_16x16x32_bf16 v[128:131], a[0:3], v[208:211], v[128:131]
    ds_read_b64_tr_b16 a[112:113], v26 offset:45056
    buffer_load_dwordx4 v[252:255], v36, s[40:43], s59 offen offset:3072 sc1
    v_mfma_f32_16x16x32_bf16 v[132:135], a[4:7], v[208:211], v[132:135]
    ds_read_b64_tr_b16 a[114:115], v26 offset:46080
    s_waitcnt lgkmcnt(15)
    v_mfma_f32_16x16x32_bf16 v[136:139], a[8:11], v[208:211], v[136:139]
    ds_read_b64_tr_b16 a[116:117], v27 offset:45056
    v_mfma_f32_16x16x32_bf16 v[140:143], a[12:15], v[208:211], v[140:143]
    ds_read_b64_tr_b16 a[118:119], v27 offset:46080
    s_waitcnt vmcnt(10) lgkmcnt(15)
    v_mfma_f32_16x16x32_bf16 v[128:131], a[16:19], v[212:215], v[128:131]
    ds_read_b64_tr_b16 a[120:121], v28 offset:45056
    s_mul_i32 s58, s44, 2304
    s_add_u32 s58, s58, 81920
    v_lshrrev_b32 v1, 4, v0
    v_mfma_f32_16x16x32_bf16 v[132:135], a[20:23], v[212:215], v[132:135]
    ds_read_b64_tr_b16 a[122:123], v28 offset:46080
    s_waitcnt lgkmcnt(15)
    v_mfma_f32_16x16x32_bf16 v[136:139], a[24:27], v[212:215], v[136:139]
    ds_read_b64_tr_b16 a[124:125], v29 offset:45056
    v_mfma_f32_16x16x32_bf16 v[140:143], a[28:31], v[212:215], v[140:143]
    ds_read_b64_tr_b16 a[126:127], v29 offset:46080
    s_waitcnt vmcnt(9) lgkmcnt(15)
    v_mfma_f32_16x16x32_bf16 v[128:131], a[32:35], v[216:219], v[128:131]
    ds_read_b64_tr_b16 a[128:129], v26 offset:49152
    s_cmp_eq_u32 s96, 56
    s_cbranch_scc1 L_wb_32_y
    buffer_load_dword v2, v39, s[40:43], 0 offen
L_wb_32:
    v_lshl_add_u32 v54, v1, 3, s58
    v_and_b32 v1, 15, v0
    v_mul_u32_u24 v1, 144, v1
    v_mfma_f32_16x16x32_bf16 v[132:135], a[36:39], v[216:219], v[132:135]
    ds_read_b64_tr_b16 a[130:131], v26 offset:50176
    s_waitcnt lgkmcnt(15)
    v_mfma_f32_16x16x32_bf16 v[136:139], a[40:43], v[216:219], v[136:139]
    ds_read_b64_tr_b16 a[132:133], v27 offset:49152
    v_mfma_f32_16x16x32_bf16 v[140:143], a[44:47], v[216:219], v[140:143]
    ds_read_b64_tr_b16 a[134:135], v27 offset:50176
    s_waitcnt vmcnt(9) lgkmcnt(15)
    v_mfma_f32_16x16x32_bf16 v[128:131], a[48:51], v[220:223], v[128:131]
    ds_read_b64_tr_b16 a[136:137], v28 offset:49152
    v_add_u32 v54, v54, v1
    v_and_b32 v1, 7, v0
    v_lshlrev_b32 v37, 4, v1
    v_mfma_f32_16x16x32_bf16 v[132:135], a[52:55], v[220:223], v[132:135]
    ds_read_b64_tr_b16 a[138:139], v28 offset:50176
    s_waitcnt lgkmcnt(15)
    v_mfma_f32_16x16x32_bf16 v[136:139], a[56:59], v[220:223], v[136:139]
    ds_read_b64_tr_b16 a[140:141], v29 offset:49152
    v_mfma_f32_16x16x32_bf16 v[140:143], a[60:63], v[220:223], v[140:143]
    ds_read_b64_tr_b16 a[142:143], v29 offset:50176
    s_waitcnt vmcnt(8) lgkmcnt(15)
    v_mfma_f32_16x16x32_bf16 v[128:131], a[64:67], v[224:227], v[128:131]
    ds_read_b64_tr_b16 a[144:145], v26 offset:53248
    v_lshl_add_u32 v55, v37, 0, s58
    v_lshrrev_b32 v1, 3, v0
    v_mul_u32_u24 v1, 144, v1
    v_mfma_f32_16x16x32_bf16 v[132:135], a[68:71], v[224:227], v[132:135]
    ds_read_b64_tr_b16 a[146:147], v26 offset:54272
    s_waitcnt lgkmcnt(15)
    v_mfma_f32_16x16x32_bf16 v[136:139], a[72:75], v[224:227], v[136:139]
    ds_read_b64_tr_b16 a[148:149], v27 offset:53248
    v_mfma_f32_16x16x32_bf16 v[140:143], a[76:79], v[224:227], v[140:143]
    ds_read_b64_tr_b16 a[150:151], v27 offset:54272
    s_waitcnt vmcnt(7) lgkmcnt(15)
    v_mfma_f32_16x16x32_bf16 v[128:131], a[80:83], v[228:231], v[128:131]
    ds_read_b64_tr_b16 a[152:153], v28 offset:53248
    v_add_u32 v55, v55, v1
    v_lshlrev_b32 v56, 0, v37
    v_lshrrev_b32 v1, 3, v0
    v_mfma_f32_16x16x32_bf16 v[132:135], a[84:87], v[228:231], v[132:135]
    ds_read_b64_tr_b16 a[154:155], v28 offset:54272
    s_waitcnt lgkmcnt(15)
    v_mfma_f32_16x16x32_bf16 v[136:139], a[88:91], v[228:231], v[136:139]
    ds_read_b64_tr_b16 a[156:157], v29 offset:53248
    v_mfma_f32_16x16x32_bf16 v[140:143], a[92:95], v[228:231], v[140:143]
    ds_read_b64_tr_b16 a[158:159], v29 offset:54272
    s_waitcnt vmcnt(6) lgkmcnt(15)
    v_mfma_f32_16x16x32_bf16 v[128:131], a[96:99], v[232:235], v[128:131]
    ds_read_b64_tr_b16 a[160:161], v26 offset:57344
    v_lshl_add_u32 v56, v1, 10, v56
    s_lshl_b32 s58, s60, 14
    s_lshl_b32 s91, s63, 7
    v_mfma_f32_16x16x32_bf16 v[132:135], a[100:103], v[232:235], v[132:135]
    ds_read_b64_tr_b16 a[162:163], v26 offset:58368
    s_waitcnt lgkmcnt(15)
    v_mfma_f32_16x16x32_bf16 v[136:139], a[104:107], v[232:235], v[136:139]
    ds_read_b64_tr_b16 a[164:165], v27 offset:57344
    v_mfma_f32_16x16x32_bf16 v[140:143], a[108:111], v[232:235], v[140:143]
    ds_read_b64_tr_b16 a[166:167], v27 offset:58368
    s_waitcnt vmcnt(5) lgkmcnt(15)
    v_mfma_f32_16x16x32_bf16 v[128:131], a[112:115], v[236:239], v[128:131]
    ds_read_b64_tr_b16 a[168:169], v28 offset:57344
    s_add_u32 s58, s58, s91
    s_add_u32 s60, s58, 8192
    v_mfma_f32_16x16x32_bf16 v[132:135], a[116:119], v[236:239], v[132:135]
    ds_read_b64_tr_b16 a[170:171], v28 offset:58368
    s_waitcnt lgkmcnt(15)
    v_mfma_f32_16x16x32_bf16 v[136:139], a[120:123], v[236:239], v[136:139]
    ds_read_b64_tr_b16 a[172:173], v29 offset:57344
    v_mfma_f32_16x16x32_bf16 v[140:143], a[124:127], v[236:239], v[140:143]
    ds_read_b64_tr_b16 a[174:175], v29 offset:58368
    s_waitcnt vmcnt(4) lgkmcnt(15)
    v_mfma_f32_16x16x32_bf16 v[128:131], a[128:131], v[240:243], v[128:131]
    ds_read_b64_tr_b16 a[176:177], v26 offset:61440
    v_mfma_f32_16x16x32_bf16 v[132:135], a[132:135], v[240:243], v[132:135]
    ds_read_b64_tr_b16 a[178:179], v26 offset:62464
    s_waitcnt lgkmcnt(15)
    v_mfma_f32_16x16x32_bf16 v[136:139], a[136:139], v[240:243], v[136:139]
    ds_read_b64_tr_b16 a[180:181], v27 offset:61440
    v_mfma_f32_16x16x32_bf16 v[140:143], a[140:143], v[240:243], v[140:143]
    ds_read_b64_tr_b16 a[182:183], v27 offset:62464
    s_waitcnt vmcnt(3) lgkmcnt(15)
    v_mfma_f32_16x16x32_bf16 v[128:131], a[144:147], v[244:247], v[128:131]
    ds_read_b64_tr_b16 a[184:185], v28 offset:61440
    v_mfma_f32_16x16x32_bf16 v[132:135], a[148:151], v[244:247], v[132:135]
    ds_read_b64_tr_b16 a[186:187], v28 offset:62464
    s_waitcnt lgkmcnt(14)
    v_mfma_f32_16x16x32_bf16 v[136:139], a[152:155], v[244:247], v[136:139]
    ds_read_b64_tr_b16 a[188:189], v29 offset:61440
    v_mfma_f32_16x16x32_bf16 v[140:143], a[156:159], v[244:247], v[140:143]
    ds_read_b64_tr_b16 a[190:191], v29 offset:62464
    s_waitcnt vmcnt(2) lgkmcnt(12)
    v_mfma_f32_16x16x32_bf16 v[128:131], a[160:163], v[248:251], v[128:131]
    v_mfma_f32_16x16x32_bf16 v[132:135], a[164:167], v[248:251], v[132:135]
    s_waitcnt lgkmcnt(8)
    v_mfma_f32_16x16x32_bf16 v[136:139], a[168:171], v[248:251], v[136:139]
    v_mfma_f32_16x16x32_bf16 v[140:143], a[172:175], v[248:251], v[140:143]
    s_waitcnt vmcnt(1) lgkmcnt(4)
    v_mfma_f32_16x16x32_bf16 v[128:131], a[176:179], v[252:255], v[128:131]
    v_mfma_f32_16x16x32_bf16 v[132:135], a[180:183], v[252:255], v[132:135]
    s_waitcnt lgkmcnt(0)
    v_mfma_f32_16x16x32_bf16 v[136:139], a[184:187], v[252:255], v[136:139]
    v_mfma_f32_16x16x32_bf16 v[140:143], a[188:191], v[252:255], v[140:143]
    s_nop 3
    v_cvt_pk_bf16_f32 v18, v128, v129
    v_cvt_pk_bf16_f32 v19, v130, v131
    v_cvt_pk_bf16_f32 v20, v132, v133
    v_cvt_pk_bf16_f32 v21, v134, v135
    v_cvt_pk_bf16_f32 v22, v136, v137
    v_cvt_pk_bf16_f32 v23, v138, v139
    v_cvt_pk_bf16_f32 v24, v140, v141
    v_cvt_pk_bf16_f32 v25, v142, v143
    ds_write_b64 v54, v[18:19] offset:0
    ds_write_b64 v54, v[20:21] offset:32
    ds_write_b64 v54, v[22:23] offset:64
    ds_write_b64 v54, v[24:25] offset:96
    ds_read_b128 v[128:131], v55 offset:0
    ds_read_b128 v[132:135], v55 offset:1152
    s_waitcnt lgkmcnt(1)
    buffer_store_dwordx4 v[128:131], v56, s[36:39], s58 offen sc1 nt
    s_waitcnt lgkmcnt(0)
    buffer_store_dwordx4 v[132:135], v56, s[36:39], s60 offen sc1 nt
L_abort:
L_end:
    s_endpgm
L_retry_1:
    s_mov_b32 s61, 0
L_again_3:
    buffer_load_dwordx2 v[90:91], v81, s[40:43], 0 offen sc1
    s_addk_i32 s61, 1
    s_cmp_gt_u32 s61, 0x80000
    s_cbranch_scc1 L_abort
    s_waitcnt vmcnt(0)
    v_xor_b32 v91, s54, v91
    v_lshrrev_b32 v37, 3, v91
    v_xor_b32 v90, s53, v90
    v_or_b32 v37, v37, v90
    v_cmp_ne_u32 vcc, 0, v37
    s_cbranch_vccnz L_again_3
    s_branch L_got_2
L_retry_4:
    s_mov_b32 s61, 0
L_again_6:
    buffer_load_dwordx2 v[248:249], v57, s[40:43], 0 offen offset:0 sc1
    buffer_load_dwordx2 v[250:251], v57, s[40:43], 0 offen offset:272 sc1
    buffer_load_dwordx2 v[252:253], v59, s[40:43], 0 offen offset:0 sc1
    buffer_load_dwordx2 v[254:255], v59, s[40:43], 0 offen offset:272 sc1
    v_mov_b32 v52, 0
    v_mov_b32 v53, 0
    v_mov_b32 v54, 0
    v_mov_b32 v55, 0
    s_addk_i32 s61, 1
    s_cmp_gt_u32 s61, 0x80000
    s_cbranch_scc1 L_abort
    s_waitcnt vmcnt(0)
    v_dot2c_f32_bf16 v52, s55, v248
    v_dot2c_f32_bf16 v53, s56, v248
    v_dot2c_f32_bf16 v54, s55, v249
    v_dot2c_f32_bf16 v55, s56, v249
    v_dot2c_f32_bf16 v52, s55, v250
    v_dot2c_f32_bf16 v53, s56, v250
    v_dot2c_f32_bf16 v54, s55, v251
    v_dot2c_f32_bf16 v55, s56, v251
    v_dot2c_f32_bf16 v52, s55, v252
    v_dot2c_f32_bf16 v53, s56, v252
    v_dot2c_f32_bf16 v54, s55, v253
    v_dot2c_f32_bf16 v55, s56, v253
    v_dot2c_f32_bf16 v52, s55, v254
    v_dot2c_f32_bf16 v53, s56, v254
    v_dot2c_f32_bf16 v54, s55, v255
    v_dot2c_f32_bf16 v55, s56, v255
    v_cmp_u_f32 vcc, v52, v52
    v_cvt_pk_bf16_f32 v248, v52, v53
    s_nop 0
    v_cvt_pk_bf16_f32 v249, v54, v55
    s_cbranch_vccnz L_again_6
    s_branch L_got_5
L_retry_16:
    s_mov_b32 s61, 0
L_again_18:
    buffer_load_dwordx2 v[54:55], v48, s[40:43], 0 offen offset:0 sc1
    buffer_load_dwordx2 v[56:57], v48, s[40:43], 0 offen offset:256 sc1
    buffer_load_dwordx2 v[58:59], v48, s[40:43], 0 offen offset:512 sc1
    buffer_load_dwordx2 v[60:61], v48, s[40:43], 0 offen offset:768 sc1
    s_addk_i32 s61, 1
    s_cmp_gt_u32 s61, 0x80000
    s_cbranch_scc1 L_abort
    s_waitcnt vmcnt(0)
    v_add_f32 v54, v54, v56
    v_add_f32 v58, v58, v60
    v_add_f32 v4, v54, v58
    v_add_f32 v55, v55, v57
    v_add_f32 v59, v59, v61
    v_add_f32 v5, v55, v59
    v_cmp_u_f32 vcc, v4, v5
    s_cbranch_vccnz L_again_18
    s_branch L_got_17
L_retry_22:
    s_mov_b32 s61, 0
L_again_24:
    buffer_load_dword v47, v62, s[40:43], 0 offen sc1
    s_addk_i32 s61, 1
    s_cmp_gt_u32 s61, 0x80000
    s_cbranch_scc1 L_abort
    s_waitcnt vmcnt(0)
    v_cmp_ne_u32 vcc, s53, v47
    s_cbranch_vccnz L_again_24
    s_branch L_got_23
L_retry_25:
    s_mov_b32 s61, 0
L_again_27:
    buffer_load_dword v47, v49, s[40:43], 0 offen sc1
    s_addk_i32 s61, 1
    s_cmp_gt_u32 s61, 0x80000
    s_cbranch_scc1 L_abort
    s_waitcnt vmcnt(0)
    v_cmp_ne_u32 vcc, s53, v47
    s_cbranch_vccnz L_again_27
    s_branch L_got_26
L_spare:
    s_lshl_b32 s59, s99, 2
    s_add_u32 s59, s59, s44
    s_and_b32 s58, s50, 1
    s_lshl_b32 s58, s58, 3
    s_add_u32 s58, s58, s59
    s_barrier
    v_and_b32 v1, 3, v0
    v_lshlrev_b32 v46, 0, v1
    v_min_u32 v46, 2, v46
    v_lshlrev_b32 v46, 9, v46
    v_lshrrev_b32 v1, 2, v0
    v_mul_u32_u24 v1, 3584, v1
    v_add_u32 v46, v46, v1
    v_add_u32 v46, 384, v46
    s_mul_i32 s88, s58, 114688
    s_add_u32 s97, s88, 0
    buffer_load_dword v2, v46, s[4:7], s97 offen sc1
    s_barrier
    v_and_b32 v1, 1, v0
    v_lshlrev_b32 v46, 7, v1
    v_lshrrev_b32 v1, 1, v0
    v_lshl_add_u32 v46, v1, 12, v46
    s_lshl_b32 s88, s95, 17
    s_lshl_b32 s91, s99, 11
    s_add_u32 s88, s88, s91
    s_add_u32 s97, s88, 0
    buffer_load_dword v2, v46, s[24:27], s97 offen sc1
    s_barrier
    v_and_b32 v1, 3, v0
    v_lshlrev_b32 v46, 0, v1
    v_min_u32 v46, 2, v46
    v_lshlrev_b32 v46, 9, v46
    v_lshrrev_b32 v1, 2, v0
    v_mul_u32_u24 v1, 3584, v1
    v_add_u32 v46, v46, v1
    v_add_u32 v46, 384, v46
    s_mul_i32 s88, s58, 114688
    s_add_u32 s97, s88, 57344
    buffer_load_dword v2, v46, s[4:7], s97 offen sc1
    s_barrier
    v_and_b32 v1, 1, v0
    v_lshlrev_b32 v46, 7, v1
    v_lshrrev_b32 v1, 1, v0
    v_lshl_add_u32 v46, v1, 12, v46
    s_lshl_b32 s88, s95, 17
    s_lshl_b32 s91, s99, 11
    s_add_u32 s88, s88, s91
    s_add_u32 s97, s88, 256
    buffer_load_dword v2, v46, s[24:27], s97 offen sc1
    s_barrier
    s_add_u32 s97, s88, 512
    buffer_load_dword v2, v46, s[24:27], s97 offen sc1
    s_barrier
    s_add_u32 s97, s88, 768
    buffer_load_dword v2, v46, s[24:27], s97 offen sc1
    s_getpc_b64 s[14:15]
L_pc_28:
    s_sub_u32 s14, s14, L_pc_28-L_s4
    s_subb_u32 s15, s15, 0
    s_lshl_b32 s97, s58, 11
    v_and_b32 v1, 15, v0
    v_lshl_add_u32 v46, v1, 7, s97
    v_min_u32 v46, L_end-L_s4, v46
    global_load_dword v2, v46, s[14:15] sc1
    s_barrier
    v_and_b32 v1, 1, v0
    v_lshlrev_b32 v46, 7, v1
    v_lshrrev_b32 v1, 1, v0
    v_lshl_add_u32 v46, v1, 12, v46
    s_lshl_b32 s88, s95, 17
    s_lshl_b32 s91, s99, 11
    s_add_u32 s88, s88, s91
    s_add_u32 s97, s88, 1024
    buffer_load_dword v2, v46, s[24:27], s97 offen sc1
    s_barrier
    s_add_u32 s97, s88, 1280
    buffer_load_dword v2, v46, s[24:27], s97 offen sc1
    s_barrier
    s_add_u32 s97, s88, 1536
    buffer_load_dword v2, v46, s[24:27], s97 offen sc1
    s_barrier
    s_add_u32 s97, s88, 1792
    buffer_load_dword v2, v46, s[24:27], s97 offen sc1
    s_barrier
    v_lshlrev_b32 v46, 7, v0
    s_lshl_b32 s88, s3, 0
    s_lshl_b32 s91, s59, 14
    s_add_u32 s88, s88, s91
    s_add_u32 s97, s88, 0
    buffer_load_dword v2, v46, s[40:43], s97 offen sc1
    s_barrier
    s_add_u32 s97, s88, 8192
    buffer_load_dword v2, v46, s[40:43], s97 offen sc1
    v_and_b32 v1, 3, v0
    v_lshlrev_b32 v46, 7, v1
    s_lshl_b32 s88, s50, 9
    s_add_u32 s88, s88, 32768
    s_add_u32 s97, s88, 0
    buffer_load_dword v2, v46, s[40:43], s97 offen sc1
    v_lshlrev_b32 v46, 0, v0
    v_min_u32 v46, 13, v46
    v_lshlrev_b32 v46, 7, v46
    s_lshl_b32 s88, s50, 11
    s_add_u32 s88, s88, 40960
    s_add_u32 s97, s88, 0
    buffer_load_dword v2, v46, s[40:43], s97 offen sc1
    s_barrier
    v_lshlrev_b32 v46, 0, v0
    v_min_u32 v46, 55, v46
    v_lshlrev_b32 v46, 7, v46
    s_mul_i32 s88, s50, 57344
    s_mul_i32 s91, s59, 7168
    s_add_u32 s88, s88, s91
    s_add_u32 s97, s88, 0
    buffer_load_dword v2, v46, s[32:35], s97 offen sc1
    s_add_u32 m0, s62, 0
    s_mov_b32 s92, 3072
    s_mov_b32 s93, 14336
    s_mov_b32 s94, 17408
    buffer_load_dwordx4 v40, s[32:35], 0 offen offset:0 lds
    buffer_load_dwordx4 v40, s[32:35], s92 offen offset:1024 lds
    buffer_load_dwordx4 v40, s[32:35], s93 offen offset:2048 lds
    buffer_load_dwordx4 v40, s[32:35], s94 offen offset:3072 lds
    v_add_u32 v40, 0x20000, v40
    s_add_u32 m0, s62, 16384
    s_nop 0
    buffer_load_dwordx4 v40, s[32:35], 0 offen offset:0 lds
    buffer_load_dwordx4 v40, s[32:35], s92 offen offset:1024 lds
    buffer_load_dwordx4 v40, s[32:35], s93 offen offset:2048 lds
    buffer_load_dwordx4 v40, s[32:35], s94 offen offset:3072 lds
    v_add_u32 v40, 0x20000, v40
    s_add_u32 m0, s62, 32768
    s_nop 0
    buffer_load_dwordx4 v40, s[32:35], 0 offen offset:0 lds
    buffer_load_dwordx4 v40, s[32:35], s92 offen offset:1024 lds
    buffer_load_dwordx4 v40, s[32:35], s93 offen offset:2048 lds
    buffer_load_dwordx4 v40, s[32:35], s94 offen offset:3072 lds
    v_add_u32 v40, 0x20000, v40
    s_add_u32 m0, s62, 49152
    s_nop 0
    buffer_load_dwordx4 v40, s[32:35], 0 offen offset:0 lds
    buffer_load_dwordx4 v40, s[32:35], s92 offen offset:1024 lds
    buffer_load_dwordx4 v40, s[32:35], s93 offen offset:2048 lds
    buffer_load_dwordx4 v40, s[32:35], s94 offen offset:3072 lds
    v_add_u32 v40, 0x20000, v40
    s_add_u32 m0, s62, 65536
    s_nop 0
    buffer_load_dwordx4 v40, s[32:35], 0 offen offset:0 lds
    buffer_load_dwordx4 v40, s[32:35], s92 offen offset:1024 lds
    buffer_load_dwordx4 v40, s[32:35], s93 offen offset:2048 lds
    buffer_load_dwordx4 v40, s[32:35], s94 offen offset:3072 lds
    v_add_u32 v40, 0x20000, v40
    s_add_u32 m0, s62, 131072
    s_nop 0
    buffer_load_dwordx4 v40, s[32:35], 0 offen offset:0 lds
    buffer_load_dwordx4 v40, s[32:35], s92 offen offset:1024 lds
    buffer_load_dwordx4 v40, s[32:35], s93 offen offset:2048 lds
    buffer_load_dwordx4 v40, s[32:35], s94 offen offset:3072 lds
    v_add_u32 v40, 0x20000, v40
    s_add_u32 m0, s62, 147456
    s_nop 0
    buffer_load_dwordx4 v40, s[32:35], 0 offen offset:0 lds
    buffer_load_dwordx4 v40, s[32:35], s92 offen offset:1024 lds
    buffer_load_dwordx4 v40, s[32:35], s93 offen offset:2048 lds
    buffer_load_dwordx4 v40, s[32:35], s94 offen offset:3072 lds
    s_waitcnt vmcnt(0)
    v_mov_b32 v1, v39
    s_branch L_s7
L_wb_32_y:
    buffer_wbl2 sc1
    s_branch L_wb_32
L_codeend:
L_part2_wt:
    s_nop 7
    v_cvt_pk_bf16_f32 v240, v120, v121
    v_cvt_pk_bf16_f32 v241, v122, v123
    v_cvt_pk_bf16_f32 v242, v124, v125
    v_cvt_pk_bf16_f32 v243, v126, v127
    v_cvt_pk_bf16_f32 v244, v128, v129
    v_cvt_pk_bf16_f32 v245, v130, v131
    v_cvt_pk_bf16_f32 v246, v132, v133
    v_cvt_pk_bf16_f32 v247, v134, v135
    buffer_store_dwordx4 v[240:243], v110, s[40:43], 0 offen offset:0 sc1
    buffer_store_dwordx4 v[244:247], v110, s[40:43], s58 offen offset:0 sc1
    s_barrier
    v_add_u32 v78, 0x14000, v78
    ds_read_b64_tr_b16 v[136:137], v78 offset:0
    ds_read_b64_tr_b16 v[138:139], v78 offset:512
    ds_read_b64_tr_b16 v[140:141], v78 offset:1024
    ds_read_b64_tr_b16 v[142:143], v78 offset:1536
    ds_read_b64_tr_b16 v[144:145], v78 offset:2048
    ds_read_b64_tr_b16 v[146:147], v78 offset:2560
    s_waitcnt lgkmcnt(4)
    v_mfma_f32_32x32x16_bf16 v[200:215], v[136:139], a[0:3], 0
    ds_read_b64_tr_b16 v[148:149], v78 offset:3072
    ds_read_b64_tr_b16 v[150:151], v78 offset:3584
    s_mul_i32 s58, s47, 36864
    s_mul_i32 s91, s44, 9216
    s_add_u32 s58, s58, s91
    s_add_u32 s58, s58, 524288
    v_mfma_f32_16x16x32_bf16 v[74:77], v[14:17], v[136:139], 0
    s_add_u32 s59, s58, 4096
    s_waitcnt lgkmcnt(4)
    v_mfma_f32_32x32x16_bf16 v[200:215], v[140:143], a[4:7], v[200:215]
    ds_read_b64_tr_b16 v[136:137], v78 offset:8192
    ds_read_b64_tr_b16 v[138:139], v78 offset:8704
    s_add_u32 s60, s58, 8192
    v_mov_b32 v64, 0
    v_mov_b32 v65, 0
    v_mov_b32 v66, 0
    v_mfma_f32_16x16x32_bf16 v[74:77], v[14:17], v[140:143], v[74:77]
    v_mov_b32 v67, 0
    s_waitcnt lgkmcnt(4)
    v_mfma_f32_32x32x16_bf16 v[200:215], v[144:147], a[8:11], v[200:215]
    ds_read_b64_tr_b16 v[140:141], v78 offset:9216
    ds_read_b64_tr_b16 v[142:143], v78 offset:9728
    v_mov_b32 v68, 0
    v_mov_b32 v69, 0
    v_mov_b32 v70, 0
    v_mov_b32 v71, 0
    v_mfma_f32_16x16x32_bf16 v[74:77], v[14:17], v[144:147], v[74:77]
    v_mov_b32 v72, 0
    s_waitcnt lgkmcnt(4)
    v_mfma_f32_32x32x16_bf16 v[200:215], v[148:151], a[12:15], v[200:215]
    ds_read_b64_tr_b16 v[144:145], v78 offset:10240
    ds_read_b64_tr_b16 v[146:147], v78 offset:10752
    v_mov_b32 v73, 0
    v_mov_b32 v45, s53
    v_lshlrev_b32 v224, 16, v18
    v_and_b32 v225, 0xffff0000, v18
    v_mfma_f32_16x16x32_bf16 v[74:77], v[14:17], v[148:151], v[74:77]
    v_lshlrev_b32 v226, 16, v19
    s_waitcnt lgkmcnt(4)
    v_mfma_f32_32x32x16_bf16 v[200:215], v[136:139], a[16:19], v[200:215]
    ds_read_b64_tr_b16 v[148:149], v78 offset:11264
    ds_read_b64_tr_b16 v[150:151], v78 offset:11776
    v_and_b32 v227, 0xffff0000, v19
    v_lshlrev_b32 v228, 16, v20
    v_and_b32 v229, 0xffff0000, v20
    v_lshlrev_b32 v230, 16, v21
    v_mfma_f32_16x16x32_bf16 v[74:77], v[14:17], v[136:139], v[74:77]
    buffer_load_dwordx2 v[248:249], v57, s[40:43], 0 offen offset:0 sc1
    buffer_load_dwordx2 v[250:251], v57, s[40:43], 0 offen offset:272 sc1
    s_waitcnt lgkmcnt(4)
    v_mfma_f32_32x32x16_bf16 v[200:215], v[140:143], a[20:23], v[200:215]
    s_barrier
    ds_read_b64_tr_b16 v[136:137], v78 offset:16384
    ds_read_b64_tr_b16 v[138:139], v78 offset:16896
    v_and_b32 v231, 0xffff0000, v21
    v_lshlrev_b32 v232, 16, v22
    v_mfma_f32_16x16x32_bf16 v[74:77], v[14:17], v[140:143], v[74:77]
    buffer_load_dwordx2 v[252:253], v59, s[40:43], 0 offen offset:0 sc1
    buffer_load_dwordx2 v[254:255], v59, s[40:43], 0 offen offset:272 sc1
    s_waitcnt lgkmcnt(4)
    v_mfma_f32_32x32x16_bf16 v[200:215], v[144:147], a[24:27], v[200:215]
    ds_read_b64_tr_b16 v[140:141], v78 offset:17408
    ds_read_b64_tr_b16 v[142:143], v78 offset:17920
    v_and_b32 v233, 0xffff0000, v22
    v_lshlrev_b32 v234, 16, v23
    v_and_b32 v235, 0xffff0000, v23
    v_lshlrev_b32 v236, 16, v24
    v_mfma_f32_16x16x32_bf16 v[74:77], v[14:17], v[144:147], v[74:77]
    buffer_load_dwordx4 v40, s[16:19], s92 offen offset:1024 lds
    s_waitcnt lgkmcnt(4)
    v_mfma_f32_32x32x16_bf16 v[200:215], v[148:151], a[28:31], v[200:215]
    ds_read_b64_tr_b16 v[144:145], v78 offset:18432
    ds_read_b64_tr_b16 v[146:147], v78 offset:18944
    v_and_b32 v237, 0xffff0000, v24
    v_lshlrev_b32 v238, 16, v25
    v_and_b32 v239, 0xffff0000, v25
    v_mfma_f32_16x16x32_bf16 v[74:77], v[14:17], v[148:151], v[74:77]
    buffer_load_dwordx4 v40, s[16:19], s93 offen offset:2048 lds
    s_waitcnt lgkmcnt(4)
    v_mfma_f32_32x32x16_bf16 v[200:215], v[136:139], a[32:35], v[200:215]
    ds_read_b64_tr_b16 v[148:149], v78 offset:19456
    ds_read_b64_tr_b16 v[150:151], v78 offset:19968
    v_mfma_f32_16x16x32_bf16 v[74:77], v[14:17], v[136:139], v[74:77]
    buffer_load_dwordx4 v40, s[16:19], s94 offen offset:3072 lds
    s_waitcnt lgkmcnt(4)
    v_mfma_f32_32x32x16_bf16 v[200:215], v[140:143], a[36:39], v[200:215]
    ds_read_b64_tr_b16 v[136:137], v78 offset:24576
    ds_read_b64_tr_b16 v[138:139], v78 offset:25088
    s_mov_b32 s97, 0x20000
    s_cmp_eq_u32 s87, 3
    s_cselect_b32 s97, 0xfffa0000, s97
    v_add_u32 v40, s97, v40
    s_add_u32 m0, s62, 0
    v_mfma_f32_16x16x32_bf16 v[74:77], v[14:17], v[140:143], v[74:77]
    buffer_load_dwordx4 v40, s[16:19], 0 offen offset:0 lds
    s_waitcnt lgkmcnt(4)
    v_mfma_f32_32x32x16_bf16 v[200:215], v[144:147], a[40:43], v[200:215]
    ds_read_b64_tr_b16 v[140:141], v78 offset:25600
    ds_read_b64_tr_b16 v[142:143], v78 offset:26112
    v_mfma_f32_16x16x32_bf16 v[74:77], v[14:17], v[144:147], v[74:77]
    buffer_load_dwordx4 v40, s[16:19], s92 offen offset:1024 lds
    s_waitcnt lgkmcnt(4)
    v_mfma_f32_32x32x16_bf16 v[200:215], v[148:151], a[44:47], v[200:215]
    ds_read_b64_tr_b16 v[144:145], v78 offset:26624
    ds_read_b64_tr_b16 v[146:147], v78 offset:27136
    v_mfma_f32_16x16x32_bf16 v[74:77], v[14:17], v[148:151], v[74:77]
    buffer_load_dwordx4 v40, s[16:19], s93 offen offset:2048 lds
    s_waitcnt lgkmcnt(4)
    v_mfma_f32_32x32x16_bf16 v[200:215], v[136:139], a[48:51], v[200:215]
    ds_read_b64_tr_b16 v[148:149], v78 offset:27648
    ds_read_b64_tr_b16 v[150:151], v78 offset:28160
    v_mfma_f32_16x16x32_bf16 v[74:77], v[14:17], v[136:139], v[74:77]
    s_waitcnt vmcnt(6)
    v_dot2c_f32_bf16 v52, s55, v248
    v_dot2c_f32_bf16 v53, s56, v248
    v_dot2c_f32_bf16 v54, s55, v249
    v_dot2c_f32_bf16 v55, s56, v249
    v_dot2c_f32_bf16 v52, s55, v250
    v_dot2c_f32_bf16 v53, s56, v250
    v_dot2c_f32_bf16 v54, s55, v251
    v_dot2c_f32_bf16 v55, s56, v251
    v_dot2c_f32_bf16 v52, s55, v252
    v_dot2c_f32_bf16 v53, s56, v252
    v_dot2c_f32_bf16 v54, s55, v253
    v_dot2c_f32_bf16 v55, s56, v253
    v_dot2c_f32_bf16 v52, s55, v254
    v_dot2c_f32_bf16 v53, s56, v254
    v_dot2c_f32_bf16 v54, s55, v255
    v_dot2c_f32_bf16 v55, s56, v255
    v_cmp_u_f32 vcc, v52, v52
    v_cvt_pk_bf16_f32 v248, v52, v53
    s_nop 0
    v_cvt_pk_bf16_f32 v249, v54, v55
    s_cbranch_vccnz L_retry_4_wt
L_got_5_wt:
    buffer_store_dwordx2 v[248:249], v56, s[40:43], 0 offen sc1
    s_waitcnt lgkmcnt(4)
    v_mfma_f32_32x32x16_bf16 v[200:215], v[140:143], a[52:55], v[200:215]
    s_barrier
    ds_read_b64_tr_b16 v[136:137], v78 offset:32768
    ds_read_b64_tr_b16 v[138:139], v78 offset:33280
    v_mfma_f32_16x16x32_bf16 v[74:77], v[14:17], v[140:143], v[74:77]
    buffer_load_dwordx4 v40, s[16:19], s94 offen offset:3072 lds
    s_waitcnt lgkmcnt(4)
    v_mfma_f32_32x32x16_bf16 v[200:215], v[144:147], a[56:59], v[200:215]
    ds_read_b64_tr_b16 v[140:141], v78 offset:33792
    ds_read_b64_tr_b16 v[142:143], v78 offset:34304
    s_mov_b32 s97, 0x20000
    s_cmp_eq_u32 s87, 2
    s_cselect_b32 s97, 0xfffa0000, s97
    v_add_u32 v40, s97, v40
    s_add_u32 m0, s62, 16384
    v_mfma_f32_16x16x32_bf16 v[74:77], v[14:17], v[144:147], v[74:77]
    buffer_load_dwordx4 v40, s[16:19], 0 offen offset:0 lds
    s_waitcnt lgkmcnt(4)
    v_mfma_f32_32x32x16_bf16 v[200:215], v[148:151], a[60:63], v[200:215]
    ds_read_b64_tr_b16 v[144:145], v78 offset:34816
    ds_read_b64_tr_b16 v[146:147], v78 offset:35328
    v_mfma_f32_16x16x32_bf16 v[74:77], v[14:17], v[148:151], v[74:77]
    buffer_load_dwordx4 v40, s[16:19], s92 offen offset:1024 lds
    s_waitcnt lgkmcnt(4)
    v_mfma_f32_32x32x16_bf16 v[200:215], v[136:139], a[64:67], v[200:215]
    ds_read_b64_tr_b16 v[148:149], v78 offset:35840
    ds_read_b64_tr_b16 v[150:151], v78 offset:36352
    v_mfma_f32_16x16x32_bf16 v[74:77], v[14:17], v[136:139], v[74:77]
    buffer_load_dwordx4 v40, s[16:19], s93 offen offset:2048 lds
    s_waitcnt lgkmcnt(4)
    v_mfma_f32_32x32x16_bf16 v[200:215], v[140:143], a[68:71], v[200:215]
    ds_read_b64_tr_b16 v[136:137], v78 offset:40960
    ds_read_b64_tr_b16 v[138:139], v78 offset:41472
    v_mfma_f32_16x16x32_bf16 v[74:77], v[14:17], v[140:143], v[74:77]
    buffer_load_dwordx4 v40, s[16:19], s94 offen offset:3072 lds
    s_waitcnt lgkmcnt(4)
    v_mfma_f32_32x32x16_bf16 v[200:215], v[144:147], a[72:75], v[200:215]
    ds_read_b64_tr_b16 v[140:141], v78 offset:41984
    ds_read_b64_tr_b16 v[142:143], v78 offset:42496
    s_mov_b32 s97, 0x20000
    s_cmp_eq_u32 s87, 1
    s_cselect_b32 s97, 0xfffa0000, s97
    v_add_u32 v40, s97, v40
    s_add_u32 m0, s62, 32768
    v_mfma_f32_16x16x32_bf16 v[74:77], v[14:17], v[144:147], v[74:77]
    buffer_load_dwordx4 v40, s[16:19], 0 offen offset:0 lds
    s_waitcnt lgkmcnt(4)
    v_mfma_f32_32x32x16_bf16 v[200:215], v[148:151], a[76:79], v[200:215]
    ds_read_b64_tr_b16 v[144:145], v78 offset:43008
    ds_read_b64_tr_b16 v[146:147], v78 offset:43520
    v_mfma_f32_16x16x32_bf16 v[74:77], v[14:17], v[148:151], v[74:77]
    buffer_load_dwordx4 v40, s[16:19], s92 offen offset:1024 lds
    s_waitcnt lgkmcnt(4)
    v_mfma_f32_32x32x16_bf16 v[200:215], v[136:139], a[80:83], v[200:215]
    ds_read_b64_tr_b16 v[148:149], v78 offset:44032
    ds_read_b64_tr_b16 v[150:151], v78 offset:44544
    v_mfma_f32_16x16x32_bf16 v[74:77], v[14:17], v[136:139], v[74:77]
    buffer_load_dwordx4 v40, s[16:19], s93 offen offset:2048 lds
    s_waitcnt lgkmcnt(4)
    v_mfma_f32_32x32x16_bf16 v[200:215], v[140:143], a[84:87], v[200:215]
    s_barrier
    v_add_u32 v78, 0xffff8000, v78
    ds_read_b64_tr_b16 v[136:137], v78 offset:0
    ds_read_b64_tr_b16 v[138:139], v78 offset:512
    v_mfma_f32_16x16x32_bf16 v[74:77], v[14:17], v[140:143], v[74:77]
    buffer_load_dwordx4 v40, s[16:19], s94 offen offset:3072 lds
    s_waitcnt lgkmcnt(4)
    v_mfma_f32_32x32x16_bf16 v[200:215], v[144:147], a[88:91], v[200:215]
    ds_read_b64_tr_b16 v[140:141], v78 offset:1024
    ds_read_b64_tr_b16 v[142:143], v78 offset:1536
    v_add_u32 v41, 0x700, v41
    s_add_u32 m0, s62, 131072
    s_mov_b32 s92, 27648
    s_mov_b32 s93, 55296
    s_mov_b32 s94, 82944
    v_mfma_f32_16x16x32_bf16 v[74:77], v[14:17], v[144:147], v[74:77]
    buffer_load_dwordx4 v41, s[20:23], 0 offen offset:0 lds
    s_waitcnt lgkmcnt(4)
    v_mfma_f32_32x32x16_bf16 v[200:215], v[148:151], a[92:95], v[200:215]
    ds_read_b64_tr_b16 v[144:145], v78 offset:2048
    ds_read_b64_tr_b16 v[146:147], v78 offset:2560
    v_mfma_f32_16x16x32_bf16 v[74:77], v[14:17], v[148:151], v[74:77]
    buffer_load_dwordx4 v41, s[20:23], s92 offen offset:1024 lds
    s_waitcnt lgkmcnt(4)
    v_mfma_f32_32x32x16_bf16 v[200:215], v[136:139], a[96:99], v[200:215]
    ds_read_b64_tr_b16 v[148:149], v78 offset:3072
    ds_read_b64_tr_b16 v[150:151], v78 offset:3584
    v_mfma_f32_16x16x32_bf16 v[74:77], v[14:17], v[136:139], v[74:77]
    buffer_load_dwordx4 v41, s[20:23], s93 offen offset:2048 lds
    s_waitcnt lgkmcnt(4)
    v_mfma_f32_32x32x16_bf16 v[200:215], v[140:143], a[100:103], v[200:215]
    ds_read_b64_tr_b16 v[136:137], v78 offset:8192
    ds_read_b64_tr_b16 v[138:139], v78 offset:8704
    v_mfma_f32_16x16x32_bf16 v[74:77], v[14:17], v[140:143], v[74:77]
    buffer_load_dwordx4 v41, s[20:23], s94 offen offset:3072 lds
    s_waitcnt lgkmcnt(4)
    v_mfma_f32_32x32x16_bf16 v[200:215], v[144:147], a[104:107], v[200:215]
    ds_read_b64_tr_b16 v[140:141], v78 offset:9216
    ds_read_b64_tr_b16 v[142:143], v78 offset:9728
    s_mov_b32 s97, 0x70000
    s_cmp_eq_u32 s86, 0
    s_cselect_b32 s97, 0xffeb0000, s97
    v_add_u32 v41, s97, v41
    s_add_u32 m0, s62, 81920
    v_mfma_f32_16x16x32_bf16 v[74:77], v[14:17], v[144:147], v[74:77]
    buffer_load_dwordx4 v41, s[20:23], 0 offen offset:0 lds
    s_waitcnt lgkmcnt(4)
    v_mfma_f32_32x32x16_bf16 v[200:215], v[148:151], a[108:111], v[200:215]
    ds_read_b64_tr_b16 v[144:145], v78 offset:10240
    ds_read_b64_tr_b16 v[146:147], v78 offset:10752
    v_mfma_f32_16x16x32_bf16 v[74:77], v[14:17], v[148:151], v[74:77]
    buffer_load_dwordx4 v41, s[20:23], s92 offen offset:1024 lds
    s_waitcnt lgkmcnt(4)
    v_mfma_f32_32x32x16_bf16 v[200:215], v[136:139], a[112:115], v[200:215]
    ds_read_b64_tr_b16 v[148:149], v78 offset:11264
    ds_read_b64_tr_b16 v[150:151], v78 offset:11776
    v_mfma_f32_16x16x32_bf16 v[74:77], v[14:17], v[136:139], v[74:77]
    buffer_load_dwordx4 v41, s[20:23], s93 offen offset:2048 lds
    s_waitcnt lgkmcnt(4)
    v_mfma_f32_32x32x16_bf16 v[200:215], v[140:143], a[116:119], v[200:215]
    v_mfma_f32_16x16x32_bf16 v[74:77], v[14:17], v[140:143], v[74:77]
    buffer_load_dwordx4 v41, s[20:23], s94 offen offset:3072 lds
    s_waitcnt lgkmcnt(2)
    v_mfma_f32_32x32x16_bf16 v[200:215], v[144:147], a[120:123], v[200:215]
    s_mov_b32 s97, 0x70000
    s_cmp_eq_u32 s86, 3
    s_cselect_b32 s97, 0xffeb0000, s97
    v_add_u32 v41, s97, v41
    s_add_u32 m0, s62, 98304
    v_mfma_f32_16x16x32_bf16 v[74:77], v[14:17], v[144:147], v[74:77]
    buffer_load_dwordx4 v41, s[20:23], 0 offen offset:0 lds
    s_waitcnt lgkmcnt(0)
    v_mfma_f32_16x16x32_bf16 v[74:77], v[14:17], v[148:151], v[74:77]
    v_mfma_f32_32x32x16_bf16 v[200:215], v[148:151], a[124:127], v[200:215]
    buffer_load_dwordx4 v41, s[20:23], s92 offen offset:1024 lds
    s_nop 5
    v_cvt_pk_bf16_f32 v75, v74, 0
    v_lshlrev_b32 v76, 16, v75
    v_sub_f32 v76, v74, v76
    v_cvt_pk_bf16_f32 v74, v74, v76
    v_mov_b32 v76, 0
    v_mov_b32 v77, 0
    s_nop 1
    v_mfma_f32_32x32x16_bf16 v[200:215], v[74:77], v[82:85], v[200:215]
    s_barrier
    s_nop 10
    v_cvt_pk_bf16_f32 v52, v200, v201
    v_cvt_pk_bf16_f32 v53, v202, v203
    v_cvt_pk_bf16_f32 v54, v204, v205
    v_cvt_pk_bf16_f32 v55, v206, v207
    s_nop 1
    v_mfma_f32_32x32x16_bf16 v[240:255], v[92:95], v[52:55], 0
    v_cvt_pk_bf16_f32 v56, v208, v209
    v_cvt_pk_bf16_f32 v57, v210, v211
    v_cvt_pk_bf16_f32 v58, v212, v213
    v_cvt_pk_bf16_f32 v59, v214, v215
    s_nop 1
    v_mfma_f32_32x32x16_bf16 v[240:255], v[96:99], v[56:59], v[240:255]
    s_nop 11
    v_max3_f32 v100, v240, v241, v242
    v_max3_f32 v104, v243, v244, v245
    v_max3_f32 v100, v246, v247, v100
    v_max_f32 v100, v100, v104
    v_max3_f32 v101, v248, v249, v250
    v_max3_f32 v105, v251, v252, v253
    v_max3_f32 v101, v254, v255, v101
    v_max_f32 v101, v101, v105
    v_min3_f32 v102, v240, v241, v242
    v_min3_f32 v104, v243, v244, v245
    v_min3_f32 v102, v246, v247, v102
    v_min_f32 v102, v102, v104
    v_min3_f32 v103, v248, v249, v250
    v_min3_f32 v105, v251, v252, v253
    v_min3_f32 v103, v254, v255, v103
    v_min_f32 v103, v103, v105
    v_permlane32_swap_b32 v100, v101
    s_nop 0
    v_permlane32_swap_b32 v102, v103
    v_max_f32 v100, v100, v101
    v_min_f32 v102, v102, v103
    v_mov_b32 v101, v100
    v_mov_b32 v103, v102
    s_nop 0
    v_permlane32_swap_b32 v100, v101
    v_permlane32_swap_b32 v102, v103
    v_pk_mul_f32 v[100:101], v[100:101], v[108:109] op_sel_hi:[1,0]
    v_pk_mul_f32 v[102:103], v[102:103], v[108:109] op_sel_hi:[1,0]
    v_pk_fma_f32 v[120:121], v[240:241], v[108:109], v[100:101] op_sel:[0,0,0] op_sel_hi:[1,0,0] neg_lo:[0,0,1] neg_hi:[0,0,1]
    v_pk_fma_f32 v[128:129], v[240:241], v[108:109], v[102:103] op_sel:[0,0,0] op_sel_hi:[1,0,0] neg_lo:[1,0,0] neg_hi:[1,0,0]
    v_pk_fma_f32 v[122:123], v[242:243], v[108:109], v[100:101] op_sel:[0,0,0] op_sel_hi:[1,0,0] neg_lo:[0,0,1] neg_hi:[0,0,1]
    v_pk_fma_f32 v[130:131], v[242:243], v[108:109], v[102:103] op_sel:[0,0,0] op_sel_hi:[1,0,0] neg_lo:[1,0,0] neg_hi:[1,0,0]
    v_pk_fma_f32 v[124:125], v[244:245], v[108:109], v[100:101] op_sel:[0,0,0] op_sel_hi:[1,0,0] neg_lo:[0,0,1] neg_hi:[0,0,1]
    v_pk_fma_f32 v[132:133], v[244:245], v[108:109], v[102:103] op_sel:[0,0,0] op_sel_hi:[1,0,0] neg_lo:[1,0,0] neg_hi:[1,0,0]
    v_pk_fma_f32 v[126:127], v[246:247], v[108:109], v[100:101] op_sel:[0,0,0] op_sel_hi:[1,0,0] neg_lo:[0,0,1] neg_hi:[0,0,1]
    v_pk_fma_f32 v[134:135], v[246:247], v[108:109], v[102:103] op_sel:[0,0,0] op_sel_hi:[1,0,0] neg_lo:[1,0,0] neg_hi:[1,0,0]
    v_pk_fma_f32 v[136:137], v[248:249], v[108:109], v[100:101] op_sel:[0,0,1] op_sel_hi:[1,0,1] neg_lo:[0,0,1] neg_hi:[0,0,1]
    v_pk_fma_f32 v[144:145], v[248:249], v[108:109], v[102:103] op_sel:[0,0,1] op_sel_hi:[1,0,1] neg_lo:[1,0,0] neg_hi:[1,0,0]
    v_pk_fma_f32 v[138:139], v[250:251], v[108:109], v[100:101] op_sel:[0,0,1] op_sel_hi:[1,0,1] neg_lo:[0,0,1] neg_hi:[0,0,1]
    v_pk_fma_f32 v[146:147], v[250:251], v[108:109], v[102:103] op_sel:[0,0,1] op_sel_hi:[1,0,1] neg_lo:[1,0,0] neg_hi:[1,0,0]
    v_pk_fma_f32 v[140:141], v[252:253], v[108:109], v[100:101] op_sel:[0,0,1] op_sel_hi:[1,0,1] neg_lo:[0,0,1] neg_hi:[0,0,1]
    v_pk_fma_f32 v[148:149], v[252:253], v[108:109], v[102:103] op_sel:[0,0,1] op_sel_hi:[1,0,1] neg_lo:[1,0,0] neg_hi:[1,0,0]
    v_pk_fma_f32 v[142:143], v[254:255], v[108:109], v[100:101] op_sel:[0,0,1] op_sel_hi:[1,0,1] neg_lo:[0,0,1] neg_hi:[0,0,1]
    v_pk_fma_f32 v[150:151], v[254:255], v[108:109], v[102:103] op_sel:[0,0,1] op_sel_hi:[1,0,1] neg_lo:[1,0,0] neg_hi:[1,0,0]
    v_exp_f32 v120, v120
    v_exp_f32 v121, v121
    v_exp_f32 v122, v122
    v_exp_f32 v123, v123
    v_exp_f32 v124, v124
    v_exp_f32 v125, v125
    v_exp_f32 v126, v126
    v_exp_f32 v127, v127
    buffer_load_dword v60, v115, s[40:43], s60 offen offset:0 sc1
    buffer_load_dword v61, v115, s[40:43], s60 offen offset:512 sc1
    v_exp_f32 v128, v128
    v_exp_f32 v129, v129
    v_exp_f32 v130, v130
    v_exp_f32 v131, v131
    v_exp_f32 v132, v132
    v_exp_f32 v133, v133
    v_exp_f32 v134, v134
    v_exp_f32 v135, v135
    buffer_load_dwordx4 v[168:171], v36, s[40:43], s58 offen offset:0 sc1
    buffer_load_dwordx4 v[172:175], v36, s[40:43], s58 offen offset:1024 sc1
    v_exp_f32 v136, v136
    v_exp_f32 v137, v137
    v_exp_f32 v138, v138
    v_exp_f32 v139, v139
    v_exp_f32 v140, v140
    v_exp_f32 v141, v141
    v_exp_f32 v142, v142
    v_exp_f32 v143, v143
    buffer_load_dwordx4 v[176:179], v36, s[40:43], s58 offen offset:2048 sc1
    buffer_load_dwordx4 v[180:183], v36, s[40:43], s58 offen offset:3072 sc1
    v_exp_f32 v144, v144
    v_exp_f32 v145, v145
    v_exp_f32 v146, v146
    v_exp_f32 v147, v147
    v_exp_f32 v148, v148
    v_exp_f32 v149, v149
    v_exp_f32 v150, v150
    v_exp_f32 v151, v151
    buffer_load_dwordx4 v[184:187], v36, s[40:43], s59 offen offset:0 sc1
    buffer_load_dwordx4 v[188:191], v36, s[40:43], s59 offen offset:1024 sc1
    v_pk_add_f32 v[240:241], v[120:121], v[122:123]
    v_pk_add_f32 v[242:243], v[124:125], v[126:127]
    v_pk_add_f32 v[244:245], v[128:129], v[130:131]
    v_pk_add_f32 v[246:247], v[132:133], v[134:135]
    v_pk_add_f32 v[248:249], v[136:137], v[138:139]
    v_pk_add_f32 v[250:251], v[140:141], v[142:143]
    v_pk_add_f32 v[252:253], v[144:145], v[146:147]
    v_pk_add_f32 v[254:255], v[148:149], v[150:151]
    v_pk_add_f32 v[240:241], v[240:241], v[242:243]
    v_pk_add_f32 v[244:245], v[244:245], v[246:247]
    v_pk_add_f32 v[248:249], v[248:249], v[250:251]
    v_pk_add_f32 v[252:253], v[252:253], v[254:255]
    v_add_f32 v100, v240, v241
    v_add_f32 v101, v244, v245
    v_add_f32 v102, v248, v249
    v_add_f32 v103, v252, v253
    buffer_load_dwordx4 v[192:195], v36, s[40:43], s59 offen offset:2048 sc1
    buffer_load_dwordx4 v[196:199], v36, s[40:43], s59 offen offset:3072 sc1
    v_permlane32_swap_b32 v100, v101
    v_permlane32_swap_b32 v102, v103
    v_add_f32 v100, v100, v101
    v_add_f32 v102, v102, v103
    v_rcp_f32 v100, v100
    v_rcp_f32 v102, v102
    v_mov_b32 v101, v100
    v_mov_b32 v103, v102
    s_nop 0
    v_permlane32_swap_b32 v100, v101
    v_permlane32_swap_b32 v102, v103
    v_pk_mul_f32 v[120:121], v[120:121], v[100:101] op_sel:[0,0] op_sel_hi:[1,0]
    v_pk_mul_f32 v[122:123], v[122:123], v[100:101] op_sel:[0,0] op_sel_hi:[1,0]
    v_pk_mul_f32 v[124:125], v[124:125], v[100:101] op_sel:[0,0] op_sel_hi:[1,0]
    v_pk_mul_f32 v[126:127], v[126:127], v[100:101] op_sel:[0,0] op_sel_hi:[1,0]
    v_pk_mul_f32 v[128:129], v[128:129], v[100:101] op_sel:[0,1] op_sel_hi:[1,1]
    v_pk_mul_f32 v[130:131], v[130:131], v[100:101] op_sel:[0,1] op_sel_hi:[1,1]
    v_pk_mul_f32 v[132:133], v[132:133], v[100:101] op_sel:[0,1] op_sel_hi:[1,1]
    v_pk_mul_f32 v[134:135], v[134:135], v[100:101] op_sel:[0,1] op_sel_hi:[1,1]
    v_pk_mul_f32 v[136:137], v[136:137], v[102:103] op_sel:[0,0] op_sel_hi:[1,0]
    v_pk_mul_f32 v[138:139], v[138:139], v[102:103] op_sel:[0,0] op_sel_hi:[1,0]
    v_pk_mul_f32 v[140:141], v[140:141], v[102:103] op_sel:[0,0] op_sel_hi:[1,0]
    v_pk_mul_f32 v[142:143], v[142:143], v[102:103] op_sel:[0,0] op_sel_hi:[1,0]
    v_pk_mul_f32 v[144:145], v[144:145], v[102:103] op_sel:[0,1] op_sel_hi:[1,1]
    v_pk_mul_f32 v[146:147], v[146:147], v[102:103] op_sel:[0,1] op_sel_hi:[1,1]
    v_pk_mul_f32 v[148:149], v[148:149], v[102:103] op_sel:[0,1] op_sel_hi:[1,1]
    v_pk_mul_f32 v[150:151], v[150:151], v[102:103] op_sel:[0,1] op_sel_hi:[1,1]
    buffer_load_dwordx4 v41, s[20:23], s93 offen offset:2048 lds
    v_cvt_pk_bf16_f32 v152, v120, v121
    v_cvt_pk_bf16_f32 v153, v122, v123
    v_cvt_pk_bf16_f32 v154, v124, v125
    v_cvt_pk_bf16_f32 v155, v126, v127
    v_cvt_pk_bf16_f32 v156, v128, v129
    v_cvt_pk_bf16_f32 v157, v130, v131
    v_cvt_pk_bf16_f32 v158, v132, v133
    v_cvt_pk_bf16_f32 v159, v134, v135
    v_cvt_pk_bf16_f32 v160, v136, v137
    v_cvt_pk_bf16_f32 v161, v138, v139
    v_cvt_pk_bf16_f32 v162, v140, v141
    v_cvt_pk_bf16_f32 v163, v142, v143
    v_cvt_pk_bf16_f32 v164, v144, v145
    v_cvt_pk_bf16_f32 v165, v146, v147
    v_cvt_pk_bf16_f32 v166, v148, v149
    v_cvt_pk_bf16_f32 v167, v150, v151
    s_mov_b32 s61, 0
    s_branch L_got_8_wt
L_again_9_wt:
    buffer_load_dword v60, v115, s[40:43], s60 offen offset:0 sc1
    buffer_load_dword v61, v115, s[40:43], s60 offen offset:512 sc1
    buffer_load_dwordx4 v[168:171], v36, s[40:43], s58 offen offset:0 sc1
    buffer_load_dwordx4 v[172:175], v36, s[40:43], s58 offen offset:1024 sc1
    buffer_load_dwordx4 v[176:179], v36, s[40:43], s58 offen offset:2048 sc1
    buffer_load_dwordx4 v[180:183], v36, s[40:43], s58 offen offset:3072 sc1
    buffer_load_dwordx4 v[184:187], v36, s[40:43], s59 offen offset:0 sc1
    buffer_load_dwordx4 v[188:191], v36, s[40:43], s59 offen offset:1024 sc1
    buffer_load_dwordx4 v[192:195], v36, s[40:43], s59 offen offset:2048 sc1
    buffer_load_dwordx4 v[196:199], v36, s[40:43], s59 offen offset:3072 sc1
    v_mov_b32 v64, 0
    v_mov_b32 v65, 0
    v_mov_b32 v66, 0
    v_mov_b32 v67, 0
    v_mov_b32 v68, 0
    v_mov_b32 v69, 0
    v_mov_b32 v70, 0
    v_mov_b32 v71, 0
    v_mov_b32 v72, 0
    v_mov_b32 v73, 0
    s_addk_i32 s61, 1
    s_cmp_gt_u32 s61, 0x80000
    s_cbranch_scc1 L_abort_wt
    s_waitcnt vmcnt(0)
L_got_8_wt:
    s_waitcnt vmcnt(9)
    v_dot2c_f32_bf16 v72, s55, v60
    v_dot2c_f32_bf16 v73, s56, v60
    v_dot2c_f32_bf16 v72, s55, v61
    v_dot2c_f32_bf16 v73, s56, v61
    s_waitcnt vmcnt(8)
    v_dot2c_f32_bf16 v64, s55, v168
    v_dot2c_f32_bf16 v68, s55, v170
    v_dot2c_f32_bf16 v65, s56, v168
    v_dot2c_f32_bf16 v66, s55, v169
    v_dot2c_f32_bf16 v67, s56, v169
    v_dot2c_f32_bf16 v69, s56, v170
    v_dot2c_f32_bf16 v70, s55, v171
    v_dot2c_f32_bf16 v71, s56, v171
    v_permlane32_swap_b32 v72, v73
    v_add_f32 v72, v72, v73
    v_mov_b32 v73, v72
    s_waitcnt vmcnt(7)
    v_dot2c_f32_bf16 v64, s55, v172
    v_dot2c_f32_bf16 v68, s55, v174
    v_dot2c_f32_bf16 v65, s56, v172
    v_dot2c_f32_bf16 v66, s55, v173
    v_dot2c_f32_bf16 v67, s56, v173
    v_dot2c_f32_bf16 v69, s56, v174
    v_dot2c_f32_bf16 v70, s55, v175
    v_dot2c_f32_bf16 v71, s56, v175
    v_permlane16_swap_b32 v72, v73
    v_add_f32 v72, v72, v73
    v_cvt_pk_bf16_f32 v73, v72, v72
    s_waitcnt vmcnt(6)
    v_dot2c_f32_bf16 v64, s55, v176
    v_dot2c_f32_bf16 v68, s55, v178
    v_dot2c_f32_bf16 v65, s56, v176
    v_dot2c_f32_bf16 v66, s55, v177
    v_dot2c_f32_bf16 v67, s56, v177
    v_dot2c_f32_bf16 v69, s56, v178
    v_dot2c_f32_bf16 v70, s55, v179
    v_dot2c_f32_bf16 v71, s56, v179
    s_waitcnt vmcnt(5)
    v_dot2c_f32_bf16 v64, s55, v180
    v_dot2c_f32_bf16 v68, s55, v182
    v_dot2c_f32_bf16 v65, s56, v180
    v_dot2c_f32_bf16 v66, s55, v181
    v_dot2c_f32_bf16 v67, s56, v181
    v_dot2c_f32_bf16 v69, s56, v182
    v_dot2c_f32_bf16 v70, s55, v183
    v_dot2c_f32_bf16 v71, s56, v183
    s_waitcnt vmcnt(4)
    v_dot2c_f32_bf16 v64, s55, v184
    v_dot2c_f32_bf16 v68, s55, v186
    v_dot2c_f32_bf16 v65, s56, v184
    v_dot2c_f32_bf16 v66, s55, v185
    v_dot2c_f32_bf16 v67, s56, v185
    v_dot2c_f32_bf16 v69, s56, v186
    v_dot2c_f32_bf16 v70, s55, v187
    v_dot2c_f32_bf16 v71, s56, v187
    s_waitcnt vmcnt(3)
    v_dot2c_f32_bf16 v64, s55, v188
    v_dot2c_f32_bf16 v68, s55, v190
    v_dot2c_f32_bf16 v65, s56, v188
    v_dot2c_f32_bf16 v66, s55, v189
    v_dot2c_f32_bf16 v67, s56, v189
    v_dot2c_f32_bf16 v69, s56, v190
    v_dot2c_f32_bf16 v70, s55, v191
    v_dot2c_f32_bf16 v71, s56, v191
    s_waitcnt vmcnt(2)
    v_dot2c_f32_bf16 v64, s55, v192
    v_dot2c_f32_bf16 v68, s55, v194
    v_dot2c_f32_bf16 v65, s56, v192
    v_dot2c_f32_bf16 v66, s55, v193
    v_dot2c_f32_bf16 v67, s56, v193
    v_dot2c_f32_bf16 v69, s56, v194
    v_dot2c_f32_bf16 v70, s55, v195
    v_dot2c_f32_bf16 v71, s56, v195
    s_waitcnt vmcnt(1)
    v_dot2c_f32_bf16 v64, s55, v196
    v_dot2c_f32_bf16 v68, s55, v198
    v_dot2c_f32_bf16 v65, s56, v196
    v_dot2c_f32_bf16 v66, s55, v197
    v_dot2c_f32_bf16 v67, s56, v197
    v_dot2c_f32_bf16 v69, s56, v198
    v_dot2c_f32_bf16 v70, s55, v199
    v_dot2c_f32_bf16 v71, s56, v199
    v_add_f32 v37, v64, v72
    v_cmp_u_f32 vcc, v37, v68
    v_cvt_pk_bf16_f32 v60, v64, v65
    v_cvt_pk_bf16_f32 v61, v66, v67
    v_cvt_pk_bf16_f32 v62, v68, v69
    v_cvt_pk_bf16_f32 v63, v70, v71
    s_cbranch_vccnz L_again_9_wt
    ds_write_b128 v116, v[60:63]
    ds_write_b16 v117, v73 offset:256
    s_waitcnt lgkmcnt(0)
    s_barrier
    ds_read_b128 v[168:171], v118 offset:0
    ds_read_b128 v[172:175], v118 offset:544
    ds_read_b128 v[176:179], v118 offset:1088
    ds_read_b128 v[180:183], v118 offset:1632
    s_waitcnt lgkmcnt(3)
    v_mfma_f32_32x32x16_bf16 v[240:255], v[168:171], v[152:155], 0
    ds_read_b64_tr_b16 a[0:1], v26 offset:0
    ds_read_b64_tr_b16 a[2:3], v26 offset:1024
    s_waitcnt lgkmcnt(4)
    v_mfma_f32_32x32x16_bf16 v[240:255], v[172:175], v[156:159], v[240:255]
    ds_read_b64_tr_b16 a[4:5], v27 offset:0
    ds_read_b64_tr_b16 a[6:7], v27 offset:1024
    s_waitcnt lgkmcnt(5)
    v_mfma_f32_32x32x16_bf16 v[208:223], v[176:179], v[160:163], 0
    ds_read_b64_tr_b16 a[8:9], v28 offset:0
    ds_read_b64_tr_b16 a[10:11], v28 offset:1024
    s_waitcnt lgkmcnt(6)
    v_mfma_f32_32x32x16_bf16 v[208:223], v[180:183], v[164:167], v[208:223]
    ds_read_b64_tr_b16 a[12:13], v29 offset:0
    ds_read_b64_tr_b16 a[14:15], v29 offset:1024
    ds_read_b64_tr_b16 a[16:17], v26 offset:4096
    ds_read_b64_tr_b16 a[18:19], v26 offset:5120
    v_add_f32 v248, 0x358637bd, v248
    v_rcp_f32 v248, v248
    s_nop 0
    v_mul_f32 v240, v240, v248
    v_mul_f32 v241, v241, v248
    v_mul_f32 v242, v242, v248
    v_mul_f32 v243, v243, v248
    v_mul_f32 v244, v244, v248
    v_mul_f32 v245, v245, v248
    v_mul_f32 v246, v246, v248
    v_mul_f32 v247, v247, v248
    v_cvt_pk_bf16_f32 v184, v240, v241
    v_cvt_pk_bf16_f32 v185, v242, v243
    v_cvt_pk_bf16_f32 v186, v244, v245
    v_cvt_pk_bf16_f32 v187, v246, v247
    v_add_f32 v216, 0x358637bd, v216
    v_rcp_f32 v216, v216
    s_nop 0
    v_pk_mul_f32 v[208:209], v[208:209], v[216:217] op_sel_hi:[1,0]
    v_pk_mul_f32 v[210:211], v[210:211], v[216:217] op_sel_hi:[1,0]
    v_pk_mul_f32 v[212:213], v[212:213], v[216:217] op_sel_hi:[1,0]
    v_pk_mul_f32 v[214:215], v[214:215], v[216:217] op_sel_hi:[1,0]
    v_cvt_pk_bf16_f32 v188, v208, v209
    v_cvt_pk_bf16_f32 v189, v210, v211
    v_cvt_pk_bf16_f32 v190, v212, v213
    v_cvt_pk_bf16_f32 v191, v214, v215
    buffer_store_dwordx4 v[184:187], v111, s[40:43], 0 offen offset:0 sc1
    buffer_store_dwordx4 v[188:191], v111, s[40:43], 0 offen offset:512 sc1
    ds_read_b64_tr_b16 a[20:21], v27 offset:4096
    ds_read_b64_tr_b16 a[22:23], v27 offset:5120
    ds_read_b64_tr_b16 a[24:25], v28 offset:4096
    ds_read_b64_tr_b16 a[26:27], v28 offset:5120
    ds_read_b64_tr_b16 a[28:29], v29 offset:4096
    ds_read_b64_tr_b16 a[30:31], v29 offset:5120
    ds_read_b64_tr_b16 a[32:33], v26 offset:8192
    ds_read_b64_tr_b16 a[34:35], v26 offset:9216
    ds_read_b64_tr_b16 a[36:37], v27 offset:8192
    ds_read_b64_tr_b16 a[38:39], v27 offset:9216
    ds_read_b64_tr_b16 a[40:41], v28 offset:8192
    ds_read_b64_tr_b16 a[42:43], v28 offset:9216
    ds_read_b64_tr_b16 a[44:45], v29 offset:8192
    ds_read_b64_tr_b16 a[46:47], v29 offset:9216
    ds_read_b64_tr_b16 a[48:49], v26 offset:12288
    ds_read_b64_tr_b16 a[50:51], v26 offset:13312
    ds_read_b64_tr_b16 a[52:53], v27 offset:12288
    ds_read_b64_tr_b16 a[54:55], v27 offset:13312
    ds_read_b64_tr_b16 a[56:57], v28 offset:12288
    ds_read_b64_tr_b16 a[58:59], v28 offset:13312
    ds_read_b64_tr_b16 a[60:61], v29 offset:12288
    ds_read_b64_tr_b16 a[62:63], v29 offset:13312
    v_add_u32 v26, 0xffff0000, v26
    v_add_u32 v27, 0xffff0000, v27
    v_add_u32 v28, 0xffff0000, v28
    v_add_u32 v29, 0xffff0000, v29
    ds_read_b64_tr_b16 a[64:65], v26 offset:0
    ds_read_b64_tr_b16 a[66:67], v26 offset:1024
    ds_read_b64_tr_b16 a[68:69], v27 offset:0
    ds_read_b64_tr_b16 a[70:71], v27 offset:1024
    ds_read_b64_tr_b16 a[72:73], v28 offset:0
    ds_read_b64_tr_b16 a[74:75], v28 offset:1024
    s_movk_i32 s58, 16384
    s_waitcnt vmcnt(0)
    buffer_store_dword v45, v112, s[40:43], s58 offen sc1
    ds_read_b64_tr_b16 a[76:77], v29 offset:0
    ds_read_b64_tr_b16 a[78:79], v29 offset:1024
    ds_read_b64_tr_b16 a[80:81], v26 offset:4096
    ds_read_b64_tr_b16 a[82:83], v26 offset:5120
    ds_read_b64_tr_b16 a[84:85], v27 offset:4096
    ds_read_b64_tr_b16 a[86:87], v27 offset:5120
    ds_read_b64_tr_b16 a[88:89], v28 offset:4096
    ds_read_b64_tr_b16 a[90:91], v28 offset:5120
    ds_read_b64_tr_b16 a[92:93], v29 offset:4096
    ds_read_b64_tr_b16 a[94:95], v29 offset:5120
    ds_read_b64_tr_b16 a[96:97], v26 offset:8192
    ds_read_b64_tr_b16 a[98:99], v26 offset:9216
    s_lshl_b32 s59, s49, 16
    s_lshl_b32 s91, s50, 17
    s_add_u32 s59, s59, s91
    s_lshl_b32 s91, s44, 14
    s_add_u32 s59, s59, s91
    s_add_u32 s59, s59, 4194304
    v_add_u32 v38, s59, v36
    s_lshl_b32 s59, s87, 12
    buffer_load_dword v47, v44, s[40:43], s58 offen sc1
    ds_read_b64_tr_b16 a[100:101], v27 offset:8192
    ds_read_b64_tr_b16 a[102:103], v27 offset:9216
    ds_read_b64_tr_b16 a[104:105], v28 offset:8192
    ds_read_b64_tr_b16 a[106:107], v28 offset:9216
    ds_read_b64_tr_b16 a[108:109], v29 offset:8192
    ds_read_b64_tr_b16 a[110:111], v29 offset:9216
    ds_read_b64_tr_b16 a[112:113], v26 offset:12288
    ds_read_b64_tr_b16 a[114:115], v26 offset:13312
    ds_read_b64_tr_b16 a[116:117], v27 offset:12288
    ds_read_b64_tr_b16 a[118:119], v27 offset:13312
    ds_read_b64_tr_b16 a[120:121], v28 offset:12288
    ds_read_b64_tr_b16 a[122:123], v28 offset:13312
    v_mov_b32 v4, 0
    v_mov_b32 v5, 0
    s_mov_b32 s61, 0
    s_branch L_got_11_wt
L_again_12_wt:
    buffer_load_dword v47, v44, s[40:43], s58 offen sc1
    s_addk_i32 s61, 1
    s_cmp_gt_u32 s61, 0x80000
    s_cbranch_scc1 L_abort_wt
    s_waitcnt vmcnt(0)
L_got_11_wt:
    s_waitcnt vmcnt(0)
    v_cmp_ne_u32 vcc, s53, v47
    s_cbranch_vccnz L_again_12_wt
    buffer_load_dwordx4 v[160:163], v38, s[40:43], s59 offen offset:0 sc1
    buffer_load_dwordx4 v[164:167], v38, s[40:43], s59 offen offset:1024 sc1
    buffer_load_dwordx4 v[168:171], v38, s[40:43], s59 offen offset:2048 sc1
    buffer_load_dwordx4 v[172:175], v38, s[40:43], s59 offen offset:3072 sc1
    s_add_u32 s59, s59, 4096
    s_and_b32 s59, s59, 0x3fff
    buffer_load_dwordx4 v[176:179], v38, s[40:43], s59 offen offset:0 sc1
    buffer_load_dwordx4 v[180:183], v38, s[40:43], s59 offen offset:1024 sc1
    buffer_load_dwordx4 v[184:187], v38, s[40:43], s59 offen offset:2048 sc1
    s_waitcnt vmcnt(6) lgkmcnt(15)
    v_mfma_f32_16x16x32_bf16 v[224:227], a[0:3], v[160:163], v[224:227]
    buffer_load_dwordx4 v[188:191], v38, s[40:43], s59 offen offset:3072 sc1
    ds_read_b64_tr_b16 a[124:125], v29 offset:12288
    v_mfma_f32_16x16x32_bf16 v[228:231], a[4:7], v[160:163], v[228:231]
    ds_read_b64_tr_b16 a[126:127], v29 offset:13312
    ds_read_b64_tr_b16 a[128:129], v26 offset:16384
    s_waitcnt lgkmcnt(15)
    v_mfma_f32_16x16x32_bf16 v[232:235], a[8:11], v[160:163], v[232:235]
    ds_read_b64_tr_b16 a[130:131], v26 offset:17408
    v_mfma_f32_16x16x32_bf16 v[236:239], a[12:15], v[160:163], v[236:239]
    ds_read_b64_tr_b16 a[132:133], v27 offset:16384
    s_waitcnt vmcnt(6) lgkmcnt(15)
    v_mfma_f32_16x16x32_bf16 v[224:227], a[16:19], v[164:167], v[224:227]
    ds_read_b64_tr_b16 a[134:135], v27 offset:17408
    s_add_u32 s59, s59, 4096
    s_and_b32 s59, s59, 0x3fff
    buffer_load_dwordx4 v[192:195], v38, s[40:43], s59 offen offset:0 sc1
    v_mfma_f32_16x16x32_bf16 v[228:231], a[20:23], v[164:167], v[228:231]
    ds_read_b64_tr_b16 a[136:137], v28 offset:16384
    ds_read_b64_tr_b16 a[138:139], v28 offset:17408
    s_waitcnt lgkmcnt(15)
    v_mfma_f32_16x16x32_bf16 v[232:235], a[24:27], v[164:167], v[232:235]
    ds_read_b64_tr_b16 a[140:141], v29 offset:16384
    v_mfma_f32_16x16x32_bf16 v[236:239], a[28:31], v[164:167], v[236:239]
    ds_read_b64_tr_b16 a[142:143], v29 offset:17408
    s_waitcnt vmcnt(6) lgkmcnt(15)
    v_mfma_f32_16x16x32_bf16 v[224:227], a[32:35], v[168:171], v[224:227]
    ds_read_b64_tr_b16 a[144:145], v26 offset:20480
    buffer_load_dwordx4 v[196:199], v38, s[40:43], s59 offen offset:1024 sc1
    v_mfma_f32_16x16x32_bf16 v[228:231], a[36:39], v[168:171], v[228:231]
    ds_read_b64_tr_b16 a[146:147], v26 offset:21504
    ds_read_b64_tr_b16 a[148:149], v27 offset:20480
    s_waitcnt lgkmcnt(15)
    v_mfma_f32_16x16x32_bf16 v[232:235], a[40:43], v[168:171], v[232:235]
    ds_read_b64_tr_b16 a[150:151], v27 offset:21504
    v_mfma_f32_16x16x32_bf16 v[236:239], a[44:47], v[168:171], v[236:239]
    ds_read_b64_tr_b16 a[152:153], v28 offset:20480
    s_waitcnt vmcnt(6) lgkmcnt(15)
    v_mfma_f32_16x16x32_bf16 v[224:227], a[48:51], v[172:175], v[224:227]
    ds_read_b64_tr_b16 a[154:155], v28 offset:21504
    buffer_load_dwordx4 v[200:203], v38, s[40:43], s59 offen offset:2048 sc1
    v_mfma_f32_16x16x32_bf16 v[228:231], a[52:55], v[172:175], v[228:231]
    ds_read_b64_tr_b16 a[156:157], v29 offset:20480
    ds_read_b64_tr_b16 a[158:159], v29 offset:21504
    s_waitcnt lgkmcnt(15)
    v_mfma_f32_16x16x32_bf16 v[232:235], a[56:59], v[172:175], v[232:235]
    ds_read_b64_tr_b16 a[160:161], v26 offset:24576
    v_mfma_f32_16x16x32_bf16 v[236:239], a[60:63], v[172:175], v[236:239]
    ds_read_b64_tr_b16 a[162:163], v26 offset:25600
    s_waitcnt vmcnt(6) lgkmcnt(15)
    v_mfma_f32_16x16x32_bf16 v[224:227], a[64:67], v[176:179], v[224:227]
    ds_read_b64_tr_b16 a[164:165], v27 offset:24576
    buffer_load_dwordx4 v[204:207], v38, s[40:43], s59 offen offset:3072 sc1
    v_mfma_f32_16x16x32_bf16 v[228:231], a[68:71], v[176:179], v[228:231]
    ds_read_b64_tr_b16 a[166:167], v27 offset:25600
    ds_read_b64_tr_b16 a[168:169], v28 offset:24576
    s_waitcnt lgkmcnt(15)
    v_mfma_f32_16x16x32_bf16 v[232:235], a[72:75], v[176:179], v[232:235]
    ds_read_b64_tr_b16 a[170:171], v28 offset:25600
    v_mfma_f32_16x16x32_bf16 v[236:239], a[76:79], v[176:179], v[236:239]
    ds_read_b64_tr_b16 a[172:173], v29 offset:24576
    s_waitcnt vmcnt(6) lgkmcnt(15)
    v_mfma_f32_16x16x32_bf16 v[224:227], a[80:83], v[180:183], v[224:227]
    ds_read_b64_tr_b16 a[174:175], v29 offset:25600
    s_add_u32 s59, s59, 4096
    s_and_b32 s59, s59, 0x3fff
    buffer_load_dwordx4 v[208:211], v38, s[40:43], s59 offen offset:0 sc1
    v_mfma_f32_16x16x32_bf16 v[228:231], a[84:87], v[180:183], v[228:231]
    ds_read_b64_tr_b16 a[176:177], v26 offset:28672
    ds_read_b64_tr_b16 a[178:179], v26 offset:29696
    s_waitcnt lgkmcnt(15)
    v_mfma_f32_16x16x32_bf16 v[232:235], a[88:91], v[180:183], v[232:235]
    ds_read_b64_tr_b16 a[180:181], v27 offset:28672
    v_mfma_f32_16x16x32_bf16 v[236:239], a[92:95], v[180:183], v[236:239]
    ds_read_b64_tr_b16 a[182:183], v27 offset:29696
    s_waitcnt vmcnt(6) lgkmcnt(15)
    v_mfma_f32_16x16x32_bf16 v[224:227], a[96:99], v[184:187], v[224:227]
    ds_read_b64_tr_b16 a[184:185], v28 offset:28672
    buffer_load_dwordx4 v[212:215], v38, s[40:43], s59 offen offset:1024 sc1
    v_mfma_f32_16x16x32_bf16 v[228:231], a[100:103], v[184:187], v[228:231]
    ds_read_b64_tr_b16 a[186:187], v28 offset:29696
    ds_read_b64_tr_b16 a[188:189], v29 offset:28672
    s_waitcnt lgkmcnt(15)
    v_mfma_f32_16x16x32_bf16 v[232:235], a[104:107], v[184:187], v[232:235]
    ds_read_b64_tr_b16 a[190:191], v29 offset:29696
    v_mfma_f32_16x16x32_bf16 v[236:239], a[108:111], v[184:187], v[236:239]
    ds_read_b64_tr_b16 a[192:193], v26 offset:32768
    s_waitcnt vmcnt(6) lgkmcnt(15)
    v_mfma_f32_16x16x32_bf16 v[224:227], a[112:115], v[188:191], v[224:227]
    ds_read_b64_tr_b16 a[194:195], v26 offset:33792
    buffer_load_dwordx4 v[216:219], v38, s[40:43], s59 offen offset:2048 sc1
    v_mfma_f32_16x16x32_bf16 v[228:231], a[116:119], v[188:191], v[228:231]
    ds_read_b64_tr_b16 a[196:197], v27 offset:32768
    ds_read_b64_tr_b16 a[198:199], v27 offset:33792
    s_waitcnt lgkmcnt(15)
    v_mfma_f32_16x16x32_bf16 v[232:235], a[120:123], v[188:191], v[232:235]
    ds_read_b64_tr_b16 a[200:201], v28 offset:32768
    v_mfma_f32_16x16x32_bf16 v[236:239], a[124:127], v[188:191], v[236:239]
    ds_read_b64_tr_b16 a[202:203], v28 offset:33792
    s_waitcnt vmcnt(6) lgkmcnt(15)
    v_mfma_f32_16x16x32_bf16 v[224:227], a[128:131], v[192:195], v[224:227]
    ds_read_b64_tr_b16 a[204:205], v29 offset:32768
    buffer_load_dwordx4 v[220:223], v38, s[40:43], s59 offen offset:3072 sc1
    v_mfma_f32_16x16x32_bf16 v[228:231], a[132:135], v[192:195], v[228:231]
    ds_read_b64_tr_b16 a[206:207], v29 offset:33792
    ds_read_b64_tr_b16 a[208:209], v26 offset:36864
    s_waitcnt lgkmcnt(15)
    v_mfma_f32_16x16x32_bf16 v[232:235], a[136:139], v[192:195], v[232:235]
    ds_read_b64_tr_b16 a[210:211], v26 offset:37888
    v_mfma_f32_16x16x32_bf16 v[236:239], a[140:143], v[192:195], v[236:239]
    ds_read_b64_tr_b16 a[212:213], v27 offset:36864
    s_waitcnt vmcnt(6) lgkmcnt(15)
    v_mfma_f32_16x16x32_bf16 v[224:227], a[144:147], v[196:199], v[224:227]
    ds_read_b64_tr_b16 a[214:215], v27 offset:37888
    buffer_load_dwordx4 v41, s[20:23], s94 offen offset:3072 lds
    v_mfma_f32_16x16x32_bf16 v[228:231], a[148:151], v[196:199], v[228:231]
    ds_read_b64_tr_b16 a[216:217], v28 offset:36864
    ds_read_b64_tr_b16 a[218:219], v28 offset:37888
    s_waitcnt lgkmcnt(15)
    v_mfma_f32_16x16x32_bf16 v[232:235], a[152:155], v[196:199], v[232:235]
    ds_read_b64_tr_b16 a[220:221], v29 offset:36864
    v_mfma_f32_16x16x32_bf16 v[236:239], a[156:159], v[196:199], v[236:239]
    ds_read_b64_tr_b16 a[222:223], v29 offset:37888
    s_waitcnt vmcnt(6) lgkmcnt(15)
    v_mfma_f32_16x16x32_bf16 v[224:227], a[160:163], v[200:203], v[224:227]
    ds_read_b64_tr_b16 a[224:225], v26 offset:40960
    s_mov_b32 s97, 0x70000
    s_cmp_eq_u32 s86, 2
    s_cselect_b32 s97, 0xffeb0000, s97
    v_add_u32 v41, s97, v41
    s_add_u32 m0, s62, 114688
    s_nop 0
    buffer_load_dwordx4 v41, s[20:23], 0 offen offset:0 lds
    v_mfma_f32_16x16x32_bf16 v[228:231], a[164:167], v[200:203], v[228:231]
    ds_read_b64_tr_b16 a[226:227], v26 offset:41984
    ds_read_b64_tr_b16 a[228:229], v27 offset:40960
    s_waitcnt lgkmcnt(15)
    v_mfma_f32_16x16x32_bf16 v[232:235], a[168:171], v[200:203], v[232:235]
    ds_read_b64_tr_b16 a[230:231], v27 offset:41984
    v_mfma_f32_16x16x32_bf16 v[236:239], a[172:175], v[200:203], v[236:239]
    ds_read_b64_tr_b16 a[232:233], v28 offset:40960
    s_waitcnt vmcnt(6) lgkmcnt(15)
    v_mfma_f32_16x16x32_bf16 v[224:227], a[176:179], v[204:207], v[224:227]
    ds_read_b64_tr_b16 a[234:235], v28 offset:41984
    buffer_load_dwordx4 v41, s[20:23], s92 offen offset:1024 lds
    v_mfma_f32_16x16x32_bf16 v[228:231], a[180:183], v[204:207], v[228:231]
    ds_read_b64_tr_b16 a[236:237], v29 offset:40960
    ds_read_b64_tr_b16 a[238:239], v29 offset:41984
    s_waitcnt lgkmcnt(15)
    v_mfma_f32_16x16x32_bf16 v[232:235], a[184:187], v[204:207], v[232:235]
    ds_read_b64_tr_b16 a[240:241], v26 offset:45056
    v_mfma_f32_16x16x32_bf16 v[236:239], a[188:191], v[204:207], v[236:239]
    ds_read_b64_tr_b16 a[242:243], v26 offset:46080
    s_waitcnt vmcnt(6) lgkmcnt(15)
    v_mfma_f32_16x16x32_bf16 v[224:227], a[192:195], v[208:211], v[224:227]
    ds_read_b64_tr_b16 a[244:245], v27 offset:45056
    buffer_load_dwordx4 v41, s[20:23], s93 offen offset:2048 lds
    v_mfma_f32_16x16x32_bf16 v[228:231], a[196:199], v[208:211], v[228:231]
    ds_read_b64_tr_b16 a[246:247], v27 offset:46080
    ds_read_b64_tr_b16 a[248:249], v28 offset:45056
    s_waitcnt lgkmcnt(15)
    v_mfma_f32_16x16x32_bf16 v[232:235], a[200:203], v[208:211], v[232:235]
    ds_read_b64_tr_b16 a[250:251], v28 offset:46080
    v_mfma_f32_16x16x32_bf16 v[236:239], a[204:207], v[208:211], v[236:239]
    ds_read_b64_tr_b16 a[252:253], v29 offset:45056
    s_waitcnt vmcnt(6) lgkmcnt(15)
    v_mfma_f32_16x16x32_bf16 v[224:227], a[208:211], v[212:215], v[224:227]
    ds_read_b64_tr_b16 a[254:255], v29 offset:46080
    buffer_load_dwordx4 v41, s[20:23], s94 offen offset:3072 lds
    v_mfma_f32_16x16x32_bf16 v[228:231], a[212:215], v[212:215], v[228:231]
    s_waitcnt lgkmcnt(15)
    v_mfma_f32_16x16x32_bf16 v[232:235], a[216:219], v[212:215], v[232:235]
    v_mfma_f32_16x16x32_bf16 v[236:239], a[220:223], v[212:215], v[236:239]
    s_waitcnt vmcnt(6) lgkmcnt(12)
    v_mfma_f32_16x16x32_bf16 v[224:227], a[224:227], v[216:219], v[224:227]
    v_mfma_f32_16x16x32_bf16 v[228:231], a[228:231], v[216:219], v[228:231]
    s_waitcnt lgkmcnt(8)
    v_mfma_f32_16x16x32_bf16 v[232:235], a[232:235], v[216:219], v[232:235]
    v_mfma_f32_16x16x32_bf16 v[236:239], a[236:239], v[216:219], v[236:239]
    s_waitcnt vmcnt(5) lgkmcnt(4)
    v_mfma_f32_16x16x32_bf16 v[224:227], a[240:243], v[220:223], v[224:227]
    v_mfma_f32_16x16x32_bf16 v[228:231], a[244:247], v[220:223], v[228:231]
    s_waitcnt lgkmcnt(0)
    v_mfma_f32_16x16x32_bf16 v[232:235], a[248:251], v[220:223], v[232:235]
    v_mfma_f32_16x16x32_bf16 v[236:239], a[252:255], v[220:223], v[236:239]
    s_movk_i32 s58, 24576
    s_nop 2
    v_cvt_pk_bf16_f32 v18, v224, v225
    v_cvt_pk_bf16_f32 v19, v226, v227
    v_cvt_pk_bf16_f32 v20, v228, v229
    v_cvt_pk_bf16_f32 v21, v230, v231
    v_cvt_pk_bf16_f32 v22, v232, v233
    v_cvt_pk_bf16_f32 v23, v234, v235
    v_cvt_pk_bf16_f32 v24, v236, v237
    v_cvt_pk_bf16_f32 v25, v238, v239
    buffer_store_dwordx4 v[18:21], v113, s[40:43], 0 offen offset:0 sc1
    buffer_store_dwordx4 v[22:25], v113, s[40:43], 0 offen offset:2048 sc1
    v_dot2c_f32_bf16 v4, s57, v18
    v_dot2c_f32_bf16 v5, v18, v18
    v_dot2c_f32_bf16 v4, s57, v19
    v_dot2c_f32_bf16 v5, v19, v19
    v_dot2c_f32_bf16 v4, s57, v20
    v_dot2c_f32_bf16 v5, v20, v20
    v_dot2c_f32_bf16 v4, s57, v21
    v_dot2c_f32_bf16 v5, v21, v21
    v_dot2c_f32_bf16 v4, s57, v22
    v_dot2c_f32_bf16 v5, v22, v22
    v_dot2c_f32_bf16 v4, s57, v23
    v_dot2c_f32_bf16 v5, v23, v23
    v_dot2c_f32_bf16 v4, s57, v24
    v_dot2c_f32_bf16 v5, v24, v24
    v_dot2c_f32_bf16 v4, s57, v25
    v_dot2c_f32_bf16 v5, v25, v25
    s_nop 2
    v_permlane32_swap_b32 v4, v5
    v_add_f32 v4, v4, v5
    v_mov_b32 v5, v4
    s_nop 1
    v_permlane16_swap_b32 v4, v5
    v_add_f32 v4, v4, v5
    buffer_store_dword v4, v114, s[40:43], 0 offen sc1
    s_barrier
    v_and_b32 v40, 131071, v40
    s_mov_b32 s97, 0x6f900
    s_cmp_eq_u32 s86, 1
    s_cselect_b32 s97, 0xffeaf900, s97
    v_add_u32 v41, s97, v41
    s_add_u32 m0, s62, 49152
    s_nop 0
    buffer_load_dwordx4 v41, s[20:23], 0 offen offset:0 lds
    buffer_load_dwordx4 v41, s[20:23], s92 offen offset:1024 lds
    v_and_b32 v37, 19, v0
    v_bfe_u32 v1, v0, 2, 1
    v_lshl_add_u32 v37, v1, 3, v37
    v_bfe_u32 v1, v0, 3, 1
    v_lshl_add_u32 v37, v1, 2, v37
    s_lshl_b32 s88, s95, 15
    s_lshl_b32 s91, s50, 17
    s_add_u32 s88, s88, s91
    s_add_u32 s88, s88, 4325376
    v_lshl_add_u32 v49, v37, 4, s88
    v_lshrrev_b32 v1, 5, v0
    v_lshl_add_u32 v49, v1, 9, v49
    s_lshl_b32 s88, s95, 11
    s_add_u32 s88, s88, 131072
    v_lshl_add_u32 v48, v37, 3, s88
    v_lshl_add_u32 v48, v1, 10, v48
    s_lshl_b32 s88, s95, 6
    v_lshl_add_u32 v51, v37, 1, s88
    s_lshl_b32 s3, s50, 18
    s_add_u32 s3, s3, 12582912
    s_mul_i32 s88, s44, 57344
    s_lshl_b32 s91, s48, 11
    s_add_u32 s88, s88, s91
    s_add_u32 s88, s88, s3
    v_and_b32 v38, 15, v37
    v_lshl_add_u32 v50, v1, 8, s88
    v_lshl_add_u32 v50, v38, 4, v50
    v_bfe_u32 v1, v0, 4, 1
    v_mul_u32_u24 v1, 28672, v1
    v_add_u32 v50, v50, v1
    s_lshl_b32 s88, s95, 7
    v_and_b32 v1, 15, v0
    v_lshl_add_u32 v38, v1, 2, s88
    s_or_b32 s88, s2, s44
    v_or_b32 v37, s88, v0
    v_cmp_eq_u32 vcc, 0, v37
    s_add_u32 s59, s44, s86
    s_and_b32 s59, s59, 3
    s_lshl_b32 s59, s59, 13
    s_lshl_b32 s60, s44, 14
    v_cndmask_b32 v1, v39, v37, vcc
    s_waitcnt vmcnt(3)
    buffer_store_dword v45, v112, s[40:43], s58 offen sc1
    buffer_store_dword v45, v1, s[40:43], 0 offen offset:0
    s_cmp_ge_u32 s48, 14
    s_cbranch_scc1 L_spare_wt
L_s4_wt:
    s_barrier
    buffer_load_dword v47, v38, s[40:43], s58 offen sc1
    buffer_load_dwordx4 v41, s[20:23], s93 offen offset:2048 lds
    buffer_load_dwordx4 v41, s[20:23], s94 offen offset:3072 lds
    s_add_u32 s97, s60, 81920
    v_add_u32 v52, s97, v43
    v_xor_b32 v53, 64, v52
    ds_read_b64_tr_b16 v[76:77], v52 offset:0
    ds_read_b64_tr_b16 v[78:79], v52 offset:2048
    ds_read_b64_tr_b16 v[80:81], v53 offset:0
    ds_read_b64_tr_b16 v[82:83], v53 offset:2048
    ds_read_b64_tr_b16 v[84:85], v52 offset:1024
    ds_read_b64_tr_b16 v[86:87], v52 offset:3072
    ds_read_b64_tr_b16 v[88:89], v53 offset:1024
    ds_read_b64_tr_b16 v[90:91], v53 offset:3072
    s_mov_b32 s61, 0
    s_branch L_got_14_wt
L_again_15_wt:
    buffer_load_dword v47, v38, s[40:43], s58 offen sc1
    s_addk_i32 s61, 1
    s_cmp_gt_u32 s61, 0x80000
    s_cbranch_scc1 L_abort_wt
    s_waitcnt vmcnt(0)
L_got_14_wt:
    s_waitcnt vmcnt(2)
    v_cmp_ne_u32 vcc, s53, v47
    s_cbranch_vccnz L_again_15_wt
    buffer_load_dwordx4 v[128:131], v49, s[40:43], s59 offen offset:0 sc1
    buffer_load_dwordx4 v[132:135], v49, s[40:43], s59 offen offset:1024 sc1
    buffer_load_dwordx4 v[136:139], v49, s[40:43], s59 offen offset:2048 sc1
    buffer_load_dwordx4 v[140:143], v49, s[40:43], s59 offen offset:3072 sc1
    s_add_u32 s59, s59, 4096
    s_and_b32 s59, s59, 0x7fff
    buffer_load_dwordx4 v[144:147], v49, s[40:43], s59 offen offset:0 sc1
    s_waitcnt vmcnt(4) lgkmcnt(6)
    v_mfma_f32_32x32x16_bf16 v[96:111], v[76:79], v[128:131], 0
    buffer_load_dwordx4 v[148:151], v49, s[40:43], s59 offen offset:1024 sc1
    ds_read_b64_tr_b16 v[92:93], v52 offset:4096
    ds_read_b64_tr_b16 v[94:95], v52 offset:6144
    v_mfma_f32_16x16x32_bf16 v[62:65], v[14:17], v[76:79], 0
    s_waitcnt lgkmcnt(6)
    v_mfma_f32_32x32x16_bf16 v[112:127], v[80:83], v[128:131], 0
    buffer_load_dwordx4 v[152:155], v49, s[40:43], s59 offen offset:2048 sc1
    ds_read_b64_tr_b16 v[76:77], v53 offset:4096
    ds_read_b64_tr_b16 v[78:79], v53 offset:6144
    v_mfma_f32_16x16x32_bf16 v[66:69], v[14:17], v[80:83], 0
    s_waitcnt vmcnt(5) lgkmcnt(6)
    v_mfma_f32_32x32x16_bf16 v[96:111], v[84:87], v[132:135], v[96:111]
    buffer_load_dwordx4 v[156:159], v49, s[40:43], s59 offen offset:3072 sc1
    ds_read_b64_tr_b16 v[80:81], v52 offset:5120
    ds_read_b64_tr_b16 v[82:83], v52 offset:7168
    v_mfma_f32_16x16x32_bf16 v[62:65], v[14:17], v[84:87], v[62:65]
    s_waitcnt lgkmcnt(6)
    v_mfma_f32_32x32x16_bf16 v[112:127], v[88:91], v[132:135], v[112:127]
    s_add_u32 s59, s59, 4096
    s_and_b32 s59, s59, 0x7fff
    buffer_load_dwordx4 v[160:163], v49, s[40:43], s59 offen offset:0 sc1
    ds_read_b64_tr_b16 v[84:85], v53 offset:5120
    ds_read_b64_tr_b16 v[86:87], v53 offset:7168
    v_mfma_f32_16x16x32_bf16 v[66:69], v[14:17], v[88:91], v[66:69]
    s_waitcnt vmcnt(6) lgkmcnt(6)
    v_mfma_f32_32x32x16_bf16 v[96:111], v[92:95], v[136:139], v[96:111]
    buffer_load_dwordx4 v[164:167], v49, s[40:43], s59 offen offset:1024 sc1
    ds_read_b64_tr_b16 v[88:89], v52 offset:8192
    ds_read_b64_tr_b16 v[90:91], v52 offset:10240
    v_mfma_f32_16x16x32_bf16 v[62:65], v[14:17], v[92:95], v[62:65]
    s_waitcnt lgkmcnt(6)
    v_mfma_f32_32x32x16_bf16 v[112:127], v[76:79], v[136:139], v[112:127]
    buffer_load_dwordx4 v[168:171], v49, s[40:43], s59 offen offset:2048 sc1
    ds_read_b64_tr_b16 v[92:93], v53 offset:8192
    ds_read_b64_tr_b16 v[94:95], v53 offset:10240
    v_mfma_f32_16x16x32_bf16 v[66:69], v[14:17], v[76:79], v[66:69]
    s_waitcnt vmcnt(7) lgkmcnt(6)
    v_mfma_f32_32x32x16_bf16 v[96:111], v[80:83], v[140:143], v[96:111]
    buffer_load_dwordx4 v[172:175], v49, s[40:43], s59 offen offset:3072 sc1
    ds_read_b64_tr_b16 v[76:77], v52 offset:9216
    ds_read_b64_tr_b16 v[78:79], v52 offset:11264
    v_mfma_f32_16x16x32_bf16 v[62:65], v[14:17], v[80:83], v[62:65]
    s_waitcnt lgkmcnt(6)
    v_mfma_f32_32x32x16_bf16 v[112:127], v[84:87], v[140:143], v[112:127]
    buffer_load_dwordx2 v[54:55], v48, s[40:43], 0 offen offset:0 sc1
    ds_read_b64_tr_b16 v[80:81], v53 offset:9216
    ds_read_b64_tr_b16 v[82:83], v53 offset:11264
    v_mfma_f32_16x16x32_bf16 v[66:69], v[14:17], v[84:87], v[66:69]
    s_waitcnt vmcnt(8) lgkmcnt(6)
    v_mfma_f32_32x32x16_bf16 v[96:111], v[88:91], v[144:147], v[96:111]
    buffer_load_dwordx2 v[56:57], v48, s[40:43], 0 offen offset:256 sc1
    ds_read_b64_tr_b16 v[84:85], v52 offset:12288
    ds_read_b64_tr_b16 v[86:87], v52 offset:14336
    v_mfma_f32_16x16x32_bf16 v[62:65], v[14:17], v[88:91], v[62:65]
    s_waitcnt lgkmcnt(6)
    v_mfma_f32_32x32x16_bf16 v[112:127], v[92:95], v[144:147], v[112:127]
    buffer_load_dwordx2 v[58:59], v48, s[40:43], 0 offen offset:512 sc1
    ds_read_b64_tr_b16 v[88:89], v53 offset:12288
    ds_read_b64_tr_b16 v[90:91], v53 offset:14336
    v_mfma_f32_16x16x32_bf16 v[66:69], v[14:17], v[92:95], v[66:69]
    s_waitcnt vmcnt(9) lgkmcnt(6)
    v_mfma_f32_32x32x16_bf16 v[96:111], v[76:79], v[148:151], v[96:111]
    buffer_load_dwordx2 v[60:61], v48, s[40:43], 0 offen offset:768 sc1
    ds_read_b64_tr_b16 v[92:93], v52 offset:13312
    ds_read_b64_tr_b16 v[94:95], v52 offset:15360
    v_mfma_f32_16x16x32_bf16 v[62:65], v[14:17], v[76:79], v[62:65]
    s_waitcnt lgkmcnt(6)
    v_mfma_f32_32x32x16_bf16 v[112:127], v[80:83], v[148:151], v[112:127]
    s_add_u32 s59, s59, 4096
    s_and_b32 s59, s59, 0x7fff
    buffer_load_dwordx4 v[176:179], v49, s[40:43], s59 offen offset:0 sc1
    ds_read_b64_tr_b16 v[76:77], v53 offset:13312
    ds_read_b64_tr_b16 v[78:79], v53 offset:15360
    v_mfma_f32_16x16x32_bf16 v[66:69], v[14:17], v[80:83], v[66:69]
    s_waitcnt vmcnt(10) lgkmcnt(6)
    v_mfma_f32_32x32x16_bf16 v[96:111], v[84:87], v[152:155], v[96:111]
    buffer_load_dwordx4 v[180:183], v49, s[40:43], s59 offen offset:1024 sc1
    s_add_u32 s60, s60, 16384
    s_and_b32 s60, s60, 0xffff
    s_add_u32 s97, s60, 81920
    v_add_u32 v52, s97, v43
    v_xor_b32 v53, 64, v52
    ds_read_b64_tr_b16 v[80:81], v52 offset:0
    ds_read_b64_tr_b16 v[82:83], v52 offset:2048
    v_mfma_f32_16x16x32_bf16 v[62:65], v[14:17], v[84:87], v[62:65]
    s_waitcnt lgkmcnt(6)
    v_mfma_f32_32x32x16_bf16 v[112:127], v[88:91], v[152:155], v[112:127]
    buffer_load_dwordx4 v[184:187], v49, s[40:43], s59 offen offset:2048 sc1
    ds_read_b64_tr_b16 v[84:85], v53 offset:0
    ds_read_b64_tr_b16 v[86:87], v53 offset:2048
    v_mfma_f32_16x16x32_bf16 v[66:69], v[14:17], v[88:91], v[66:69]
    s_waitcnt vmcnt(11) lgkmcnt(6)
    v_mfma_f32_32x32x16_bf16 v[96:111], v[92:95], v[156:159], v[96:111]
    buffer_load_dwordx4 v[188:191], v49, s[40:43], s59 offen offset:3072 sc1
    ds_read_b64_tr_b16 v[88:89], v52 offset:1024
    ds_read_b64_tr_b16 v[90:91], v52 offset:3072
    v_mfma_f32_16x16x32_bf16 v[62:65], v[14:17], v[92:95], v[62:65]
    s_waitcnt lgkmcnt(6)
    v_mfma_f32_32x32x16_bf16 v[112:127], v[76:79], v[156:159], v[112:127]
    s_add_u32 s59, s59, 4096
    s_and_b32 s59, s59, 0x7fff
    buffer_load_dwordx4 v[192:195], v49, s[40:43], s59 offen offset:0 sc1
    ds_read_b64_tr_b16 v[92:93], v53 offset:1024
    ds_read_b64_tr_b16 v[94:95], v53 offset:3072
    v_mfma_f32_16x16x32_bf16 v[66:69], v[14:17], v[76:79], v[66:69]
    s_waitcnt vmcnt(12) lgkmcnt(6)
    v_mfma_f32_32x32x16_bf16 v[96:111], v[80:83], v[160:163], v[96:111]
    buffer_load_dwordx4 v[196:199], v49, s[40:43], s59 offen offset:1024 sc1
    ds_read_b64_tr_b16 v[76:77], v52 offset:4096
    ds_read_b64_tr_b16 v[78:79], v52 offset:6144
    s_waitcnt lgkmcnt(6)
    v_mfma_f32_32x32x16_bf16 v[112:127], v[84:87], v[160:163], v[112:127]
    ds_read_b64_tr_b16 v[80:81], v53 offset:4096
    ds_read_b64_tr_b16 v[82:83], v53 offset:6144
    s_waitcnt vmcnt(12) lgkmcnt(6)
    v_mfma_f32_32x32x16_bf16 v[96:111], v[88:91], v[164:167], v[96:111]
    buffer_load_dwordx4 v[200:203], v49, s[40:43], s59 offen offset:2048 sc1
    ds_read_b64_tr_b16 v[84:85], v52 offset:5120
    ds_read_b64_tr_b16 v[86:87], v52 offset:7168
    s_lshl2_add_u32 s97, s44, 155648
    v_add_u32 v38, s97, v36
    s_waitcnt lgkmcnt(6)
    v_mfma_f32_32x32x16_bf16 v[112:127], v[92:95], v[164:167], v[112:127]
    ds_read_b64_tr_b16 v[88:89], v53 offset:5120
    ds_read_b64_tr_b16 v[90:91], v53 offset:7168
    s_waitcnt vmcnt(12) lgkmcnt(6)
    v_mfma_f32_32x32x16_bf16 v[96:111], v[76:79], v[168:171], v[96:111]
    buffer_load_dwordx4 v[204:207], v49, s[40:43], s59 offen offset:3072 sc1
    ds_read_b64_tr_b16 v[92:93], v52 offset:8192
    ds_read_b64_tr_b16 v[94:95], v52 offset:10240
    ds_write_b32 v38, v62 offset:0
    s_waitcnt lgkmcnt(7)
    v_mfma_f32_32x32x16_bf16 v[112:127], v[80:83], v[168:171], v[112:127]
    ds_read_b64_tr_b16 v[76:77], v53 offset:8192
    ds_read_b64_tr_b16 v[78:79], v53 offset:10240
    ds_write_b32 v38, v66 offset:1024
    s_waitcnt vmcnt(12) lgkmcnt(8)
    v_mfma_f32_32x32x16_bf16 v[96:111], v[84:87], v[172:175], v[96:111]
    s_add_u32 s59, s59, 4096
    s_and_b32 s59, s59, 0x7fff
    buffer_load_dwordx4 v[208:211], v49, s[40:43], s59 offen offset:0 sc1
    ds_read_b64_tr_b16 v[80:81], v52 offset:9216
    ds_read_b64_tr_b16 v[82:83], v52 offset:11264
    s_waitcnt lgkmcnt(8)
    v_mfma_f32_32x32x16_bf16 v[112:127], v[88:91], v[172:175], v[112:127]
    ds_read_b64_tr_b16 v[84:85], v53 offset:9216
    ds_read_b64_tr_b16 v[86:87], v53 offset:11264
    s_waitcnt vmcnt(8) lgkmcnt(8)
    v_mfma_f32_32x32x16_bf16 v[96:111], v[92:95], v[176:179], v[96:111]
    buffer_load_dwordx4 v[212:215], v49, s[40:43], s59 offen offset:1024 sc1
    ds_read_b64_tr_b16 v[88:89], v52 offset:12288
    ds_read_b64_tr_b16 v[90:91], v52 offset:14336
    v_add_u32 v38, 155648, v36
    s_waitcnt lgkmcnt(7)
    v_mfma_f32_32x32x16_bf16 v[112:127], v[76:79], v[176:179], v[112:127]
    ds_read_b64_tr_b16 v[92:93], v53 offset:12288
    ds_read_b64_tr_b16 v[94:95], v53 offset:14336
    s_waitcnt vmcnt(8) lgkmcnt(6)
    v_mfma_f32_32x32x16_bf16 v[96:111], v[80:83], v[180:183], v[96:111]
    buffer_load_dwordx4 v[216:219], v49, s[40:43], s59 offen offset:2048 sc1
    v_add_f32 v54, v54, v56
    v_add_f32 v58, v58, v60
    v_add_f32 v4, v54, v58
    v_add_f32 v55, v55, v57
    v_add_f32 v59, v59, v61
    v_add_f32 v5, v55, v59
    v_cmp_u_f32 vcc, v4, v5
    s_cbranch_vccnz L_retry_16_wt
L_got_17_wt:
    ds_read_b64_tr_b16 v[76:77], v52 offset:13312
    ds_read_b64_tr_b16 v[78:79], v52 offset:15360
    s_waitcnt lgkmcnt(6)
    v_mfma_f32_32x32x16_bf16 v[112:127], v[84:87], v[180:183], v[112:127]
    ds_read_b64_tr_b16 v[80:81], v53 offset:13312
    ds_read_b64_tr_b16 v[82:83], v53 offset:15360
    s_mov_b32 s12, 0xc0135761
    s_mov_b32 s13, 0xbdd2d3e8
    s_waitcnt vmcnt(8) lgkmcnt(6)
    v_mfma_f32_32x32x16_bf16 v[96:111], v[88:91], v[184:187], v[96:111]
    buffer_load_dwordx4 v[220:223], v49, s[40:43], s59 offen offset:3072 sc1
    s_add_u32 s60, s60, 16384
    s_and_b32 s60, s60, 0xffff
    s_add_u32 s97, s60, 81920
    v_add_u32 v52, s97, v43
    v_xor_b32 v53, 64, v52
    ds_read_b64_tr_b16 v[84:85], v52 offset:0
    ds_read_b64_tr_b16 v[86:87], v52 offset:2048
    s_waitcnt lgkmcnt(6)
    v_mfma_f32_32x32x16_bf16 v[112:127], v[92:95], v[184:187], v[112:127]
    ds_read_b64_tr_b16 v[88:89], v53 offset:0
    ds_read_b64_tr_b16 v[90:91], v53 offset:2048
    v_permlane32_swap_b32 v4, v5
    s_waitcnt vmcnt(8) lgkmcnt(6)
    v_mfma_f32_32x32x16_bf16 v[96:111], v[76:79], v[188:191], v[96:111]
    s_add_u32 s59, s59, 4096
    s_and_b32 s59, s59, 0x7fff
    buffer_load_dwordx4 v[224:227], v49, s[40:43], s59 offen offset:0 sc1
    ds_read_b64_tr_b16 v[92:93], v52 offset:1024
    ds_read_b64_tr_b16 v[94:95], v52 offset:3072
    s_waitcnt lgkmcnt(6)
    v_mfma_f32_32x32x16_bf16 v[112:127], v[80:83], v[188:191], v[112:127]
    ds_read_b64_tr_b16 v[76:77], v53 offset:1024
    ds_read_b64_tr_b16 v[78:79], v53 offset:3072
    v_add_f32 v4, v4, v5
    v_mov_b32 v5, v4
    s_waitcnt vmcnt(8) lgkmcnt(6)
    v_mfma_f32_32x32x16_bf16 v[96:111], v[84:87], v[192:195], v[96:111]
    buffer_load_dwordx4 v[228:231], v49, s[40:43], s59 offen offset:1024 sc1
    ds_read_b64_tr_b16 v[80:81], v52 offset:4096
    ds_read_b64_tr_b16 v[82:83], v52 offset:6144
    s_barrier
    s_waitcnt lgkmcnt(6)
    v_mfma_f32_32x32x16_bf16 v[112:127], v[88:91], v[192:195], v[112:127]
    ds_read_b64_tr_b16 v[84:85], v53 offset:4096
    ds_read_b64_tr_b16 v[86:87], v53 offset:6144
    v_permlane32_swap_b32 v4, v5
    s_waitcnt vmcnt(8) lgkmcnt(6)
    v_mfma_f32_32x32x16_bf16 v[96:111], v[92:95], v[196:199], v[96:111]
    buffer_load_dwordx4 v[232:235], v49, s[40:43], s59 offen offset:2048 sc1
    ds_read_b64_tr_b16 v[88:89], v52 offset:5120
    ds_read_b64_tr_b16 v[90:91], v52 offset:7168
    ds_read_b128 v[62:65], v38 offset:0
    s_waitcnt lgkmcnt(7)
    v_mfma_f32_32x32x16_bf16 v[112:127], v[76:79], v[196:199], v[112:127]
    ds_read_b64_tr_b16 v[92:93], v53 offset:5120
    ds_read_b64_tr_b16 v[94:95], v53 offset:7168
    ds_read_b128 v[66:69], v38 offset:1024
    v_mul_f32 v4, 0x3b000000, v4
    s_waitcnt vmcnt(8) lgkmcnt(8)
    v_mfma_f32_32x32x16_bf16 v[96:111], v[80:83], v[200:203], v[96:111]
    buffer_load_dwordx4 v[236:239], v49, s[40:43], s59 offen offset:3072 sc1
    ds_read_b64_tr_b16 v[76:77], v52 offset:8192
    ds_read_b64_tr_b16 v[78:79], v52 offset:10240
    v_mul_f32 v37, v4, v4
    s_waitcnt lgkmcnt(8)
    v_mfma_f32_32x32x16_bf16 v[112:127], v[84:87], v[200:203], v[112:127]
    ds_read_b64_tr_b16 v[80:81], v53 offset:8192
    ds_read_b64_tr_b16 v[82:83], v53 offset:10240
    v_fmamk_f32 v5, v5, 0xbb000000, v37
    v_min_f32 v5, 0, v5
    s_waitcnt vmcnt(8) lgkmcnt(8)
    v_mfma_f32_32x32x16_bf16 v[96:111], v[88:91], v[204:207], v[96:111]
    s_add_u32 s59, s59, 4096
    s_and_b32 s59, s59, 0x7fff
    buffer_load_dwordx4 v[240:243], v49, s[40:43], s59 offen offset:0 sc1
    ds_read_b64_tr_b16 v[84:85], v52 offset:9216
    ds_read_b64_tr_b16 v[86:87], v52 offset:11264
    s_waitcnt lgkmcnt(7)
    v_mfma_f32_32x32x16_bf16 v[112:127], v[92:95], v[204:207], v[112:127]
    ds_read_b64_tr_b16 v[88:89], v53 offset:9216
    ds_read_b64_tr_b16 v[90:91], v53 offset:11264
    v_sub_f32 v5, 0x3727c5ac, v5
    v_mul_f32 v60, 0x3727c5ac, v5
    s_waitcnt vmcnt(8) lgkmcnt(6)
    v_mfma_f32_32x32x16_bf16 v[96:111], v[76:79], v[208:211], v[96:111]
    buffer_load_dwordx4 v[244:247], v49, s[40:43], s59 offen offset:1024 sc1
    ds_read_b64_tr_b16 v[92:93], v52 offset:12288
    ds_read_b64_tr_b16 v[94:95], v52 offset:14336
    s_waitcnt lgkmcnt(6)
    v_mfma_f32_32x32x16_bf16 v[112:127], v[80:83], v[208:211], v[112:127]
    ds_read_b64_tr_b16 v[76:77], v53 offset:12288
    ds_read_b64_tr_b16 v[78:79], v53 offset:14336
    v_rsq_f32 v5, v5
    s_waitcnt vmcnt(8) lgkmcnt(6)
    v_mfma_f32_32x32x16_bf16 v[96:111], v[84:87], v[212:215], v[96:111]
    buffer_load_dwordx4 v[248:251], v49, s[40:43], s59 offen offset:2048 sc1
    ds_read_b64_tr_b16 v[80:81], v52 offset:13312
    ds_read_b64_tr_b16 v[82:83], v52 offset:15360
    v_cvt_pk_bf16_f32 v54, -v4, -v4
    s_waitcnt lgkmcnt(6)
    v_mfma_f32_32x32x16_bf16 v[112:127], v[88:91], v[212:215], v[112:127]
    ds_read_b64_tr_b16 v[84:85], v53 offset:13312
    ds_read_b64_tr_b16 v[86:87], v53 offset:15360
    v_and_b32 v37, 0xffff0000, v54
    v_sub_f32 v37, -v4, v37
    s_waitcnt vmcnt(8) lgkmcnt(6)
    v_mfma_f32_32x32x16_bf16 v[96:111], v[92:95], v[216:219], v[96:111]
    buffer_load_dwordx4 v[252:255], v49, s[40:43], s59 offen offset:3072 sc1
    s_add_u32 s60, s60, 16384
    s_and_b32 s60, s60, 0xffff
    s_add_u32 s97, s60, 81920
    v_add_u32 v52, s97, v43
    v_xor_b32 v53, 64, v52
    ds_read_b64_tr_b16 v[88:89], v52 offset:0
    ds_read_b64_tr_b16 v[90:91], v52 offset:2048
    s_waitcnt lgkmcnt(6)
    v_mfma_f32_32x32x16_bf16 v[112:127], v[76:79], v[216:219], v[112:127]
    ds_read_b64_tr_b16 v[92:93], v53 offset:0
    ds_read_b64_tr_b16 v[94:95], v53 offset:2048
    v_cvt_pk_bf16_f32 v55, v37, 0
    v_mov_b32 v56, 0
    s_waitcnt vmcnt(8) lgkmcnt(6)
    v_mfma_f32_32x32x16_bf16 v[96:111], v[80:83], v[220:223], v[96:111]
    buffer_load_ushort v51, v51, s[28:31], 0 offen
    ds_read_b64_tr_b16 v[76:77], v52 offset:1024
    ds_read_b64_tr_b16 v[78:79], v52 offset:3072
    v_mov_b32 v57, 0
    s_waitcnt lgkmcnt(6)
    v_mfma_f32_32x32x16_bf16 v[112:127], v[84:87], v[220:223], v[112:127]
    ds_read_b64_tr_b16 v[80:81], v53 offset:1024
    ds_read_b64_tr_b16 v[82:83], v53 offset:3072
    s_mov_b32 s97, 0x70000
    s_cmp_eq_u32 s86, 0
    s_cselect_b32 s97, 0xffeb0000, s97
    v_add_u32 v41, s97, v41
    s_add_u32 m0, s62, 0
    s_waitcnt vmcnt(8) lgkmcnt(6)
    v_mfma_f32_32x32x16_bf16 v[96:111], v[88:91], v[224:227], v[96:111]
    buffer_load_dwordx4 v41, s[20:23], 0 offen offset:0 lds
    ds_read_b64_tr_b16 v[84:85], v52 offset:4096
    ds_read_b64_tr_b16 v[86:87], v52 offset:6144
    v_mov_b32 v4, v5
    s_waitcnt lgkmcnt(6)
    v_mfma_f32_32x32x16_bf16 v[112:127], v[92:95], v[224:227], v[112:127]
    ds_read_b64_tr_b16 v[88:89], v53 offset:4096
    ds_read_b64_tr_b16 v[90:91], v53 offset:6144
    v_mul_f32 v58, s12, v4
    v_mul_f32 v59, v4, v4
    s_waitcnt vmcnt(8) lgkmcnt(6)
    v_mfma_f32_32x32x16_bf16 v[96:111], v[76:79], v[228:231], v[96:111]
    buffer_load_dwordx4 v41, s[20:23], s92 offen offset:1024 lds
    ds_read_b64_tr_b16 v[92:93], v52 offset:5120
    ds_read_b64_tr_b16 v[94:95], v52 offset:7168
    v_mul_f32 v59, v59, v58
    s_waitcnt lgkmcnt(6)
    v_mfma_f32_32x32x16_bf16 v[112:127], v[80:83], v[228:231], v[112:127]
    ds_read_b64_tr_b16 v[76:77], v53 offset:5120
    ds_read_b64_tr_b16 v[78:79], v53 offset:7168
    v_mul_f32 v59, 0x3d372713, v59
    s_lshl_b32 s88, s95, 12
    s_waitcnt vmcnt(8) lgkmcnt(6)
    v_mfma_f32_32x32x16_bf16 v[96:111], v[84:87], v[232:235], v[96:111]
    buffer_load_dwordx4 v41, s[20:23], s93 offen offset:2048 lds
    ds_read_b64_tr_b16 v[80:81], v52 offset:8192
    ds_read_b64_tr_b16 v[82:83], v52 offset:10240
    s_add_u32 s88, s88, 262144
    s_waitcnt lgkmcnt(6)
    v_mfma_f32_32x32x16_bf16 v[112:127], v[88:91], v[232:235], v[112:127]
    ds_read_b64_tr_b16 v[84:85], v53 offset:8192
    ds_read_b64_tr_b16 v[86:87], v53 offset:10240
    v_and_b32 v1, 31, v0
    v_lshl_add_u32 v48, v1, 4, s88
    s_waitcnt vmcnt(8) lgkmcnt(6)
    v_mfma_f32_32x32x16_bf16 v[96:111], v[92:95], v[236:239], v[96:111]
    buffer_load_dwordx4 v41, s[20:23], s94 offen offset:3072 lds
    ds_read_b64_tr_b16 v[88:89], v52 offset:9216
    ds_read_b64_tr_b16 v[90:91], v52 offset:11264
    v_lshrrev_b32 v1, 5, v0
    s_waitcnt lgkmcnt(6)
    v_mfma_f32_32x32x16_bf16 v[112:127], v[76:79], v[236:239], v[112:127]
    ds_read_b64_tr_b16 v[92:93], v53 offset:9216
    ds_read_b64_tr_b16 v[94:95], v53 offset:11264
    s_mov_b32 s97, 0x70000
    s_cmp_eq_u32 s86, 3
    s_cselect_b32 s97, 0xffeb0000, s97
    v_add_u32 v41, s97, v41
    s_add_u32 m0, s62, 16384
    s_waitcnt vmcnt(8) lgkmcnt(6)
    v_mfma_f32_32x32x16_bf16 v[96:111], v[80:83], v[240:243], v[96:111]
    buffer_load_dwordx4 v41, s[20:23], 0 offen offset:0 lds
    ds_read_b64_tr_b16 v[76:77], v52 offset:12288
    ds_read_b64_tr_b16 v[78:79], v52 offset:14336
    v_lshl_add_u32 v48, v1, 11, v48
    s_waitcnt lgkmcnt(6)
    v_mfma_f32_32x32x16_bf16 v[112:127], v[84:87], v[240:243], v[112:127]
    ds_read_b64_tr_b16 v[80:81], v53 offset:12288
    ds_read_b64_tr_b16 v[82:83], v53 offset:14336
    v_add_f32 v62, v62, v63
    v_add_f32 v64, v64, v65
    s_waitcnt vmcnt(8) lgkmcnt(6)
    v_mfma_f32_32x32x16_bf16 v[96:111], v[88:91], v[244:247], v[96:111]
    buffer_load_dwordx4 v41, s[20:23], s92 offen offset:1024 lds
    ds_read_b64_tr_b16 v[84:85], v52 offset:13312
    ds_read_b64_tr_b16 v[86:87], v52 offset:15360
    v_add_f32 v62, v62, v64
    s_waitcnt lgkmcnt(6)
    v_mfma_f32_32x32x16_bf16 v[112:127], v[92:95], v[244:247], v[112:127]
    ds_read_b64_tr_b16 v[88:89], v53 offset:13312
    ds_read_b64_tr_b16 v[90:91], v53 offset:15360
    v_cvt_pk_bf16_f32 v63, v62, 0
    v_lshlrev_b32 v64, 16, v63
    s_waitcnt vmcnt(8) lgkmcnt(6)
    v_mfma_f32_32x32x16_bf16 v[96:111], v[76:79], v[248:251], v[96:111]
    buffer_load_dwordx4 v41, s[20:23], s93 offen offset:2048 lds
    v_sub_f32 v64, v62, v64
    v_cvt_pk_bf16_f32 v62, v62, v64
    v_mov_b32 v64, 0
    s_waitcnt lgkmcnt(4)
    v_mfma_f32_32x32x16_bf16 v[112:127], v[80:83], v[248:251], v[112:127]
    v_mov_b32 v65, 0
    v_add_f32 v66, v66, v67
    v_add_f32 v68, v68, v69
    v_add_f32 v66, v66, v68
    s_waitcnt vmcnt(8) lgkmcnt(2)
    v_mfma_f32_32x32x16_bf16 v[96:111], v[84:87], v[252:255], v[96:111]
    buffer_load_dwordx4 v41, s[20:23], s94 offen offset:3072 lds
    v_cvt_pk_bf16_f32 v67, v66, 0
    v_lshlrev_b32 v68, 16, v67
    v_sub_f32 v68, v66, v68
    s_waitcnt lgkmcnt(0)
    v_mfma_f32_32x32x16_bf16 v[112:127], v[88:91], v[252:255], v[112:127]
    s_mov_b32 s97, 0x70000
    s_cmp_eq_u32 s86, 2
    s_cselect_b32 s97, 0xffeb0000, s97
    v_add_u32 v41, s97, v41
    s_add_u32 m0, s62, 32768
    v_cvt_pk_bf16_f32 v66, v66, v68
    v_mov_b32 v68, 0
    v_mov_b32 v69, 0
    v_mfma_f32_32x32x16_bf16 v[96:111], v[62:65], v[54:57], v[96:111]
    s_nop 0
    v_mfma_f32_32x32x16_bf16 v[112:127], v[66:69], v[54:57], v[112:127]
    s_add_u32 s60, s60, 16384
    s_and_b32 s60, s60, 0xffff
    s_barrier
    buffer_load_dwordx4 v41, s[20:23], 0 offen offset:0 lds
    s_nop 5
    v_pk_mul_f32 v[80:81], v[96:97], v[96:97]
    v_pk_mul_f32 v[82:83], v[98:99], v[98:99]
    v_pk_mul_f32 v[84:85], v[100:101], v[100:101]
    v_pk_mul_f32 v[86:87], v[102:103], v[102:103]
    v_pk_mul_f32 v[88:89], v[104:105], v[104:105]
    v_pk_mul_f32 v[90:91], v[106:107], v[106:107]
    v_pk_mul_f32 v[92:93], v[108:109], v[108:109]
    v_pk_mul_f32 v[94:95], v[110:111], v[110:111]
    buffer_load_dwordx4 v41, s[20:23], s92 offen offset:1024 lds
    v_pk_fma_f32 v[80:81], v[80:81], v[58:59], v[58:59] op_sel:[0,1,0] op_sel_hi:[1,1,0]
    v_pk_fma_f32 v[82:83], v[82:83], v[58:59], v[58:59] op_sel:[0,1,0] op_sel_hi:[1,1,0]
    v_pk_fma_f32 v[84:85], v[84:85], v[58:59], v[58:59] op_sel:[0,1,0] op_sel_hi:[1,1,0]
    v_pk_fma_f32 v[86:87], v[86:87], v[58:59], v[58:59] op_sel:[0,1,0] op_sel_hi:[1,1,0]
    v_pk_fma_f32 v[88:89], v[88:89], v[58:59], v[58:59] op_sel:[0,1,0] op_sel_hi:[1,1,0]
    v_pk_fma_f32 v[90:91], v[90:91], v[58:59], v[58:59] op_sel:[0,1,0] op_sel_hi:[1,1,0]
    v_pk_fma_f32 v[92:93], v[92:93], v[58:59], v[58:59] op_sel:[0,1,0] op_sel_hi:[1,1,0]
    v_pk_fma_f32 v[94:95], v[94:95], v[58:59], v[58:59] op_sel:[0,1,0] op_sel_hi:[1,1,0]
    v_pk_mul_f32 v[80:81], v[80:81], v[96:97]
    v_pk_mul_f32 v[82:83], v[82:83], v[98:99]
    v_pk_mul_f32 v[84:85], v[84:85], v[100:101]
    v_pk_mul_f32 v[86:87], v[86:87], v[102:103]
    v_pk_mul_f32 v[88:89], v[88:89], v[104:105]
    v_pk_mul_f32 v[90:91], v[90:91], v[106:107]
    v_pk_mul_f32 v[92:93], v[92:93], v[108:109]
    v_pk_mul_f32 v[94:95], v[94:95], v[110:111]
    buffer_load_dwordx4 v41, s[20:23], s93 offen offset:2048 lds
    v_exp_f32 v80, v80
    v_exp_f32 v81, v81
    v_exp_f32 v82, v82
    v_exp_f32 v83, v83
    v_exp_f32 v84, v84
    v_exp_f32 v85, v85
    v_exp_f32 v86, v86
    v_exp_f32 v87, v87
    buffer_load_dwordx4 v41, s[20:23], s94 offen offset:3072 lds
    v_exp_f32 v88, v88
    v_exp_f32 v89, v89
    v_exp_f32 v90, v90
    v_exp_f32 v91, v91
    v_exp_f32 v92, v92
    v_exp_f32 v93, v93
    v_exp_f32 v94, v94
    v_exp_f32 v95, v95
    s_add_u32 m0, s62, 81920
    s_mov_b32 s92, 15360
    s_mov_b32 s93, 63488
    s_mov_b32 s94, 78848
    buffer_load_dwordx4 v34, s[24:27], 0 offen offset:0 lds
    v_pk_add_f32 v[80:81], v[80:81], 1.0 op_sel_hi:[1,0]
    v_pk_add_f32 v[82:83], v[82:83], 1.0 op_sel_hi:[1,0]
    v_pk_add_f32 v[84:85], v[84:85], 1.0 op_sel_hi:[1,0]
    v_pk_add_f32 v[86:87], v[86:87], 1.0 op_sel_hi:[1,0]
    v_pk_add_f32 v[88:89], v[88:89], 1.0 op_sel_hi:[1,0]
    v_pk_add_f32 v[90:91], v[90:91], 1.0 op_sel_hi:[1,0]
    v_pk_add_f32 v[92:93], v[92:93], 1.0 op_sel_hi:[1,0]
    v_pk_add_f32 v[94:95], v[94:95], 1.0 op_sel_hi:[1,0]
    v_rcp_f32 v80, v80
    v_rcp_f32 v81, v81
    v_rcp_f32 v82, v82
    v_rcp_f32 v83, v83
    buffer_load_dwordx4 v35, s[24:27], s92 offen offset:1024 lds
    v_rcp_f32 v84, v84
    v_rcp_f32 v85, v85
    v_rcp_f32 v86, v86
    v_rcp_f32 v87, v87
    v_rcp_f32 v88, v88
    v_rcp_f32 v89, v89
    v_rcp_f32 v90, v90
    v_rcp_f32 v91, v91
    buffer_load_dwordx4 v34, s[24:27], s93 offen offset:2048 lds
    v_rcp_f32 v92, v92
    v_rcp_f32 v93, v93
    v_rcp_f32 v94, v94
    v_rcp_f32 v95, v95
    v_pk_mul_f32 v[96:97], v[96:97], v[80:81]
    v_pk_mul_f32 v[98:99], v[98:99], v[82:83]
    v_pk_mul_f32 v[100:101], v[100:101], v[84:85]
    v_pk_mul_f32 v[102:103], v[102:103], v[86:87]
    v_pk_mul_f32 v[104:105], v[104:105], v[88:89]
    v_pk_mul_f32 v[106:107], v[106:107], v[90:91]
    v_pk_mul_f32 v[108:109], v[108:109], v[92:93]
    v_pk_mul_f32 v[110:111], v[110:111], v[94:95]
    buffer_load_dwordx4 v35, s[24:27], s94 offen offset:3072 lds
    v_pk_mul_f32 v[80:81], v[112:113], v[112:113]
    v_pk_mul_f32 v[82:83], v[114:115], v[114:115]
    v_pk_mul_f32 v[84:85], v[116:117], v[116:117]
    v_pk_mul_f32 v[86:87], v[118:119], v[118:119]
    v_pk_mul_f32 v[88:89], v[120:121], v[120:121]
    v_pk_mul_f32 v[90:91], v[122:123], v[122:123]
    v_pk_mul_f32 v[92:93], v[124:125], v[124:125]
    v_pk_mul_f32 v[94:95], v[126:127], v[126:127]
    v_add_u32 v34, 128, v34
    v_xor_b32 v35, 64, v34
    s_add_u32 m0, s62, 98304
    s_nop 0
    buffer_load_dwordx4 v34, s[24:27], 0 offen offset:0 lds
    v_pk_fma_f32 v[80:81], v[80:81], v[58:59], v[58:59] op_sel:[0,1,0] op_sel_hi:[1,1,0]
    v_pk_fma_f32 v[82:83], v[82:83], v[58:59], v[58:59] op_sel:[0,1,0] op_sel_hi:[1,1,0]
    v_pk_fma_f32 v[84:85], v[84:85], v[58:59], v[58:59] op_sel:[0,1,0] op_sel_hi:[1,1,0]
    v_pk_fma_f32 v[86:87], v[86:87], v[58:59], v[58:59] op_sel:[0,1,0] op_sel_hi:[1,1,0]
    v_pk_fma_f32 v[88:89], v[88:89], v[58:59], v[58:59] op_sel:[0,1,0] op_sel_hi:[1,1,0]
    v_pk_fma_f32 v[90:91], v[90:91], v[58:59], v[58:59] op_sel:[0,1,0] op_sel_hi:[1,1,0]
    v_pk_fma_f32 v[92:93], v[92:93], v[58:59], v[58:59] op_sel:[0,1,0] op_sel_hi:[1,1,0]
    v_pk_fma_f32 v[94:95], v[94:95], v[58:59], v[58:59] op_sel:[0,1,0] op_sel_hi:[1,1,0]
    v_pk_mul_f32 v[80:81], v[80:81], v[112:113]
    v_pk_mul_f32 v[82:83], v[82:83], v[114:115]
    v_pk_mul_f32 v[84:85], v[84:85], v[116:117]
    v_pk_mul_f32 v[86:87], v[86:87], v[118:119]
    v_pk_mul_f32 v[88:89], v[88:89], v[120:121]
    v_pk_mul_f32 v[90:91], v[90:91], v[122:123]
    v_pk_mul_f32 v[92:93], v[92:93], v[124:125]
    v_pk_mul_f32 v[94:95], v[94:95], v[126:127]
    buffer_load_dwordx4 v35, s[24:27], s92 offen offset:1024 lds
    v_exp_f32 v80, v80
    v_exp_f32 v81, v81
    v_exp_f32 v82, v82
    v_exp_f32 v83, v83
    v_exp_f32 v84, v84
    v_exp_f32 v85, v85
    v_exp_f32 v86, v86
    v_exp_f32 v87, v87
    buffer_load_dwordx4 v34, s[24:27], s93 offen offset:2048 lds
    v_exp_f32 v88, v88
    v_exp_f32 v89, v89
    v_exp_f32 v90, v90
    v_exp_f32 v91, v91
    v_exp_f32 v92, v92
    v_exp_f32 v93, v93
    v_exp_f32 v94, v94
    v_exp_f32 v95, v95
    buffer_load_dwordx4 v35, s[24:27], s94 offen offset:3072 lds
    v_pk_add_f32 v[80:81], v[80:81], 1.0 op_sel_hi:[1,0]
    v_pk_add_f32 v[82:83], v[82:83], 1.0 op_sel_hi:[1,0]
    v_pk_add_f32 v[84:85], v[84:85], 1.0 op_sel_hi:[1,0]
    v_pk_add_f32 v[86:87], v[86:87], 1.0 op_sel_hi:[1,0]
    v_pk_add_f32 v[88:89], v[88:89], 1.0 op_sel_hi:[1,0]
    v_pk_add_f32 v[90:91], v[90:91], 1.0 op_sel_hi:[1,0]
    v_pk_add_f32 v[92:93], v[92:93], 1.0 op_sel_hi:[1,0]
    v_pk_add_f32 v[94:95], v[94:95], 1.0 op_sel_hi:[1,0]
    v_rcp_f32 v80, v80
    v_rcp_f32 v81, v81
    v_rcp_f32 v82, v82
    v_rcp_f32 v83, v83
    v_add_u32 v34, 128, v34
    v_xor_b32 v35, 64, v34
    s_add_u32 m0, s62, 114688
    s_nop 0
    buffer_load_dwordx4 v34, s[24:27], 0 offen offset:0 lds
    v_rcp_f32 v84, v84
    v_rcp_f32 v85, v85
    v_rcp_f32 v86, v86
    v_rcp_f32 v87, v87
    v_rcp_f32 v88, v88
    v_rcp_f32 v89, v89
    v_rcp_f32 v90, v90
    v_rcp_f32 v91, v91
    buffer_load_dwordx4 v35, s[24:27], s92 offen offset:1024 lds
    v_rcp_f32 v92, v92
    v_rcp_f32 v93, v93
    v_rcp_f32 v94, v94
    v_rcp_f32 v95, v95
    v_pk_mul_f32 v[112:113], v[112:113], v[80:81]
    v_pk_mul_f32 v[114:115], v[114:115], v[82:83]
    v_pk_mul_f32 v[116:117], v[116:117], v[84:85]
    v_pk_mul_f32 v[118:119], v[118:119], v[86:87]
    v_pk_mul_f32 v[120:121], v[120:121], v[88:89]
    v_pk_mul_f32 v[122:123], v[122:123], v[90:91]
    v_pk_mul_f32 v[124:125], v[124:125], v[92:93]
    v_pk_mul_f32 v[126:127], v[126:127], v[94:95]
    v_pk_add_f32 v[80:81], v[96:97], v[98:99]
    v_pk_mul_f32 v[82:83], v[96:97], v[96:97]
    v_pk_fma_f32 v[82:83], v[98:99], v[98:99], v[82:83]
    v_pk_add_f32 v[80:81], v[80:81], v[100:101]
    v_pk_fma_f32 v[82:83], v[100:101], v[100:101], v[82:83]
    v_pk_add_f32 v[80:81], v[80:81], v[102:103]
    v_pk_fma_f32 v[82:83], v[102:103], v[102:103], v[82:83]
    v_pk_add_f32 v[80:81], v[80:81], v[104:105]
    v_pk_fma_f32 v[82:83], v[104:105], v[104:105], v[82:83]
    v_pk_add_f32 v[80:81], v[80:81], v[106:107]
    v_pk_fma_f32 v[82:83], v[106:107], v[106:107], v[82:83]
    v_pk_add_f32 v[80:81], v[80:81], v[108:109]
    v_pk_fma_f32 v[82:83], v[108:109], v[108:109], v[82:83]
    v_pk_add_f32 v[80:81], v[80:81], v[110:111]
    v_pk_fma_f32 v[82:83], v[110:111], v[110:111], v[82:83]
    v_pk_add_f32 v[80:81], v[80:81], v[112:113]
    v_pk_fma_f32 v[82:83], v[112:113], v[112:113], v[82:83]
    v_pk_add_f32 v[80:81], v[80:81], v[114:115]
    v_pk_fma_f32 v[82:83], v[114:115], v[114:115], v[82:83]
    v_pk_add_f32 v[80:81], v[80:81], v[116:117]
    v_pk_fma_f32 v[82:83], v[116:117], v[116:117], v[82:83]
    v_pk_add_f32 v[80:81], v[80:81], v[118:119]
    v_pk_fma_f32 v[82:83], v[118:119], v[118:119], v[82:83]
    v_pk_add_f32 v[80:81], v[80:81], v[120:121]
    v_pk_fma_f32 v[82:83], v[120:121], v[120:121], v[82:83]
    v_pk_add_f32 v[80:81], v[80:81], v[122:123]
    v_pk_fma_f32 v[82:83], v[122:123], v[122:123], v[82:83]
    v_pk_add_f32 v[80:81], v[80:81], v[124:125]
    v_pk_fma_f32 v[82:83], v[124:125], v[124:125], v[82:83]
    v_pk_add_f32 v[80:81], v[80:81], v[126:127]
    v_pk_fma_f32 v[82:83], v[126:127], v[126:127], v[82:83]
    v_add_f32 v80, v80, v81
    v_add_f32 v82, v82, v83
    s_nop 1
    v_permlane32_swap_b32 v80, v82
    v_add_f32 v80, v80, v82
    buffer_store_dword v80, v42, s[40:43], 0 offen sc1
    s_waitcnt vmcnt(7)
    v_add_u32 v30, 0x14000, v30
    v_add_u32 v31, 0x14000, v31
    v_add_u32 v32, 0x14000, v32
    v_add_u32 v33, 0x14000, v33
    ds_read_b128 a[128:131], v30 offset:0
    buffer_load_dwordx4 v34, s[24:27], s93 offen offset:2048 lds
    ds_read_b128 a[132:135], v31 offset:0
    buffer_load_dwordx4 v35, s[24:27], s94 offen offset:3072 lds
    v_mov_b32 v38, v48
    v_cmp_gt_u32 vcc, 32, v0
    s_nop 1
    v_cndmask_b32 v38, v39, v38, vcc
    s_and_b32 s88, s48, 14
    s_lshl_b32 s88, s88, 11
    s_lshl_b32 s91, s51, 11
    s_add_u32 s88, s88, s91
    s_lshl_b32 s91, s99, 10
    s_add_u32 s88, s88, s91
    s_lshl_b32 s91, s52, 9
    s_add_u32 s88, s88, s91
    s_add_u32 s88, s88, 73728
    v_and_b32 v1, 3, v0
    v_lshl_add_u32 v62, v1, 7, s88
    s_lshl_b32 s90, s50, 4
    s_add_u32 s90, s90, s48
    s_lshl_b32 s88, s90, 7
    s_lshl2_add_u32 s88, s44, s88
    s_add_u32 s88, s88, 40960
    v_mov_b32 v49, s88
    s_lshl_b32 s88, s48, 11
    s_lshl_b32 s91, s50, 7
    s_add_u32 s88, s88, s91
    s_add_u32 s88, s88, 73728
    v_lshl_add_u32 v42, v0, 2, s88
    v_lshl_or_b32 v37, s44, 6, v0
    v_cmp_gt_u32 vcc, 32, v37
    s_nop 1
    v_cndmask_b32 v42, v39, v42, vcc
    s_lshl_b32 s59, s48, 18
    s_lshl_b32 s91, s95, 12
    s_add_u32 s59, s59, s91
    s_add_u32 s59, s59, 8388608
    buffer_load_dwordx4 v[80:83], v48, s[40:43], 0 offen offset:0 sc1
    buffer_load_dwordx4 v[84:87], v48, s[40:43], 0 offen offset:512 sc1
    buffer_load_dwordx4 v[88:91], v48, s[40:43], 0 offen offset:1024 sc1
    buffer_load_dwordx4 v[92:95], v38, s[40:43], 0 offen offset:1536 sc1
    ds_read_b128 a[136:139], v32 offset:0
    v_add_u32 v34, 128, v34
    v_xor_b32 v35, 64, v34
    s_add_u32 m0, s62, 131072
    s_nop 0
    buffer_load_dwordx4 v34, s[24:27], 0 offen offset:0 lds
    ds_read_b128 a[140:143], v33 offset:0
    buffer_load_dwordx4 v35, s[24:27], s92 offen offset:1024 lds
    s_waitcnt vmcnt(11)
    ds_read_b128 a[144:147], v30 offset:16384
    buffer_load_dwordx4 v34, s[24:27], s93 offen offset:2048 lds
    ds_read_b128 a[148:151], v31 offset:16384
    buffer_load_dwordx4 v35, s[24:27], s94 offen offset:3072 lds
    ds_read_b128 a[152:155], v32 offset:16384
    v_add_u32 v34, 128, v34
    v_xor_b32 v35, 64, v34
    s_add_u32 m0, s62, 65536
    s_nop 0
    buffer_load_dwordx4 v34, s[24:27], 0 offen offset:0 lds
    ds_read_b128 a[156:159], v33 offset:16384
    buffer_load_dwordx4 v35, s[24:27], s92 offen offset:1024 lds
    s_mov_b32 s61, 0
    s_branch L_got_20_wt
L_again_21_wt:
    buffer_load_dwordx4 v[80:83], v48, s[40:43], 0 offen offset:0 sc1
    buffer_load_dwordx4 v[84:87], v48, s[40:43], 0 offen offset:512 sc1
    buffer_load_dwordx4 v[88:91], v48, s[40:43], 0 offen offset:1024 sc1
    buffer_load_dwordx4 v[92:95], v38, s[40:43], 0 offen offset:1536 sc1
    s_addk_i32 s61, 1
    s_cmp_gt_u32 s61, 0x80000
    s_cbranch_scc1 L_abort_wt
    s_waitcnt vmcnt(0)
L_got_20_wt:
    s_waitcnt vmcnt(6)
    v_pk_add_f32 v[80:81], v[80:81], v[82:83]
    v_pk_add_f32 v[84:85], v[84:85], v[86:87]
    v_pk_add_f32 v[88:89], v[88:89], v[90:91]
    v_pk_add_f32 v[92:93], v[92:93], v[94:95]
    v_pk_add_f32 v[80:81], v[80:81], v[92:93]
    v_pk_add_f32 v[84:85], v[84:85], v[88:89]
    v_pk_add_f32 v[80:81], v[80:81], v[84:85]
    v_cmp_u_f32 vcc, v80, v81
    s_cbranch_vccnz L_again_21_wt
    v_permlane32_swap_b32 v80, v81
    v_add_f32 v80, v80, v81
    v_mov_b32 v81, v80
    ds_read_b128 a[160:163], v30 offset:32768
    buffer_load_dwordx4 v34, s[24:27], s93 offen offset:2048 lds
    v_permlane32_swap_b32 v80, v81
    v_mul_f32 v80, 0x3a924925, v80
    v_mul_f32 v37, v80, v80
    v_fmamk_f32 v81, v81, 0xba924925, v37
    v_min_f32 v81, 0, v81
    v_sub_f32 v81, v60, v81
    v_rsq_f32 v81, v81
    ds_read_b128 a[164:167], v31 offset:32768
    buffer_load_dwordx4 v35, s[24:27], s94 offen offset:3072 lds
    v_mul_f32 v80, v80, v81
    v_pk_fma_f32 v[96:97], v[96:97], v[80:81], v[80:81] op_sel:[0,1,0] op_sel_hi:[1,1,0] neg_lo:[0,0,1] neg_hi:[0,0,1]
    v_pk_fma_f32 v[98:99], v[98:99], v[80:81], v[80:81] op_sel:[0,1,0] op_sel_hi:[1,1,0] neg_lo:[0,0,1] neg_hi:[0,0,1]
    v_pk_fma_f32 v[100:101], v[100:101], v[80:81], v[80:81] op_sel:[0,1,0] op_sel_hi:[1,1,0] neg_lo:[0,0,1] neg_hi:[0,0,1]
    v_pk_fma_f32 v[102:103], v[102:103], v[80:81], v[80:81] op_sel:[0,1,0] op_sel_hi:[1,1,0] neg_lo:[0,0,1] neg_hi:[0,0,1]
    v_pk_fma_f32 v[104:105], v[104:105], v[80:81], v[80:81] op_sel:[0,1,0] op_sel_hi:[1,1,0] neg_lo:[0,0,1] neg_hi:[0,0,1]
    v_pk_fma_f32 v[106:107], v[106:107], v[80:81], v[80:81] op_sel:[0,1,0] op_sel_hi:[1,1,0] neg_lo:[0,0,1] neg_hi:[0,0,1]
    v_pk_fma_f32 v[108:109], v[108:109], v[80:81], v[80:81] op_sel:[0,1,0] op_sel_hi:[1,1,0] neg_lo:[0,0,1] neg_hi:[0,0,1]
    v_pk_fma_f32 v[110:111], v[110:111], v[80:81], v[80:81] op_sel:[0,1,0] op_sel_hi:[1,1,0] neg_lo:[0,0,1] neg_hi:[0,0,1]
    v_pk_fma_f32 v[112:113], v[112:113], v[80:81], v[80:81] op_sel:[0,1,0] op_sel_hi:[1,1,0] neg_lo:[0,0,1] neg_hi:[0,0,1]
    v_pk_fma_f32 v[114:115], v[114:115], v[80:81], v[80:81] op_sel:[0,1,0] op_sel_hi:[1,1,0] neg_lo:[0,0,1] neg_hi:[0,0,1]
    v_pk_fma_f32 v[116:117], v[116:117], v[80:81], v[80:81] op_sel:[0,1,0] op_sel_hi:[1,1,0] neg_lo:[0,0,1] neg_hi:[0,0,1]
    v_pk_fma_f32 v[118:119], v[118:119], v[80:81], v[80:81] op_sel:[0,1,0] op_sel_hi:[1,1,0] neg_lo:[0,0,1] neg_hi:[0,0,1]
    v_pk_fma_f32 v[120:121], v[120:121], v[80:81], v[80:81] op_sel:[0,1,0] op_sel_hi:[1,1,0] neg_lo:[0,0,1] neg_hi:[0,0,1]
    v_pk_fma_f32 v[122:123], v[122:123], v[80:81], v[80:81] op_sel:[0,1,0] op_sel_hi:[1,1,0] neg_lo:[0,0,1] neg_hi:[0,0,1]
    v_pk_fma_f32 v[124:125], v[124:125], v[80:81], v[80:81] op_sel:[0,1,0] op_sel_hi:[1,1,0] neg_lo:[0,0,1] neg_hi:[0,0,1]
    v_pk_fma_f32 v[126:127], v[126:127], v[80:81], v[80:81] op_sel:[0,1,0] op_sel_hi:[1,1,0] neg_lo:[0,0,1] neg_hi:[0,0,1]
    v_cvt_pk_bf16_f32 v64, v96, v97
    v_cvt_pk_bf16_f32 v65, v98, v99
    v_cvt_pk_bf16_f32 v66, v100, v101
    v_cvt_pk_bf16_f32 v67, v102, v103
    v_cvt_pk_bf16_f32 v68, v104, v105
    v_cvt_pk_bf16_f32 v69, v106, v107
    v_cvt_pk_bf16_f32 v70, v108, v109
    v_cvt_pk_bf16_f32 v71, v110, v111
    v_mfma_f32_32x32x16_bf16 v[96:111], v[64:67], v[6:9], 0
    ds_read_b128 a[168:171], v32 offset:32768
    s_waitcnt lgkmcnt(7)
    v_add_u32 v34, 128, v34
    v_xor_b32 v35, 64, v34
    s_add_u32 m0, s62, 81920
    s_nop 0
    buffer_load_dwordx4 v34, s[24:27], 0 offen offset:0 lds
    v_mfma_f32_32x32x16_bf16 v[96:111], v[68:71], v[10:13], v[96:111]
    v_cvt_pk_bf16_f32 v72, v112, v113
    v_cvt_pk_bf16_f32 v73, v114, v115
    v_cvt_pk_bf16_f32 v74, v116, v117
    v_cvt_pk_bf16_f32 v75, v118, v119
    v_cvt_pk_bf16_f32 v76, v120, v121
    v_cvt_pk_bf16_f32 v77, v122, v123
    v_cvt_pk_bf16_f32 v78, v124, v125
    v_cvt_pk_bf16_f32 v79, v126, v127
    v_mfma_f32_32x32x16_bf16 v[112:127], v[72:75], v[6:9], 0
    ds_read_b128 a[172:175], v33 offset:32768
    buffer_load_dwordx4 v35, s[24:27], s92 offen offset:1024 lds
    v_mfma_f32_32x32x16_bf16 v[112:127], v[76:79], v[10:13], v[112:127]
    s_barrier
    v_cvt_pk_bf16_f32 v64, v96, v97
    v_cvt_pk_bf16_f32 v65, v98, v99
    v_cvt_pk_bf16_f32 v66, v100, v101
    v_cvt_pk_bf16_f32 v67, v102, v103
    v_cvt_pk_bf16_f32 v68, v104, v105
    v_cvt_pk_bf16_f32 v69, v106, v107
    v_cvt_pk_bf16_f32 v70, v108, v109
    v_cvt_pk_bf16_f32 v71, v110, v111
    buffer_store_dwordx4 v[64:67], v36, s[40:43], s59 offen offset:0 sc1
    buffer_store_dwordx4 v[68:71], v36, s[40:43], s59 offen offset:2048 sc1
    s_nop 0
    v_cvt_pk_bf16_f32 v72, v112, v113
    v_cvt_pk_bf16_f32 v73, v114, v115
    v_cvt_pk_bf16_f32 v74, v116, v117
    v_cvt_pk_bf16_f32 v75, v118, v119
    v_cvt_pk_bf16_f32 v76, v120, v121
    v_cvt_pk_bf16_f32 v77, v122, v123
    v_cvt_pk_bf16_f32 v78, v124, v125
    v_cvt_pk_bf16_f32 v79, v126, v127
    buffer_store_dwordx4 v[72:75], v36, s[40:43], s59 offen offset:1024 sc1
    buffer_store_dwordx4 v[76:79], v36, s[40:43], s59 offen offset:3072 sc1
    s_nop 0
    s_add_u32 s97, s60, 0
    v_add_u32 v52, s97, v43
    v_xor_b32 v53, 64, v52
    ds_read_b64_tr_b16 v[76:77], v52 offset:0
    ds_read_b64_tr_b16 v[78:79], v52 offset:2048
    ds_read_b64_tr_b16 v[80:81], v53 offset:0
    ds_read_b64_tr_b16 v[82:83], v53 offset:2048
    ds_read_b64_tr_b16 v[84:85], v52 offset:1024
    ds_read_b64_tr_b16 v[86:87], v52 offset:3072
    ds_read_b64_tr_b16 v[88:89], v53 offset:1024
    ds_read_b64_tr_b16 v[90:91], v53 offset:3072
    s_waitcnt lgkmcnt(6)
    v_mfma_f32_32x32x16_bf16 v[96:111], v[76:79], v[128:131], 0
    s_waitcnt vmcnt(10)
    ds_read_b128 a[176:179], v30 offset:49152
    buffer_load_dwordx4 v34, s[24:27], s93 offen offset:2048 lds
    ds_read_b64_tr_b16 v[92:93], v52 offset:4096
    ds_read_b64_tr_b16 v[94:95], v52 offset:6144
    v_mfma_f32_16x16x32_bf16 v[6:9], v[14:17], v[76:79], 0
    s_waitcnt lgkmcnt(7)
    v_mfma_f32_32x32x16_bf16 v[112:127], v[80:83], v[128:131], 0
    ds_read_b128 a[180:183], v31 offset:49152
    buffer_load_dwordx4 v35, s[24:27], s94 offen offset:3072 lds
    ds_read_b64_tr_b16 v[76:77], v53 offset:4096
    ds_read_b64_tr_b16 v[78:79], v53 offset:6144
    v_mfma_f32_16x16x32_bf16 v[10:13], v[14:17], v[80:83], 0
    v_add_u32 v34, 128, v34
    v_xor_b32 v35, 64, v34
    s_add_u32 m0, s62, 98304
    s_waitcnt lgkmcnt(8)
    v_mfma_f32_32x32x16_bf16 v[96:111], v[84:87], v[132:135], v[96:111]
    ds_read_b128 a[184:187], v32 offset:49152
    buffer_load_dwordx4 v34, s[24:27], 0 offen offset:0 lds
    ds_read_b64_tr_b16 v[80:81], v52 offset:5120
    ds_read_b64_tr_b16 v[82:83], v52 offset:7168
    v_mfma_f32_16x16x32_bf16 v[6:9], v[14:17], v[84:87], v[6:9]
    s_waitcnt lgkmcnt(9)
    v_mfma_f32_32x32x16_bf16 v[112:127], v[88:91], v[132:135], v[112:127]
    ds_read_b128 a[188:191], v33 offset:49152
    buffer_load_dwordx4 v35, s[24:27], s92 offen offset:1024 lds
    ds_read_b64_tr_b16 v[84:85], v53 offset:5120
    ds_read_b64_tr_b16 v[86:87], v53 offset:7168
    v_mfma_f32_16x16x32_bf16 v[10:13], v[14:17], v[88:91], v[10:13]
    s_waitcnt lgkmcnt(9)
    v_mfma_f32_32x32x16_bf16 v[96:111], v[92:95], v[136:139], v[96:111]
    s_waitcnt vmcnt(10)
    v_add_u32 v30, 0xffffc000, v30
    v_add_u32 v31, 0xffffc000, v31
    v_add_u32 v32, 0xffffc000, v32
    v_add_u32 v33, 0xffffc000, v33
    ds_read_b128 a[192:195], v30 offset:0
    buffer_load_dwordx4 v34, s[24:27], s93 offen offset:2048 lds
    ds_read_b64_tr_b16 v[88:89], v52 offset:8192
    ds_read_b64_tr_b16 v[90:91], v52 offset:10240
    v_mfma_f32_16x16x32_bf16 v[6:9], v[14:17], v[92:95], v[6:9]
    s_waitcnt lgkmcnt(9)
    v_mfma_f32_32x32x16_bf16 v[112:127], v[76:79], v[136:139], v[112:127]
    ds_read_b128 a[196:199], v31 offset:0
    buffer_load_dwordx4 v35, s[24:27], s94 offen offset:3072 lds
    ds_read_b64_tr_b16 v[92:93], v53 offset:8192
    ds_read_b64_tr_b16 v[94:95], v53 offset:10240
    v_mfma_f32_16x16x32_bf16 v[10:13], v[14:17], v[76:79], v[10:13]
    v_add_u32 v34, 128, v34
    v_xor_b32 v35, 64, v34
    s_add_u32 m0, s62, 114688
    s_waitcnt lgkmcnt(9)
    v_mfma_f32_32x32x16_bf16 v[96:111], v[80:83], v[140:143], v[96:111]
    ds_read_b128 a[200:203], v32 offset:0
    buffer_load_dwordx4 v34, s[24:27], 0 offen offset:0 lds
    ds_read_b64_tr_b16 v[76:77], v52 offset:9216
    ds_read_b64_tr_b16 v[78:79], v52 offset:11264
    v_mfma_f32_16x16x32_bf16 v[6:9], v[14:17], v[80:83], v[6:9]
    s_waitcnt lgkmcnt(9)
    v_mfma_f32_32x32x16_bf16 v[112:127], v[84:87], v[140:143], v[112:127]
    ds_read_b64_tr_b16 v[80:81], v53 offset:9216
    ds_read_b64_tr_b16 v[82:83], v53 offset:11264
    v_mfma_f32_16x16x32_bf16 v[10:13], v[14:17], v[84:87], v[10:13]
    s_waitcnt lgkmcnt(8)
    v_mfma_f32_32x32x16_bf16 v[96:111], v[88:91], v[144:147], v[96:111]
    ds_read_b64_tr_b16 v[84:85], v52 offset:12288
    ds_read_b64_tr_b16 v[86:87], v52 offset:14336
    v_mfma_f32_16x16x32_bf16 v[6:9], v[14:17], v[88:91], v[6:9]
    s_waitcnt lgkmcnt(7)
    v_mfma_f32_32x32x16_bf16 v[112:127], v[92:95], v[144:147], v[112:127]
    ds_read_b64_tr_b16 v[88:89], v53 offset:12288
    ds_read_b64_tr_b16 v[90:91], v53 offset:14336
    v_mfma_f32_16x16x32_bf16 v[10:13], v[14:17], v[92:95], v[10:13]
    s_waitcnt lgkmcnt(6)
    v_mfma_f32_32x32x16_bf16 v[96:111], v[76:79], v[148:151], v[96:111]
    ds_read_b64_tr_b16 v[92:93], v52 offset:13312
    ds_read_b64_tr_b16 v[94:95], v52 offset:15360
    v_mfma_f32_16x16x32_bf16 v[6:9], v[14:17], v[76:79], v[6:9]
    s_waitcnt lgkmcnt(6)
    v_mfma_f32_32x32x16_bf16 v[112:127], v[80:83], v[148:151], v[112:127]
    ds_read_b64_tr_b16 v[76:77], v53 offset:13312
    ds_read_b64_tr_b16 v[78:79], v53 offset:15360
    v_mfma_f32_16x16x32_bf16 v[10:13], v[14:17], v[80:83], v[10:13]
    s_waitcnt lgkmcnt(6)
    v_mfma_f32_32x32x16_bf16 v[96:111], v[84:87], v[152:155], v[96:111]
    s_add_u32 s60, s60, 16384
    s_and_b32 s60, s60, 0xffff
    s_add_u32 s97, s60, 0
    v_add_u32 v52, s97, v43
    v_xor_b32 v53, 64, v52
    ds_read_b64_tr_b16 v[80:81], v52 offset:0
    ds_read_b64_tr_b16 v[82:83], v52 offset:2048
    v_mfma_f32_16x16x32_bf16 v[6:9], v[14:17], v[84:87], v[6:9]
    s_waitcnt lgkmcnt(6)
    v_mfma_f32_32x32x16_bf16 v[112:127], v[88:91], v[152:155], v[112:127]
    ds_read_b64_tr_b16 v[84:85], v53 offset:0
    ds_read_b64_tr_b16 v[86:87], v53 offset:2048
    v_mfma_f32_16x16x32_bf16 v[10:13], v[14:17], v[88:91], v[10:13]
    s_waitcnt lgkmcnt(6)
    v_mfma_f32_32x32x16_bf16 v[96:111], v[92:95], v[156:159], v[96:111]
    ds_read_b64_tr_b16 v[88:89], v52 offset:1024
    ds_read_b64_tr_b16 v[90:91], v52 offset:3072
    v_mfma_f32_16x16x32_bf16 v[6:9], v[14:17], v[92:95], v[6:9]
    s_waitcnt lgkmcnt(6)
    v_mfma_f32_32x32x16_bf16 v[112:127], v[76:79], v[156:159], v[112:127]
    ds_read_b64_tr_b16 v[92:93], v53 offset:1024
    ds_read_b64_tr_b16 v[94:95], v53 offset:3072
    v_mfma_f32_16x16x32_bf16 v[10:13], v[14:17], v[76:79], v[10:13]
    s_waitcnt lgkmcnt(6)
    v_mfma_f32_32x32x16_bf16 v[96:111], v[80:83], v[160:163], v[96:111]
    ds_read_b64_tr_b16 v[76:77], v52 offset:4096
    ds_read_b64_tr_b16 v[78:79], v52 offset:6144
    s_lshl_b32 s59, s44, 11
    s_lshl_b32 s9, s48, 18
    s_waitcnt lgkmcnt(6)
    v_mfma_f32_32x32x16_bf16 v[112:127], v[84:87], v[160:163], v[112:127]
    ds_read_b64_tr_b16 v[80:81], v53 offset:4096
    ds_read_b64_tr_b16 v[82:83], v53 offset:6144
    s_lshl_b32 s91, s99, 17
    s_add_u32 s9, s9, s91
    s_waitcnt lgkmcnt(6)
    v_mfma_f32_32x32x16_bf16 v[96:111], v[88:91], v[164:167], v[96:111]
    ds_read_b64_tr_b16 v[84:85], v52 offset:5120
    ds_read_b64_tr_b16 v[86:87], v52 offset:7168
    s_lshl2_add_u32 s97, s44, 155648
    v_add_u32 v38, s97, v36
    s_waitcnt lgkmcnt(6)
    v_mfma_f32_32x32x16_bf16 v[112:127], v[92:95], v[164:167], v[112:127]
    ds_read_b64_tr_b16 v[88:89], v53 offset:5120
    ds_read_b64_tr_b16 v[90:91], v53 offset:7168
    s_add_u32 s9, s9, s59
    s_add_u32 s9, s9, 8388608
    s_waitcnt lgkmcnt(6)
    v_mfma_f32_32x32x16_bf16 v[96:111], v[76:79], v[168:171], v[96:111]
    s_waitcnt vmcnt(7)
    s_barrier
    buffer_store_dword v45, v42, s[40:43], 0 offen sc1
    ds_read_b64_tr_b16 v[92:93], v52 offset:8192
    ds_read_b64_tr_b16 v[94:95], v52 offset:10240
    ds_write_b32 v38, v6 offset:2048
    s_waitcnt lgkmcnt(7)
    v_mfma_f32_32x32x16_bf16 v[112:127], v[80:83], v[168:171], v[112:127]
    ds_read_b64_tr_b16 v[76:77], v53 offset:8192
    ds_read_b64_tr_b16 v[78:79], v53 offset:10240
    ds_write_b32 v38, v10 offset:3072
    s_xor_b32 s8, s9, 262144
    s_waitcnt lgkmcnt(8)
    v_mfma_f32_32x32x16_bf16 v[96:111], v[84:87], v[172:175], v[96:111]
    ds_read_b128 a[204:207], v33 offset:0
    buffer_load_dwordx4 v35, s[24:27], s92 offen offset:1024 lds
    ds_read_b64_tr_b16 v[80:81], v52 offset:9216
    ds_read_b64_tr_b16 v[82:83], v52 offset:11264
    s_waitcnt lgkmcnt(9)
    v_mfma_f32_32x32x16_bf16 v[112:127], v[88:91], v[172:175], v[112:127]
    ds_read_b64_tr_b16 v[84:85], v53 offset:9216
    ds_read_b64_tr_b16 v[86:87], v53 offset:11264
    v_lshlrev_b32 v51, 16, v51
    s_waitcnt lgkmcnt(9)
    v_mfma_f32_32x32x16_bf16 v[96:111], v[92:95], v[176:179], v[96:111]
    s_waitcnt vmcnt(7)
    ds_read_b128 a[208:211], v30 offset:16384
    buffer_load_dwordx4 v34, s[24:27], s93 offen offset:2048 lds
    ds_read_b64_tr_b16 v[88:89], v52 offset:12288
    ds_read_b64_tr_b16 v[90:91], v52 offset:14336
    v_add_u32 v38, 155648, v36
    s_waitcnt lgkmcnt(9)
    v_mfma_f32_32x32x16_bf16 v[112:127], v[76:79], v[176:179], v[112:127]
    ds_read_b64_tr_b16 v[92:93], v53 offset:12288
    ds_read_b64_tr_b16 v[94:95], v53 offset:14336
    s_waitcnt lgkmcnt(7)
    v_mfma_f32_32x32x16_bf16 v[96:111], v[80:83], v[180:183], v[96:111]
    ds_read_b128 a[212:215], v31 offset:16384
    buffer_load_dwordx4 v35, s[24:27], s94 offen offset:3072 lds
    ds_read_b64_tr_b16 v[76:77], v52 offset:13312
    ds_read_b64_tr_b16 v[78:79], v52 offset:15360
    s_waitcnt lgkmcnt(8)
    v_mfma_f32_32x32x16_bf16 v[112:127], v[84:87], v[180:183], v[112:127]
    ds_read_b64_tr_b16 v[80:81], v53 offset:13312
    ds_read_b64_tr_b16 v[82:83], v53 offset:15360
    v_add_u32 v34, 128, v34
    v_xor_b32 v35, 64, v34
    s_add_u32 m0, s62, 131072
    s_waitcnt lgkmcnt(7)
    v_mfma_f32_32x32x16_bf16 v[96:111], v[88:91], v[184:187], v[96:111]
    ds_read_b128 a[216:219], v32 offset:16384
    buffer_load_dwordx4 v34, s[24:27], 0 offen offset:0 lds
    s_add_u32 s60, s60, 16384
    s_and_b32 s60, s60, 0xffff
    s_add_u32 s97, s60, 0
    v_add_u32 v52, s97, v43
    v_xor_b32 v53, 64, v52
    ds_read_b64_tr_b16 v[84:85], v52 offset:0
    ds_read_b64_tr_b16 v[86:87], v52 offset:2048
    s_waitcnt lgkmcnt(8)
    v_mfma_f32_32x32x16_bf16 v[112:127], v[92:95], v[184:187], v[112:127]
    ds_read_b64_tr_b16 v[88:89], v53 offset:0
    ds_read_b64_tr_b16 v[90:91], v53 offset:2048
    s_waitcnt lgkmcnt(7)
    v_mfma_f32_32x32x16_bf16 v[96:111], v[76:79], v[188:191], v[96:111]
    ds_read_b128 a[220:223], v33 offset:16384
    buffer_load_dwordx4 v35, s[24:27], s92 offen offset:1024 lds
    ds_read_b64_tr_b16 v[92:93], v52 offset:1024
    ds_read_b64_tr_b16 v[94:95], v52 offset:3072
    s_waitcnt lgkmcnt(8)
    v_mfma_f32_32x32x16_bf16 v[112:127], v[80:83], v[188:191], v[112:127]
    ds_read_b64_tr_b16 v[76:77], v53 offset:1024
    ds_read_b64_tr_b16 v[78:79], v53 offset:3072
    s_waitcnt lgkmcnt(7)
    v_mfma_f32_32x32x16_bf16 v[96:111], v[84:87], v[192:195], v[96:111]
    s_waitcnt vmcnt(7)
    ds_read_b128 a[224:227], v30 offset:32768
    buffer_load_dwordx4 v34, s[24:27], s93 offen offset:2048 lds
    ds_read_b64_tr_b16 v[80:81], v52 offset:4096
    ds_read_b64_tr_b16 v[82:83], v52 offset:6144
    s_barrier
    s_waitcnt lgkmcnt(8)
    v_mfma_f32_32x32x16_bf16 v[112:127], v[88:91], v[192:195], v[112:127]
    ds_read_b64_tr_b16 v[84:85], v53 offset:4096
    ds_read_b64_tr_b16 v[86:87], v53 offset:6144
    s_waitcnt lgkmcnt(7)
    v_mfma_f32_32x32x16_bf16 v[96:111], v[92:95], v[196:199], v[96:111]
    ds_read_b128 a[228:231], v31 offset:32768
    buffer_load_dwordx4 v35, s[24:27], s94 offen offset:3072 lds
    ds_read_b64_tr_b16 v[88:89], v52 offset:5120
    ds_read_b64_tr_b16 v[90:91], v52 offset:7168
    ds_read_b128 v[6:9], v38 offset:2048
    s_waitcnt lgkmcnt(9)
    v_mfma_f32_32x32x16_bf16 v[112:127], v[76:79], v[196:199], v[112:127]
    ds_read_b64_tr_b16 v[92:93], v53 offset:5120
    ds_read_b64_tr_b16 v[94:95], v53 offset:7168
    ds_read_b128 v[10:13], v38 offset:3072
    v_add_u32 v34, 128, v34
    v_xor_b32 v35, 64, v34
    s_add_u32 m0, s62, 65536
    s_waitcnt lgkmcnt(9)
    v_mfma_f32_32x32x16_bf16 v[96:111], v[80:83], v[200:203], v[96:111]
    ds_read_b128 a[232:235], v32 offset:32768
    buffer_load_dwordx4 v34, s[24:27], 0 offen offset:0 lds
    ds_read_b64_tr_b16 v[76:77], v52 offset:8192
    ds_read_b64_tr_b16 v[78:79], v52 offset:10240
    s_waitcnt lgkmcnt(10)
    v_mfma_f32_32x32x16_bf16 v[112:127], v[84:87], v[200:203], v[112:127]
    ds_read_b64_tr_b16 v[80:81], v53 offset:8192
    ds_read_b64_tr_b16 v[82:83], v53 offset:10240
    s_waitcnt lgkmcnt(9)
    v_mfma_f32_32x32x16_bf16 v[96:111], v[88:91], v[204:207], v[96:111]
    ds_read_b128 a[236:239], v33 offset:32768
    buffer_load_dwordx4 v35, s[24:27], s92 offen offset:1024 lds
    ds_read_b64_tr_b16 v[84:85], v52 offset:9216
    ds_read_b64_tr_b16 v[86:87], v52 offset:11264
    s_waitcnt lgkmcnt(9)
    v_mfma_f32_32x32x16_bf16 v[112:127], v[92:95], v[204:207], v[112:127]
    ds_read_b64_tr_b16 v[88:89], v53 offset:9216
    ds_read_b64_tr_b16 v[90:91], v53 offset:11264
    s_waitcnt lgkmcnt(7)
    v_mfma_f32_32x32x16_bf16 v[96:111], v[76:79], v[208:211], v[96:111]
    s_waitcnt vmcnt(6)
    ds_read_b128 a[240:243], v30 offset:49152
    buffer_load_dwordx4 v34, s[24:27], s93 offen offset:2048 lds
    ds_read_b64_tr_b16 v[92:93], v52 offset:12288
    ds_read_b64_tr_b16 v[94:95], v52 offset:14336
    s_waitcnt lgkmcnt(8)
    v_mfma_f32_32x32x16_bf16 v[112:127], v[80:83], v[208:211], v[112:127]
    ds_read_b64_tr_b16 v[76:77], v53 offset:12288
    ds_read_b64_tr_b16 v[78:79], v53 offset:14336
    s_waitcnt lgkmcnt(7)
    v_mfma_f32_32x32x16_bf16 v[96:111], v[84:87], v[212:215], v[96:111]
    buffer_load_dword v47, v62, s[40:43], 0 offen sc1
    ds_read_b64_tr_b16 v[80:81], v52 offset:13312
    ds_read_b64_tr_b16 v[82:83], v52 offset:15360
    v_add_f32 v6, v6, v7
    s_waitcnt lgkmcnt(7)
    v_mfma_f32_32x32x16_bf16 v[112:127], v[88:91], v[212:215], v[112:127]
    ds_read_b64_tr_b16 v[84:85], v53 offset:13312
    ds_read_b64_tr_b16 v[86:87], v53 offset:15360
    v_add_f32 v8, v8, v9
    v_add_f32 v6, v6, v8
    s_waitcnt lgkmcnt(6)
    v_mfma_f32_32x32x16_bf16 v[96:111], v[92:95], v[216:219], v[96:111]
    ds_read_b128 a[244:247], v31 offset:49152
    buffer_load_dwordx4 v35, s[24:27], s94 offen offset:3072 lds
    s_add_u32 s60, s60, 16384
    s_and_b32 s60, s60, 0xffff
    s_add_u32 s97, s60, 0
    v_add_u32 v52, s97, v43
    v_xor_b32 v53, 64, v52
    ds_read_b64_tr_b16 v[88:89], v52 offset:0
    ds_read_b64_tr_b16 v[90:91], v52 offset:2048
    s_waitcnt lgkmcnt(7)
    v_mfma_f32_32x32x16_bf16 v[112:127], v[76:79], v[216:219], v[112:127]
    ds_read_b64_tr_b16 v[92:93], v53 offset:0
    ds_read_b64_tr_b16 v[94:95], v53 offset:2048
    v_add_u32 v34, 128, v34
    v_xor_b32 v35, 64, v34
    s_waitcnt lgkmcnt(7)
    v_mfma_f32_32x32x16_bf16 v[96:111], v[80:83], v[220:223], v[96:111]
    ds_read_b128 a[248:251], v32 offset:49152
    ds_read_b128 a[252:255], v33 offset:49152
    ds_read_b64_tr_b16 v[76:77], v52 offset:1024
    ds_read_b64_tr_b16 v[78:79], v52 offset:3072
    s_waitcnt lgkmcnt(9)
    v_mfma_f32_32x32x16_bf16 v[112:127], v[84:87], v[220:223], v[112:127]
    ds_read_b64_tr_b16 v[80:81], v53 offset:1024
    ds_read_b64_tr_b16 v[82:83], v53 offset:3072
    v_cvt_pk_bf16_f32 v7, v6, 0
    v_lshlrev_b32 v8, 16, v7
    s_waitcnt lgkmcnt(8)
    v_mfma_f32_32x32x16_bf16 v[96:111], v[88:91], v[224:227], v[96:111]
    s_waitcnt vmcnt(5)
    v_add_u32 v30, 0x8000, v30
    v_add_u32 v31, 0x8000, v31
    v_add_u32 v32, 0x8000, v32
    v_add_u32 v33, 0x8000, v33
    ds_read_b128 a[0:3], v30 offset:32768
    ds_read_b128 a[4:7], v31 offset:32768
    ds_read_b64_tr_b16 v[84:85], v52 offset:4096
    ds_read_b64_tr_b16 v[86:87], v52 offset:6144
    s_waitcnt lgkmcnt(10)
    v_mfma_f32_32x32x16_bf16 v[112:127], v[92:95], v[224:227], v[112:127]
    ds_read_b64_tr_b16 v[88:89], v53 offset:4096
    ds_read_b64_tr_b16 v[90:91], v53 offset:6144
    v_sub_f32 v8, v6, v8
    v_cvt_pk_bf16_f32 v6, v6, v8
    s_waitcnt lgkmcnt(8)
    v_mfma_f32_32x32x16_bf16 v[96:111], v[76:79], v[228:231], v[96:111]
    ds_read_b128 a[8:11], v32 offset:32768
    ds_read_b128 a[12:15], v33 offset:32768
    ds_read_b64_tr_b16 v[92:93], v52 offset:5120
    ds_read_b64_tr_b16 v[94:95], v52 offset:7168
    s_waitcnt lgkmcnt(10)
    v_mfma_f32_32x32x16_bf16 v[112:127], v[80:83], v[228:231], v[112:127]
    ds_read_b64_tr_b16 v[76:77], v53 offset:5120
    ds_read_b64_tr_b16 v[78:79], v53 offset:7168
    s_add_u32 m0, s62, 131072
    v_mov_b32 v8, 0
    s_waitcnt lgkmcnt(8)
    v_mfma_f32_32x32x16_bf16 v[96:111], v[84:87], v[232:235], v[96:111]
    s_waitcnt lgkmcnt(4)
    buffer_load_dwordx4 v34, s[24:27], 0 offen offset:0 lds
    ds_read_b64_tr_b16 v[80:81], v52 offset:8192
    ds_read_b64_tr_b16 v[82:83], v52 offset:10240
    v_mfma_f32_32x32x16_bf16 v[112:127], v[88:91], v[232:235], v[112:127]
    ds_read_b64_tr_b16 v[84:85], v53 offset:8192
    ds_read_b64_tr_b16 v[86:87], v53 offset:10240
    v_mov_b32 v9, 0
    v_add_f32 v10, v10, v11
    s_waitcnt lgkmcnt(6)
    v_mfma_f32_32x32x16_bf16 v[96:111], v[92:95], v[236:239], v[96:111]
    buffer_load_dwordx4 v35, s[24:27], s92 offen offset:1024 lds
    ds_read_b64_tr_b16 v[88:89], v52 offset:9216
    ds_read_b64_tr_b16 v[90:91], v52 offset:11264
    v_add_f32 v12, v12, v13
    s_waitcnt lgkmcnt(6)
    v_mfma_f32_32x32x16_bf16 v[112:127], v[76:79], v[236:239], v[112:127]
    ds_read_b64_tr_b16 v[92:93], v53 offset:9216
    ds_read_b64_tr_b16 v[94:95], v53 offset:11264
    v_add_f32 v10, v10, v12
    v_cvt_pk_bf16_f32 v11, v10, 0
    s_waitcnt lgkmcnt(6)
    v_mfma_f32_32x32x16_bf16 v[96:111], v[80:83], v[240:243], v[96:111]
    buffer_load_dwordx4 v34, s[24:27], s93 offen offset:2048 lds
    ds_read_b64_tr_b16 v[76:77], v52 offset:12288
    ds_read_b64_tr_b16 v[78:79], v52 offset:14336
    v_lshlrev_b32 v12, 16, v11
    s_waitcnt lgkmcnt(6)
    v_mfma_f32_32x32x16_bf16 v[112:127], v[84:87], v[240:243], v[112:127]
    ds_read_b64_tr_b16 v[80:81], v53 offset:12288
    ds_read_b64_tr_b16 v[82:83], v53 offset:14336
    v_sub_f32 v12, v10, v12
    v_cvt_pk_bf16_f32 v10, v10, v12
    s_waitcnt lgkmcnt(6)
    v_mfma_f32_32x32x16_bf16 v[96:111], v[88:91], v[244:247], v[96:111]
    buffer_load_dwordx4 v35, s[24:27], s94 offen offset:3072 lds
    ds_read_b64_tr_b16 v[84:85], v52 offset:13312
    ds_read_b64_tr_b16 v[86:87], v52 offset:15360
    v_mov_b32 v12, 0
    s_waitcnt lgkmcnt(6)
    v_mfma_f32_32x32x16_bf16 v[112:127], v[92:95], v[244:247], v[112:127]
    ds_read_b64_tr_b16 v[88:89], v53 offset:13312
    ds_read_b64_tr_b16 v[90:91], v53 offset:15360
    v_add_u32 v34, 128, v34
    v_xor_b32 v35, 64, v34
    s_waitcnt lgkmcnt(6)
    v_mfma_f32_32x32x16_bf16 v[96:111], v[76:79], v[248:251], v[96:111]
    s_waitcnt vmcnt(5)
    v_cmp_ne_u32 vcc, s53, v47
    s_cbranch_vccnz L_retry_22_wt
L_got_23_wt:
    s_barrier
    v_mov_b32 v13, 0
    s_waitcnt lgkmcnt(4)
    v_mfma_f32_32x32x16_bf16 v[112:127], v[80:83], v[248:251], v[112:127]
    s_add_u32 m0, s59, 81920
    s_add_u32 s58, s8, 0
    buffer_load_dwordx4 v36, s[40:43], s58 offen offset:0 sc1 lds
    s_waitcnt lgkmcnt(2)
    v_mfma_f32_32x32x16_bf16 v[96:111], v[84:87], v[252:255], v[96:111]
    buffer_load_dwordx4 v36, s[40:43], s58 offen offset:1024 sc1 lds
    s_waitcnt lgkmcnt(0)
    v_mfma_f32_32x32x16_bf16 v[112:127], v[88:91], v[252:255], v[112:127]
    s_add_u32 m0, s59, 90112
    s_add_u32 s58, s8, 8192
    buffer_load_dwordx4 v36, s[40:43], s58 offen offset:0 sc1 lds
    v_mfma_f32_32x32x16_bf16 v[96:111], v[6:9], v[54:57], v[96:111]
    v_mfma_f32_32x32x16_bf16 v[112:127], v[10:13], v[54:57], v[112:127]
    s_add_u32 s60, s60, 16384
    s_and_b32 s60, s60, 0xffff
    s_barrier
    v_add_u32 v6, 81920, v36
    buffer_load_dwordx4 v36, s[40:43], s58 offen offset:1024 sc1 lds
    s_nop 5
    v_pk_mul_f32 v[96:97], v[96:97], v[4:5]
    v_pk_mul_f32 v[98:99], v[98:99], v[4:5]
    v_pk_mul_f32 v[100:101], v[100:101], v[4:5]
    v_pk_mul_f32 v[102:103], v[102:103], v[4:5]
    v_pk_mul_f32 v[104:105], v[104:105], v[4:5]
    v_pk_mul_f32 v[106:107], v[106:107], v[4:5]
    v_pk_mul_f32 v[108:109], v[108:109], v[4:5]
    v_pk_mul_f32 v[110:111], v[110:111], v[4:5]
    v_pk_mul_f32 v[64:65], v[96:97], v[96:97]
    v_pk_mul_f32 v[66:67], v[98:99], v[98:99]
    v_pk_mul_f32 v[68:69], v[100:101], v[100:101]
    v_pk_mul_f32 v[70:71], v[102:103], v[102:103]
    v_pk_mul_f32 v[72:73], v[104:105], v[104:105]
    v_pk_mul_f32 v[74:75], v[106:107], v[106:107]
    v_pk_mul_f32 v[76:77], v[108:109], v[108:109]
    v_pk_mul_f32 v[78:79], v[110:111], v[110:111]
    v_pk_fma_f32 v[64:65], v[64:65], s[12:13], s[12:13] op_sel:[0,1,0] op_sel_hi:[1,1,0]
    v_pk_fma_f32 v[66:67], v[66:67], s[12:13], s[12:13] op_sel:[0,1,0] op_sel_hi:[1,1,0]
    v_pk_fma_f32 v[68:69], v[68:69], s[12:13], s[12:13] op_sel:[0,1,0] op_sel_hi:[1,1,0]
    v_pk_fma_f32 v[70:71], v[70:71], s[12:13], s[12:13] op_sel:[0,1,0] op_sel_hi:[1,1,0]
    v_pk_fma_f32 v[72:73], v[72:73], s[12:13], s[12:13] op_sel:[0,1,0] op_sel_hi:[1,1,0]
    v_pk_fma_f32 v[74:75], v[74:75], s[12:13], s[12:13] op_sel:[0,1,0] op_sel_hi:[1,1,0]
    v_pk_fma_f32 v[76:77], v[76:77], s[12:13], s[12:13] op_sel:[0,1,0] op_sel_hi:[1,1,0]
    v_pk_fma_f32 v[78:79], v[78:79], s[12:13], s[12:13] op_sel:[0,1,0] op_sel_hi:[1,1,0]
    v_pk_mul_f32 v[64:65], v[64:65], v[96:97]
    v_pk_mul_f32 v[66:67], v[66:67], v[98:99]
    v_pk_mul_f32 v[68:69], v[68:69], v[100:101]
    v_pk_mul_f32 v[70:71], v[70:71], v[102:103]
    v_pk_mul_f32 v[72:73], v[72:73], v[104:105]
    v_pk_mul_f32 v[74:75], v[74:75], v[106:107]
    v_pk_mul_f32 v[76:77], v[76:77], v[108:109]
    v_pk_mul_f32 v[78:79], v[78:79], v[110:111]
    s_add_u32 m0, s59, 98304
    s_add_u32 s58, s8, 16384
    buffer_load_dwordx4 v36, s[40:43], s58 offen offset:0 sc1 lds
    v_exp_f32 v64, v64
    v_exp_f32 v65, v65
    v_exp_f32 v66, v66
    v_exp_f32 v67, v67
    v_exp_f32 v68, v68
    v_exp_f32 v69, v69
    v_exp_f32 v70, v70
    v_exp_f32 v71, v71
    s_waitcnt vmcnt(9)
    v_add_u32 v30, 0xfffec000, v30
    v_add_u32 v31, 0xfffec000, v31
    v_add_u32 v32, 0xfffec000, v32
    v_add_u32 v33, 0xfffec000, v33
    ds_read_b128 a[16:19], v30 offset:49152
    s_add_u32 m0, s62, 147456
    s_nop 0
    buffer_load_dwordx4 v34, s[24:27], 0 offen offset:0 lds
    v_exp_f32 v72, v72
    v_exp_f32 v73, v73
    v_exp_f32 v74, v74
    v_exp_f32 v75, v75
    v_exp_f32 v76, v76
    v_exp_f32 v77, v77
    v_exp_f32 v78, v78
    v_exp_f32 v79, v79
    s_add_u32 m0, s59, 98304
    s_nop 0
    buffer_load_dwordx4 v36, s[40:43], s58 offen offset:1024 sc1 lds
    v_pk_add_f32 v[64:65], v[64:65], 1.0 op_sel_hi:[1,0]
    v_pk_add_f32 v[66:67], v[66:67], 1.0 op_sel_hi:[1,0]
    v_pk_add_f32 v[68:69], v[68:69], 1.0 op_sel_hi:[1,0]
    v_pk_add_f32 v[70:71], v[70:71], 1.0 op_sel_hi:[1,0]
    v_pk_add_f32 v[72:73], v[72:73], 1.0 op_sel_hi:[1,0]
    v_pk_add_f32 v[74:75], v[74:75], 1.0 op_sel_hi:[1,0]
    v_pk_add_f32 v[76:77], v[76:77], 1.0 op_sel_hi:[1,0]
    v_pk_add_f32 v[78:79], v[78:79], 1.0 op_sel_hi:[1,0]
    v_rcp_f32 v64, v64
    v_rcp_f32 v65, v65
    v_rcp_f32 v66, v66
    v_rcp_f32 v67, v67
    ds_read_b128 a[20:23], v31 offset:49152
    s_add_u32 m0, s62, 147456
    s_nop 0
    buffer_load_dwordx4 v35, s[24:27], s92 offen offset:1024 lds
    v_rcp_f32 v68, v68
    v_rcp_f32 v69, v69
    v_rcp_f32 v70, v70
    v_rcp_f32 v71, v71
    v_rcp_f32 v72, v72
    v_rcp_f32 v73, v73
    v_rcp_f32 v74, v74
    v_rcp_f32 v75, v75
    s_add_u32 m0, s59, 106496
    s_add_u32 s58, s8, 24576
    buffer_load_dwordx4 v36, s[40:43], s58 offen offset:0 sc1 lds
    v_rcp_f32 v76, v76
    v_rcp_f32 v77, v77
    v_rcp_f32 v78, v78
    v_rcp_f32 v79, v79
    v_pk_mul_f32 v[96:97], v[96:97], v[64:65]
    v_pk_mul_f32 v[98:99], v[98:99], v[66:67]
    v_pk_mul_f32 v[100:101], v[100:101], v[68:69]
    v_pk_mul_f32 v[102:103], v[102:103], v[70:71]
    v_pk_mul_f32 v[104:105], v[104:105], v[72:73]
    v_pk_mul_f32 v[106:107], v[106:107], v[74:75]
    v_pk_mul_f32 v[108:109], v[108:109], v[76:77]
    v_pk_mul_f32 v[110:111], v[110:111], v[78:79]
    ds_read_b128 a[24:27], v32 offset:49152
    s_add_u32 m0, s62, 147456
    s_nop 0
    buffer_load_dwordx4 v34, s[24:27], s93 offen offset:2048 lds
    s_add_u32 m0, s59, 106496
    s_nop 0
    buffer_load_dwordx4 v36, s[40:43], s58 offen offset:1024 sc1 lds
    ds_read_b128 a[28:31], v33 offset:49152
    s_add_u32 m0, s62, 147456
    s_nop 0
    buffer_load_dwordx4 v35, s[24:27], s94 offen offset:3072 lds
    v_mov_b32 v224, v51
    v_mov_b32 v225, v51
    v_mov_b32 v226, v51
    v_mov_b32 v227, v51
    v_mov_b32 v228, v51
    v_mov_b32 v229, v51
    v_mov_b32 v230, v51
    v_mov_b32 v231, v51
    v_mov_b32 v232, v51
    v_mov_b32 v233, v51
    v_mov_b32 v234, v51
    v_mov_b32 v235, v51
    v_mov_b32 v236, v51
    v_mov_b32 v237, v51
    v_mov_b32 v238, v51
    v_mov_b32 v239, v51
    v_mov_b32 v240, v51
    v_mov_b32 v241, v51
    v_mov_b32 v242, v51
    v_mov_b32 v243, v51
    v_mov_b32 v244, v51
    v_mov_b32 v245, v51
    v_mov_b32 v246, v51
    v_mov_b32 v247, v51
    s_waitcnt vmcnt(10)
    s_barrier
    ds_read_b128 v[160:163], v6 offset:0
    ds_read_b128 v[164:167], v6 offset:1024
    ds_read_b128 v[168:171], v6 offset:2048
    ds_read_b128 v[172:175], v6 offset:3072
    ds_read_b128 v[176:179], v6 offset:4096
    ds_read_b128 v[180:183], v6 offset:5120
    ds_read_b128 v[184:187], v6 offset:6144
    ds_read_b128 v[188:191], v6 offset:7168
    s_waitcnt vmcnt(8) lgkmcnt(0)
    s_barrier
    v_mfma_f32_32x32x16_bf16 v[128:143], v[160:163], a[128:131], 0
    ds_read_b128 v[192:195], v6 offset:8192
    ds_read_b128 v[196:199], v6 offset:9216
    v_mov_b32 v248, v51
    v_mov_b32 v249, v51
    v_mfma_f32_32x32x16_bf16 v[144:159], v[164:167], a[128:131], 0
    ds_read_b128 v[200:203], v6 offset:10240
    ds_read_b128 v[204:207], v6 offset:11264
    v_mov_b32 v250, v51
    v_mov_b32 v251, v51
    v_mfma_f32_32x32x16_bf16 v[128:143], v[168:171], a[132:135], v[128:143]
    ds_read_b128 v[208:211], v6 offset:12288
    ds_read_b128 v[212:215], v6 offset:13312
    v_mov_b32 v252, v51
    v_mov_b32 v253, v51
    v_mfma_f32_32x32x16_bf16 v[144:159], v[172:175], a[132:135], v[144:159]
    ds_read_b128 v[216:219], v6 offset:14336
    ds_read_b128 v[220:223], v6 offset:15360
    s_add_u32 m0, s59, 114688
    s_add_u32 s58, s8, 32768
    v_mfma_f32_32x32x16_bf16 v[128:143], v[176:179], a[136:139], v[128:143]
    v_add_u32 v30, 0x14000, v30
    v_add_u32 v31, 0x14000, v31
    v_add_u32 v32, 0x14000, v32
    v_add_u32 v33, 0x14000, v33
    ds_read_b128 a[32:35], v30 offset:32768
    ds_read_b128 a[36:39], v31 offset:32768
    buffer_load_dwordx4 v36, s[40:43], s58 offen offset:0 sc1 lds
    v_mfma_f32_32x32x16_bf16 v[144:159], v[180:183], a[136:139], v[144:159]
    ds_read_b128 a[40:43], v32 offset:32768
    ds_read_b128 a[44:47], v33 offset:32768
    buffer_load_dwordx4 v36, s[40:43], s58 offen offset:1024 sc1 lds
    v_add_u32 v34, 128, v34
    v_xor_b32 v35, 64, v34
    s_add_u32 m0, s62, 131072
    v_mfma_f32_32x32x16_bf16 v[128:143], v[184:187], a[140:143], v[128:143]
    s_waitcnt lgkmcnt(0)
    buffer_load_dwordx4 v34, s[24:27], 0 offen offset:0 lds
    s_add_u32 m0, s59, 122880
    s_add_u32 s58, s9, 0
    v_mfma_f32_32x32x16_bf16 v[144:159], v[188:191], a[140:143], v[144:159]
    buffer_load_dwordx4 v36, s[40:43], s58 offen offset:0 sc1 lds
    s_waitcnt vmcnt(9)
    s_barrier
    v_mfma_f32_32x32x16_bf16 v[128:143], v[192:195], a[144:147], v[128:143]
    ds_read_b128 v[160:163], v6 offset:16384
    ds_read_b128 v[164:167], v6 offset:17408
    v_mov_b32 v254, v51
    v_mov_b32 v255, v51
    v_mfma_f32_32x32x16_bf16 v[144:159], v[196:199], a[144:147], v[144:159]
    ds_read_b128 v[168:171], v6 offset:18432
    ds_read_b128 v[172:175], v6 offset:19456
    s_lshl_b32 s88, s95, 7
    s_lshl2_add_u32 s88, s48, s88
    v_mfma_f32_32x32x16_bf16 v[128:143], v[200:203], a[148:151], v[128:143]
    ds_read_b128 v[176:179], v6 offset:20480
    ds_read_b128 v[180:183], v6 offset:21504
    s_add_u32 s88, s88, 32768
    v_cmp_eq_u32 vcc, 0, v0
    v_mfma_f32_32x32x16_bf16 v[144:159], v[204:207], a[148:151], v[144:159]
    ds_read_b128 v[184:187], v6 offset:22528
    ds_read_b128 v[188:191], v6 offset:23552
    v_mov_b32 v38, s88
    v_xor_b32 v37, 128, v49
    v_mfma_f32_32x32x16_bf16 v[128:143], v[208:211], a[152:155], v[128:143]
    buffer_load_dwordx4 v36, s[40:43], s58 offen offset:1024 sc1 lds
    s_add_u32 m0, s59, 81920
    s_add_u32 s58, s9, 8192
    v_cndmask_b32 v62, v39, v38, vcc
    v_mfma_f32_32x32x16_bf16 v[144:159], v[212:215], a[152:155], v[144:159]
    buffer_load_dwordx4 v36, s[40:43], s58 offen offset:0 sc1 lds
    s_add_u32 m0, s62, 131072
    v_cndmask_b32 v37, v39, v37, vcc
    v_xor_b32 v46, 2048, v50
    v_mfma_f32_32x32x16_bf16 v[128:143], v[216:219], a[156:159], v[128:143]
    buffer_load_dwordx4 v35, s[24:27], s92 offen offset:1024 lds
    v_mov_b32 v11, s13
    v_mul_f32 v112, v112, v4
    v_mul_f32 v113, v113, v4
    v_mfma_f32_32x32x16_bf16 v[144:159], v[220:223], a[156:159], v[144:159]
    buffer_load_dwordx4 v34, s[24:27], s93 offen offset:2048 lds
    s_waitcnt vmcnt(9) lgkmcnt(0)
    s_barrier
    v_mfma_f32_32x32x16_bf16 v[128:143], v[160:163], a[160:163], v[128:143]
    ds_read_b128 v[192:195], v6 offset:24576
    ds_read_b128 v[196:199], v6 offset:25600
    v_mul_f32 v114, v114, v4
    v_mul_f32 v115, v115, v4
    v_mfma_f32_32x32x16_bf16 v[144:159], v[164:167], a[160:163], v[144:159]
    ds_read_b128 v[200:203], v6 offset:26624
    ds_read_b128 v[204:207], v6 offset:27648
    v_mul_f32 v7, v112, v112
    v_mul_f32 v8, v113, v113
    v_mfma_f32_32x32x16_bf16 v[128:143], v[168:171], a[164:167], v[128:143]
    ds_read_b128 v[208:211], v6 offset:28672
    ds_read_b128 v[212:215], v6 offset:29696
    v_mul_f32 v9, v114, v114
    v_mul_f32 v10, v115, v115
    v_mfma_f32_32x32x16_bf16 v[144:159], v[172:175], a[164:167], v[144:159]
    ds_read_b128 v[216:219], v6 offset:30720
    ds_read_b128 v[220:223], v6 offset:31744
    s_add_u32 m0, s59, 81920
    v_fmaak_f32 v7, v11, v7, 0xc0135761
    v_mfma_f32_32x32x16_bf16 v[128:143], v[176:179], a[168:171], v[128:143]
    s_waitcnt vmcnt(8)
    ds_read_b128 a[48:51], v30 offset:49152
    ds_read_b128 a[52:55], v31 offset:49152
    buffer_load_dwordx4 v36, s[40:43], s58 offen offset:1024 sc1 lds
    s_add_u32 m0, s59, 90112
    s_add_u32 s58, s9, 16384
    v_mfma_f32_32x32x16_bf16 v[144:159], v[180:183], a[168:171], v[144:159]
    ds_read_b128 a[56:59], v32 offset:49152
    ds_read_b128 a[60:63], v33 offset:49152
    buffer_load_dwordx4 v36, s[40:43], s58 offen offset:0 sc1 lds
    s_add_u32 m0, s62, 131072
    v_mfma_f32_32x32x16_bf16 v[128:143], v[184:187], a[172:175], v[128:143]
    buffer_load_dwordx4 v35, s[24:27], s94 offen offset:3072 lds
    v_fmaak_f32 v8, v11, v8, 0xc0135761
    v_fmaak_f32 v9, v11, v9, 0xc0135761
    v_fmaak_f32 v10, v11, v10, 0xc0135761
    v_mfma_f32_32x32x16_bf16 v[144:159], v[188:191], a[172:175], v[144:159]
    v_mul_f32 v7, v7, v112
    s_waitcnt vmcnt(9) lgkmcnt(0)
    s_barrier
    v_mfma_f32_32x32x16_bf16 v[128:143], v[192:195], a[176:179], v[128:143]
    ds_read_b128 v[160:163], v6 offset:32768
    ds_read_b128 v[164:167], v6 offset:33792
    v_mul_f32 v8, v8, v113
    v_mul_f32 v9, v9, v114
    v_mfma_f32_32x32x16_bf16 v[144:159], v[196:199], a[176:179], v[144:159]
    ds_read_b128 v[168:171], v6 offset:34816
    ds_read_b128 v[172:175], v6 offset:35840
    v_mul_f32 v10, v10, v115
    v_mfma_f32_32x32x16_bf16 v[128:143], v[200:203], a[180:183], v[128:143]
    ds_read_b128 v[176:179], v6 offset:36864
    ds_read_b128 v[180:183], v6 offset:37888
    v_exp_f32 v7, v7
    v_mfma_f32_32x32x16_bf16 v[144:159], v[204:207], a[180:183], v[144:159]
    ds_read_b128 v[184:187], v6 offset:38912
    ds_read_b128 v[188:191], v6 offset:39936
    s_add_u32 m0, s59, 90112
    v_mfma_f32_32x32x16_bf16 v[128:143], v[208:211], a[184:187], v[128:143]
    buffer_load_dwordx4 v36, s[40:43], s58 offen offset:1024 sc1 lds
    s_add_u32 m0, s59, 98304
    s_add_u32 s58, s9, 24576
    v_mfma_f32_32x32x16_bf16 v[144:159], v[212:215], a[184:187], v[144:159]
    buffer_load_dwordx4 v36, s[40:43], s58 offen offset:0 sc1 lds
    v_add_u32 v34, 128, v34
    v_xor_b32 v35, 64, v34
    s_add_u32 m0, s62, 65536
    v_mfma_f32_32x32x16_bf16 v[128:143], v[216:219], a[188:191], v[128:143]
    buffer_load_dwordx4 v34, s[24:27], 0 offen offset:0 lds
    v_exp_f32 v8, v8
    v_mfma_f32_32x32x16_bf16 v[144:159], v[220:223], a[188:191], v[144:159]
    buffer_load_dwordx4 v35, s[24:27], s92 offen offset:1024 lds
    s_waitcnt vmcnt(10) lgkmcnt(0)
    s_barrier
    v_mfma_f32_32x32x16_bf16 v[128:143], v[160:163], a[192:195], v[128:143]
    ds_read_b128 v[192:195], v6 offset:40960
    ds_read_b128 v[196:199], v6 offset:41984
    v_exp_f32 v9, v9
    v_mfma_f32_32x32x16_bf16 v[144:159], v[164:167], a[192:195], v[144:159]
    ds_read_b128 v[200:203], v6 offset:43008
    ds_read_b128 v[204:207], v6 offset:44032
    v_exp_f32 v10, v10
    v_mfma_f32_32x32x16_bf16 v[128:143], v[168:171], a[196:199], v[128:143]
    ds_read_b128 v[208:211], v6 offset:45056
    ds_read_b128 v[212:215], v6 offset:46080
    v_add_f32 v7, 1.0, v7
    v_add_f32 v8, 1.0, v8
    v_mfma_f32_32x32x16_bf16 v[144:159], v[172:175], a[196:199], v[144:159]
    ds_read_b128 v[216:219], v6 offset:47104
    ds_read_b128 v[220:223], v6 offset:48128
    s_add_u32 m0, s59, 98304
    v_add_f32 v9, 1.0, v9
    v_mfma_f32_32x32x16_bf16 v[128:143], v[176:179], a[200:203], v[128:143]
    buffer_load_dwordx4 v36, s[40:43], s58 offen offset:1024 sc1 lds
    s_add_u32 m0, s59, 106496
    s_add_u32 s58, s9, 32768
    v_add_f32 v10, 1.0, v10
    v_mfma_f32_32x32x16_bf16 v[144:159], v[180:183], a[200:203], v[144:159]
    buffer_load_dwordx4 v36, s[40:43], s58 offen offset:0 sc1 lds
    s_add_u32 m0, s62, 65536
    v_rcp_f32 v7, v7
    v_mfma_f32_32x32x16_bf16 v[128:143], v[184:187], a[204:207], v[128:143]
    buffer_load_dwordx4 v34, s[24:27], s93 offen offset:2048 lds
    v_rcp_f32 v8, v8
    v_mfma_f32_32x32x16_bf16 v[144:159], v[188:191], a[204:207], v[144:159]
    s_waitcnt vmcnt(9) lgkmcnt(0)
    s_barrier
    v_mfma_f32_32x32x16_bf16 v[224:239], v[192:195], a[128:131], v[224:239]
    ds_read_b128 v[160:163], v6 offset:0
    ds_read_b128 v[164:167], v6 offset:1024
    v_rcp_f32 v9, v9
    v_mfma_f32_32x32x16_bf16 v[240:255], v[196:199], a[128:131], v[240:255]
    ds_read_b128 v[168:171], v6 offset:2048
    ds_read_b128 v[172:175], v6 offset:3072
    v_rcp_f32 v10, v10
    v_mfma_f32_32x32x16_bf16 v[224:239], v[200:203], a[132:135], v[224:239]
    ds_read_b128 v[176:179], v6 offset:4096
    ds_read_b128 v[180:183], v6 offset:5120
    v_mul_f32 v112, v112, v7
    v_mul_f32 v113, v113, v8
    v_mfma_f32_32x32x16_bf16 v[240:255], v[204:207], a[132:135], v[240:255]
    ds_read_b128 v[184:187], v6 offset:6144
    ds_read_b128 v[188:191], v6 offset:7168
    s_add_u32 m0, s59, 106496
    v_mul_f32 v114, v114, v9
    v_mfma_f32_32x32x16_bf16 v[224:239], v[208:211], a[136:139], v[224:239]
    buffer_load_dwordx4 v36, s[40:43], s58 offen offset:1024 sc1 lds
    s_add_u32 m0, s59, 114688
    s_add_u32 s58, s8, 40960
    v_mul_f32 v115, v115, v10
    v_mfma_f32_32x32x16_bf16 v[240:255], v[212:215], a[136:139], v[240:255]
    s_waitcnt vmcnt(8)
    ds_read_b128 a[64:67], v30 offset:32768
    ds_read_b128 a[68:71], v31 offset:32768
    buffer_load_dwordx4 v36, s[40:43], s58 offen offset:0 sc1 lds
    s_add_u32 m0, s62, 65536
    v_mfma_f32_32x32x16_bf16 v[224:239], v[216:219], a[140:143], v[224:239]
    buffer_load_dwordx4 v35, s[24:27], s94 offen offset:3072 lds
    v_add_u32 v34, 128, v34
    v_xor_b32 v35, 64, v34
    s_add_u32 m0, s62, 49152
    v_mfma_f32_32x32x16_bf16 v[240:255], v[220:223], a[140:143], v[240:255]
    buffer_load_dwordx4 v34, s[24:27], 0 offen offset:0 lds
    s_waitcnt vmcnt(10) lgkmcnt(0)
    s_barrier
    v_mfma_f32_32x32x16_bf16 v[224:239], v[160:163], a[144:147], v[224:239]
    ds_read_b128 v[192:195], v6 offset:8192
    ds_read_b128 v[196:199], v6 offset:9216
    v_mul_f32 v116, v116, v4
    v_mul_f32 v117, v117, v4
    v_mfma_f32_32x32x16_bf16 v[240:255], v[164:167], a[144:147], v[240:255]
    ds_read_b128 v[200:203], v6 offset:10240
    ds_read_b128 v[204:207], v6 offset:11264
    v_mul_f32 v118, v118, v4
    v_mul_f32 v119, v119, v4
    v_mfma_f32_32x32x16_bf16 v[224:239], v[168:171], a[148:151], v[224:239]
    ds_read_b128 v[208:211], v6 offset:12288
    ds_read_b128 v[212:215], v6 offset:13312
    v_mul_f32 v7, v116, v116
    v_mul_f32 v8, v117, v117
    v_mfma_f32_32x32x16_bf16 v[240:255], v[172:175], a[148:151], v[240:255]
    ds_read_b128 v[216:219], v6 offset:14336
    ds_read_b128 v[220:223], v6 offset:15360
    s_add_u32 m0, s59, 114688
    v_mul_f32 v9, v118, v118
    v_mfma_f32_32x32x16_bf16 v[224:239], v[176:179], a[152:155], v[224:239]
    ds_read_b128 a[72:75], v32 offset:32768
    ds_read_b128 a[76:79], v33 offset:32768
    buffer_load_dwordx4 v36, s[40:43], s58 offen offset:1024 sc1 lds
    s_add_u32 m0, s59, 122880
    s_add_u32 s58, s8, 49152
    v_mfma_f32_32x32x16_bf16 v[240:255], v[180:183], a[152:155], v[240:255]
    buffer_load_dwordx4 v36, s[40:43], s58 offen offset:0 sc1 lds
    s_add_u32 m0, s62, 49152
    v_mul_f32 v10, v119, v119
    v_fmaak_f32 v7, v11, v7, 0xc0135761
    v_mfma_f32_32x32x16_bf16 v[224:239], v[184:187], a[156:159], v[224:239]
    buffer_load_dwordx4 v35, s[24:27], s92 offen offset:1024 lds
    v_fmaak_f32 v8, v11, v8, 0xc0135761
    v_fmaak_f32 v9, v11, v9, 0xc0135761
    v_fmaak_f32 v10, v11, v10, 0xc0135761
    v_mfma_f32_32x32x16_bf16 v[240:255], v[188:191], a[156:159], v[240:255]
    v_mul_f32 v7, v7, v116
    s_waitcnt vmcnt(9) lgkmcnt(0)
    s_barrier
    v_mfma_f32_32x32x16_bf16 v[224:239], v[192:195], a[160:163], v[224:239]
    ds_read_b128 v[160:163], v6 offset:16384
    ds_read_b128 v[164:167], v6 offset:17408
    v_mul_f32 v8, v8, v117
    v_mul_f32 v9, v9, v118
    v_mfma_f32_32x32x16_bf16 v[240:255], v[196:199], a[160:163], v[240:255]
    ds_read_b128 v[168:171], v6 offset:18432
    ds_read_b128 v[172:175], v6 offset:19456
    v_mul_f32 v10, v10, v119
    v_mfma_f32_32x32x16_bf16 v[224:239], v[200:203], a[164:167], v[224:239]
    ds_read_b128 v[176:179], v6 offset:20480
    ds_read_b128 v[180:183], v6 offset:21504
    v_exp_f32 v7, v7
    v_mfma_f32_32x32x16_bf16 v[240:255], v[204:207], a[164:167], v[240:255]
    ds_read_b128 v[184:187], v6 offset:22528
    ds_read_b128 v[188:191], v6 offset:23552
    s_add_u32 m0, s59, 122880
    v_mfma_f32_32x32x16_bf16 v[224:239], v[208:211], a[168:171], v[224:239]
    buffer_load_dwordx4 v36, s[40:43], s58 offen offset:1024 sc1 lds
    s_add_u32 m0, s59, 81920
    s_add_u32 s58, s8, 57344
    v_mfma_f32_32x32x16_bf16 v[240:255], v[212:215], a[168:171], v[240:255]
    buffer_load_dwordx4 v36, s[40:43], s58 offen offset:0 sc1 lds
    s_add_u32 m0, s62, 49152
    v_exp_f32 v8, v8
    v_mfma_f32_32x32x16_bf16 v[224:239], v[216:219], a[172:175], v[224:239]
    buffer_load_dwordx4 v34, s[24:27], s93 offen offset:2048 lds
    v_exp_f32 v9, v9
    v_mfma_f32_32x32x16_bf16 v[240:255], v[220:223], a[172:175], v[240:255]
    buffer_load_dwordx4 v35, s[24:27], s94 offen offset:3072 lds
    s_waitcnt vmcnt(10) lgkmcnt(0)
    s_barrier
    v_mfma_f32_32x32x16_bf16 v[224:239], v[160:163], a[176:179], v[224:239]
    ds_read_b128 v[192:195], v6 offset:24576
    ds_read_b128 v[196:199], v6 offset:25600
    v_exp_f32 v10, v10
    v_mfma_f32_32x32x16_bf16 v[240:255], v[164:167], a[176:179], v[240:255]
    ds_read_b128 v[200:203], v6 offset:26624
    ds_read_b128 v[204:207], v6 offset:27648
    v_add_f32 v7, 1.0, v7
    v_add_f32 v8, 1.0, v8
    v_mfma_f32_32x32x16_bf16 v[224:239], v[168:171], a[180:183], v[224:239]
    ds_read_b128 v[208:211], v6 offset:28672
    ds_read_b128 v[212:215], v6 offset:29696
    v_add_f32 v9, 1.0, v9
    v_add_f32 v10, 1.0, v10
    v_mfma_f32_32x32x16_bf16 v[240:255], v[172:175], a[180:183], v[240:255]
    ds_read_b128 v[216:219], v6 offset:30720
    ds_read_b128 v[220:223], v6 offset:31744
    s_add_u32 m0, s59, 81920
    v_mfma_f32_32x32x16_bf16 v[224:239], v[176:179], a[184:187], v[224:239]
    s_waitcnt vmcnt(8)
    v_add_u32 v30, 0xfffec000, v30
    v_add_u32 v31, 0xfffec000, v31
    v_add_u32 v32, 0xfffec000, v32
    v_add_u32 v33, 0xfffec000, v33
    ds_read_b128 a[80:83], v30 offset:49152
    ds_read_b128 a[84:87], v31 offset:49152
    buffer_load_dwordx4 v36, s[40:43], s58 offen offset:1024 sc1 lds
    s_add_u32 m0, s59, 90112
    s_add_u32 s58, s8, 65536
    v_mfma_f32_32x32x16_bf16 v[240:255], v[180:183], a[184:187], v[240:255]
    ds_read_b128 a[88:91], v32 offset:49152
    ds_read_b128 a[92:95], v33 offset:49152
    buffer_load_dwordx4 v36, s[40:43], s58 offen offset:0 sc1 lds
    v_add_u32 v34, 128, v34
    v_xor_b32 v35, 64, v34
    s_add_u32 m0, s62, 32768
    v_mfma_f32_32x32x16_bf16 v[224:239], v[184:187], a[188:191], v[224:239]
    buffer_load_dwordx4 v34, s[24:27], 0 offen offset:0 lds
    v_rcp_f32 v7, v7
    v_mfma_f32_32x32x16_bf16 v[240:255], v[188:191], a[188:191], v[240:255]
    s_waitcnt vmcnt(9) lgkmcnt(0)
    s_barrier
    v_mfma_f32_32x32x16_bf16 v[224:239], v[192:195], a[192:195], v[224:239]
    ds_read_b128 v[160:163], v6 offset:32768
    ds_read_b128 v[164:167], v6 offset:33792
    v_rcp_f32 v8, v8
    v_mfma_f32_32x32x16_bf16 v[240:255], v[196:199], a[192:195], v[240:255]
    ds_read_b128 v[168:171], v6 offset:34816
    ds_read_b128 v[172:175], v6 offset:35840
    v_rcp_f32 v9, v9
    v_mfma_f32_32x32x16_bf16 v[224:239], v[200:203], a[196:199], v[224:239]
    ds_read_b128 v[176:179], v6 offset:36864
    ds_read_b128 v[180:183], v6 offset:37888
    v_rcp_f32 v10, v10
    v_mfma_f32_32x32x16_bf16 v[240:255], v[204:207], a[196:199], v[240:255]
    ds_read_b128 v[184:187], v6 offset:38912
    ds_read_b128 v[188:191], v6 offset:39936
    s_add_u32 m0, s59, 90112
    v_mul_f32 v116, v116, v7
    v_mfma_f32_32x32x16_bf16 v[224:239], v[208:211], a[200:203], v[224:239]
    buffer_load_dwordx4 v36, s[40:43], s58 offen offset:1024 sc1 lds
    s_add_u32 m0, s59, 98304
    s_add_u32 s58, s8, 73728
    v_mul_f32 v117, v117, v8
    v_mfma_f32_32x32x16_bf16 v[240:255], v[212:215], a[200:203], v[240:255]
    buffer_load_dwordx4 v36, s[40:43], s58 offen offset:0 sc1 lds
    s_add_u32 m0, s62, 32768
    v_mul_f32 v118, v118, v9
    v_mul_f32 v119, v119, v10
    v_mfma_f32_32x32x16_bf16 v[224:239], v[216:219], a[204:207], v[224:239]
    buffer_load_dwordx4 v35, s[24:27], s92 offen offset:1024 lds
    v_mul_f32 v120, v120, v4
    v_mul_f32 v121, v121, v4
    v_mul_f32 v122, v122, v4
    v_mfma_f32_32x32x16_bf16 v[240:255], v[220:223], a[204:207], v[240:255]
    buffer_load_dwordx4 v34, s[24:27], s93 offen offset:2048 lds
    s_waitcnt vmcnt(10) lgkmcnt(0)
    s_barrier
    v_mfma_f32_32x32x16_bf16 v[128:143], v[160:163], a[208:211], v[128:143]
    ds_read_b128 v[192:195], v6 offset:40960
    ds_read_b128 v[196:199], v6 offset:41984
    v_mul_f32 v123, v123, v4
    v_mul_f32 v7, v120, v120
    v_mfma_f32_32x32x16_bf16 v[144:159], v[164:167], a[208:211], v[144:159]
    ds_read_b128 v[200:203], v6 offset:43008
    ds_read_b128 v[204:207], v6 offset:44032
    v_mul_f32 v8, v121, v121
    v_mul_f32 v9, v122, v122
    v_mfma_f32_32x32x16_bf16 v[128:143], v[168:171], a[212:215], v[128:143]
    ds_read_b128 v[208:211], v6 offset:45056
    ds_read_b128 v[212:215], v6 offset:46080
    v_mul_f32 v10, v123, v123
    v_fmaak_f32 v7, v11, v7, 0xc0135761
    v_mfma_f32_32x32x16_bf16 v[144:159], v[172:175], a[212:215], v[144:159]
    ds_read_b128 v[216:219], v6 offset:47104
    ds_read_b128 v[220:223], v6 offset:48128
    s_add_u32 m0, s59, 98304
    v_fmaak_f32 v8, v11, v8, 0xc0135761
    v_mfma_f32_32x32x16_bf16 v[128:143], v[176:179], a[216:219], v[128:143]
    buffer_load_dwordx4 v36, s[40:43], s58 offen offset:1024 sc1 lds
    s_add_u32 m0, s59, 106496
    s_add_u32 s58, s8, 81920
    v_fmaak_f32 v9, v11, v9, 0xc0135761
    v_mfma_f32_32x32x16_bf16 v[144:159], v[180:183], a[216:219], v[144:159]
    s_waitcnt vmcnt(8)
    ds_read_b128 a[96:99], v30 offset:32768
    ds_read_b128 a[100:103], v31 offset:32768
    buffer_load_dwordx4 v36, s[40:43], s58 offen offset:0 sc1 lds
    s_add_u32 m0, s62, 32768
    v_mfma_f32_32x32x16_bf16 v[128:143], v[184:187], a[220:223], v[128:143]
    buffer_load_dwordx4 v35, s[24:27], s94 offen offset:3072 lds
    v_fmaak_f32 v10, v11, v10, 0xc0135761
    v_mul_f32 v7, v7, v120
    v_mul_f32 v8, v8, v121
    v_mfma_f32_32x32x16_bf16 v[144:159], v[188:191], a[220:223], v[144:159]
    v_mul_f32 v9, v9, v122
    s_waitcnt vmcnt(9) lgkmcnt(0)
    s_barrier
    v_mfma_f32_32x32x16_bf16 v[128:143], v[192:195], a[224:227], v[128:143]
    ds_read_b128 v[160:163], v6 offset:0
    ds_read_b128 v[164:167], v6 offset:1024
    v_mul_f32 v10, v10, v123
    v_mfma_f32_32x32x16_bf16 v[144:159], v[196:199], a[224:227], v[144:159]
    ds_read_b128 v[168:171], v6 offset:2048
    ds_read_b128 v[172:175], v6 offset:3072
    v_exp_f32 v7, v7
    v_mfma_f32_32x32x16_bf16 v[128:143], v[200:203], a[228:231], v[128:143]
    ds_read_b128 v[176:179], v6 offset:4096
    ds_read_b128 v[180:183], v6 offset:5120
    v_exp_f32 v8, v8
    v_mfma_f32_32x32x16_bf16 v[144:159], v[204:207], a[228:231], v[144:159]
    ds_read_b128 v[184:187], v6 offset:6144
    ds_read_b128 v[188:191], v6 offset:7168
    s_add_u32 m0, s59, 106496
    v_mfma_f32_32x32x16_bf16 v[128:143], v[208:211], a[232:235], v[128:143]
    ds_read_b128 a[104:107], v32 offset:32768
    ds_read_b128 a[108:111], v33 offset:32768
    buffer_load_dwordx4 v36, s[40:43], s58 offen offset:1024 sc1 lds
    s_add_u32 m0, s59, 114688
    s_add_u32 s58, s8, 90112
    v_mfma_f32_32x32x16_bf16 v[144:159], v[212:215], a[232:235], v[144:159]
    buffer_load_dwordx4 v36, s[40:43], s58 offen offset:0 sc1 lds
    s_add_u32 m0, s62, 0
    s_mov_b32 s92, 3072
    s_mov_b32 s93, 14336
    s_mov_b32 s94, 17408
    v_mfma_f32_32x32x16_bf16 v[128:143], v[216:219], a[236:239], v[128:143]
    buffer_load_dwordx4 v40, s[32:35], 0 offen offset:0 lds
    v_exp_f32 v9, v9
    v_mfma_f32_32x32x16_bf16 v[144:159], v[220:223], a[236:239], v[144:159]
    buffer_load_dwordx4 v40, s[32:35], s92 offen offset:1024 lds
    s_waitcnt vmcnt(10) lgkmcnt(0)
    s_barrier
    v_mfma_f32_32x32x16_bf16 v[128:143], v[160:163], a[240:243], v[128:143]
    ds_read_b128 v[192:195], v6 offset:8192
    ds_read_b128 v[196:199], v6 offset:9216
    v_exp_f32 v10, v10
    v_mfma_f32_32x32x16_bf16 v[144:159], v[164:167], a[240:243], v[144:159]
    ds_read_b128 v[200:203], v6 offset:10240
    ds_read_b128 v[204:207], v6 offset:11264
    v_add_f32 v7, 1.0, v7
    v_add_f32 v8, 1.0, v8
    v_mfma_f32_32x32x16_bf16 v[128:143], v[168:171], a[244:247], v[128:143]
    ds_read_b128 v[208:211], v6 offset:12288
    ds_read_b128 v[212:215], v6 offset:13312
    v_add_f32 v9, 1.0, v9
    v_add_f32 v10, 1.0, v10
    v_mfma_f32_32x32x16_bf16 v[144:159], v[172:175], a[244:247], v[144:159]
    ds_read_b128 v[216:219], v6 offset:14336
    ds_read_b128 v[220:223], v6 offset:15360
    s_add_u32 m0, s59, 114688
    v_mfma_f32_32x32x16_bf16 v[128:143], v[176:179], a[248:251], v[128:143]
    buffer_load_dwordx4 v36, s[40:43], s58 offen offset:1024 sc1 lds
    s_add_u32 m0, s59, 122880
    s_add_u32 s58, s8, 98304
    v_mfma_f32_32x32x16_bf16 v[144:159], v[180:183], a[248:251], v[144:159]
    buffer_load_dwordx4 v36, s[40:43], s58 offen offset:0 sc1 lds
    s_add_u32 m0, s62, 0
    v_rcp_f32 v7, v7
    v_mfma_f32_32x32x16_bf16 v[128:143], v[184:187], a[252:255], v[128:143]
    buffer_load_dwordx4 v40, s[32:35], s93 offen offset:2048 lds
    v_rcp_f32 v8, v8
    v_mfma_f32_32x32x16_bf16 v[144:159], v[188:191], a[252:255], v[144:159]
    s_waitcnt vmcnt(9) lgkmcnt(0)
    s_barrier
    v_mfma_f32_32x32x16_bf16 v[128:143], v[192:195], a[0:3], v[128:143]
    ds_read_b128 v[160:163], v6 offset:16384
    ds_read_b128 v[164:167], v6 offset:17408
    v_rcp_f32 v9, v9
    v_mfma_f32_32x32x16_bf16 v[144:159], v[196:199], a[0:3], v[144:159]
    ds_read_b128 v[168:171], v6 offset:18432
    ds_read_b128 v[172:175], v6 offset:19456
    v_rcp_f32 v10, v10
    v_mfma_f32_32x32x16_bf16 v[128:143], v[200:203], a[4:7], v[128:143]
    ds_read_b128 v[176:179], v6 offset:20480
    ds_read_b128 v[180:183], v6 offset:21504
    v_mul_f32 v120, v120, v7
    v_mul_f32 v121, v121, v8
    v_mfma_f32_32x32x16_bf16 v[144:159], v[204:207], a[4:7], v[144:159]
    ds_read_b128 v[184:187], v6 offset:22528
    ds_read_b128 v[188:191], v6 offset:23552
    s_add_u32 m0, s59, 122880
    v_mul_f32 v122, v122, v9
    v_mfma_f32_32x32x16_bf16 v[128:143], v[208:211], a[8:11], v[128:143]
    buffer_load_dwordx4 v36, s[40:43], s58 offen offset:1024 sc1 lds
    s_add_u32 m0, s59, 81920
    s_add_u32 s58, s8, 106496
    v_mul_f32 v123, v123, v10
    v_mfma_f32_32x32x16_bf16 v[144:159], v[212:215], a[8:11], v[144:159]
    s_waitcnt vmcnt(8)
    ds_read_b128 a[112:115], v30 offset:16384
    ds_read_b128 a[116:119], v31 offset:16384
    buffer_load_dwordx4 v36, s[40:43], s58 offen offset:0 sc1 lds
    s_add_u32 m0, s62, 0
    v_mfma_f32_32x32x16_bf16 v[128:143], v[216:219], a[12:15], v[128:143]
    buffer_load_dwordx4 v40, s[32:35], s94 offen offset:3072 lds
    v_add_u32 v40, 0x20000, v40
    s_add_u32 m0, s62, 16384
    v_mul_f32 v124, v124, v4
    v_mfma_f32_32x32x16_bf16 v[144:159], v[220:223], a[12:15], v[144:159]
    buffer_load_dwordx4 v40, s[32:35], 0 offen offset:0 lds
    s_waitcnt vmcnt(10) lgkmcnt(0)
    s_barrier
    v_mfma_f32_32x32x16_bf16 v[128:143], v[160:163], a[16:19], v[128:143]
    ds_read_b128 v[192:195], v6 offset:24576
    ds_read_b128 v[196:199], v6 offset:25600
    v_mul_f32 v125, v125, v4
    v_mul_f32 v126, v126, v4
    v_mfma_f32_32x32x16_bf16 v[144:159], v[164:167], a[16:19], v[144:159]
    ds_read_b128 v[200:203], v6 offset:26624
    ds_read_b128 v[204:207], v6 offset:27648
    v_mul_f32 v127, v127, v4
    v_mul_f32 v7, v124, v124
    v_mfma_f32_32x32x16_bf16 v[128:143], v[168:171], a[20:23], v[128:143]
    ds_read_b128 v[208:211], v6 offset:28672
    ds_read_b128 v[212:215], v6 offset:29696
    v_mul_f32 v8, v125, v125
    v_mul_f32 v9, v126, v126
    v_mfma_f32_32x32x16_bf16 v[144:159], v[172:175], a[20:23], v[144:159]
    ds_read_b128 v[216:219], v6 offset:30720
    ds_read_b128 v[220:223], v6 offset:31744
    s_add_u32 m0, s59, 81920
    v_mul_f32 v10, v127, v127
    v_mfma_f32_32x32x16_bf16 v[128:143], v[176:179], a[24:27], v[128:143]
    ds_read_b128 a[120:123], v32 offset:16384
    ds_read_b128 a[124:127], v33 offset:16384
    buffer_load_dwordx4 v36, s[40:43], s58 offen offset:1024 sc1 lds
    s_add_u32 m0, s59, 90112
    s_add_u32 s58, s8, 114688
    v_mfma_f32_32x32x16_bf16 v[144:159], v[180:183], a[24:27], v[144:159]
    buffer_load_dwordx4 v36, s[40:43], s58 offen offset:0 sc1 lds
    s_add_u32 m0, s62, 16384
    v_fmaak_f32 v7, v11, v7, 0xc0135761
    v_fmaak_f32 v8, v11, v8, 0xc0135761
    v_mfma_f32_32x32x16_bf16 v[128:143], v[184:187], a[28:31], v[128:143]
    buffer_load_dwordx4 v40, s[32:35], s92 offen offset:1024 lds
    v_fmaak_f32 v9, v11, v9, 0xc0135761
    v_fmaak_f32 v10, v11, v10, 0xc0135761
    v_mul_f32 v7, v7, v124
    v_mfma_f32_32x32x16_bf16 v[144:159], v[188:191], a[28:31], v[144:159]
    v_mul_f32 v8, v8, v125
    s_waitcnt vmcnt(9) lgkmcnt(0)
    s_barrier
    v_mfma_f32_32x32x16_bf16 v[128:143], v[192:195], a[32:35], v[128:143]
    ds_read_b128 v[160:163], v6 offset:32768
    ds_read_b128 v[164:167], v6 offset:33792
    v_mul_f32 v9, v9, v126
    v_mul_f32 v10, v10, v127
    v_mfma_f32_32x32x16_bf16 v[144:159], v[196:199], a[32:35], v[144:159]
    ds_read_b128 v[168:171], v6 offset:34816
    ds_read_b128 v[172:175], v6 offset:35840
    v_exp_f32 v7, v7
    v_mfma_f32_32x32x16_bf16 v[128:143], v[200:203], a[36:39], v[128:143]
    ds_read_b128 v[176:179], v6 offset:36864
    ds_read_b128 v[180:183], v6 offset:37888
    v_exp_f32 v8, v8
    v_mfma_f32_32x32x16_bf16 v[144:159], v[204:207], a[36:39], v[144:159]
    ds_read_b128 v[184:187], v6 offset:38912
    ds_read_b128 v[188:191], v6 offset:39936
    s_add_u32 m0, s59, 90112
    v_mfma_f32_32x32x16_bf16 v[128:143], v[208:211], a[40:43], v[128:143]
    buffer_load_dwordx4 v36, s[40:43], s58 offen offset:1024 sc1 lds
    s_add_u32 m0, s59, 98304
    s_add_u32 s58, s8, 122880
    v_mfma_f32_32x32x16_bf16 v[144:159], v[212:215], a[40:43], v[144:159]
    buffer_load_dwordx4 v36, s[40:43], s58 offen offset:0 sc1 lds
    s_add_u32 m0, s62, 16384
    v_exp_f32 v9, v9
    v_mfma_f32_32x32x16_bf16 v[128:143], v[216:219], a[44:47], v[128:143]
    buffer_load_dwordx4 v40, s[32:35], s93 offen offset:2048 lds
    v_exp_f32 v10, v10
    v_add_f32 v7, 1.0, v7
    v_mfma_f32_32x32x16_bf16 v[144:159], v[220:223], a[44:47], v[144:159]
    buffer_load_dwordx4 v40, s[32:35], s94 offen offset:3072 lds
    s_waitcnt vmcnt(10) lgkmcnt(0)
    s_barrier
    v_mfma_f32_32x32x16_bf16 v[128:143], v[160:163], a[48:51], v[128:143]
    ds_read_b128 v[192:195], v6 offset:40960
    ds_read_b128 v[196:199], v6 offset:41984
    v_add_f32 v8, 1.0, v8
    v_add_f32 v9, 1.0, v9
    v_mfma_f32_32x32x16_bf16 v[144:159], v[164:167], a[48:51], v[144:159]
    ds_read_b128 v[200:203], v6 offset:43008
    ds_read_b128 v[204:207], v6 offset:44032
    v_add_f32 v10, 1.0, v10
    v_mfma_f32_32x32x16_bf16 v[128:143], v[168:171], a[52:55], v[128:143]
    ds_read_b128 v[208:211], v6 offset:45056
    ds_read_b128 v[212:215], v6 offset:46080
    v_rcp_f32 v7, v7
    v_mfma_f32_32x32x16_bf16 v[144:159], v[172:175], a[52:55], v[144:159]
    ds_read_b128 v[216:219], v6 offset:47104
    ds_read_b128 v[220:223], v6 offset:48128
    s_add_u32 m0, s59, 98304
    v_mfma_f32_32x32x16_bf16 v[128:143], v[176:179], a[56:59], v[128:143]
    buffer_load_dwordx4 v36, s[40:43], s58 offen offset:1024 sc1 lds
    s_add_u32 m0, s59, 106496
    s_add_u32 s58, s9, 40960
    v_mfma_f32_32x32x16_bf16 v[144:159], v[180:183], a[56:59], v[144:159]
    buffer_load_dwordx4 v36, s[40:43], s58 offen offset:0 sc1 lds
    v_add_u32 v40, 0x20000, v40
    s_add_u32 m0, s62, 32768
    v_mfma_f32_32x32x16_bf16 v[128:143], v[184:187], a[60:63], v[128:143]
    buffer_load_dwordx4 v40, s[32:35], 0 offen offset:0 lds
    v_rcp_f32 v8, v8
    v_mfma_f32_32x32x16_bf16 v[144:159], v[188:191], a[60:63], v[144:159]
    s_waitcnt vmcnt(9) lgkmcnt(0)
    s_barrier
    v_mfma_f32_32x32x16_bf16 v[128:143], v[192:195], a[64:67], v[128:143]
    ds_read_b128 v[160:163], v6 offset:0
    ds_read_b128 v[164:167], v6 offset:1024
    v_rcp_f32 v9, v9
    v_mfma_f32_32x32x16_bf16 v[144:159], v[196:199], a[64:67], v[144:159]
    ds_read_b128 v[168:171], v6 offset:2048
    ds_read_b128 v[172:175], v6 offset:3072
    v_rcp_f32 v10, v10
    v_mfma_f32_32x32x16_bf16 v[128:143], v[200:203], a[68:71], v[128:143]
    ds_read_b128 v[176:179], v6 offset:4096
    ds_read_b128 v[180:183], v6 offset:5120
    v_mul_f32 v124, v124, v7
    v_mul_f32 v125, v125, v8
    v_mfma_f32_32x32x16_bf16 v[144:159], v[204:207], a[68:71], v[144:159]
    ds_read_b128 v[184:187], v6 offset:6144
    ds_read_b128 v[188:191], v6 offset:7168
    s_add_u32 m0, s59, 106496
    v_mul_f32 v126, v126, v9
    v_mfma_f32_32x32x16_bf16 v[128:143], v[208:211], a[72:75], v[128:143]
    buffer_load_dwordx4 v36, s[40:43], s58 offen offset:1024 sc1 lds
    s_add_u32 m0, s59, 114688
    s_add_u32 s58, s9, 49152
    v_mul_f32 v127, v127, v10
    v_mfma_f32_32x32x16_bf16 v[144:159], v[212:215], a[72:75], v[144:159]
    buffer_load_dwordx4 v36, s[40:43], s58 offen offset:0 sc1 lds
    s_add_u32 m0, s62, 32768
    v_mfma_f32_32x32x16_bf16 v[128:143], v[216:219], a[76:79], v[128:143]
    buffer_load_dwordx4 v40, s[32:35], s92 offen offset:1024 lds
    v_mfma_f32_32x32x16_bf16 v[144:159], v[220:223], a[76:79], v[144:159]
    buffer_load_dwordx4 v40, s[32:35], s93 offen offset:2048 lds
    s_waitcnt vmcnt(10) lgkmcnt(0)
    s_barrier
    v_mfma_f32_32x32x16_bf16 v[128:143], v[160:163], a[80:83], v[128:143]
    ds_read_b128 v[192:195], v6 offset:8192
    ds_read_b128 v[196:199], v6 offset:9216
    v_mfma_f32_32x32x16_bf16 v[144:159], v[164:167], a[80:83], v[144:159]
    ds_read_b128 v[200:203], v6 offset:10240
    ds_read_b128 v[204:207], v6 offset:11264
    v_mfma_f32_32x32x16_bf16 v[128:143], v[168:171], a[84:87], v[128:143]
    ds_read_b128 v[208:211], v6 offset:12288
    ds_read_b128 v[212:215], v6 offset:13312
    v_mfma_f32_32x32x16_bf16 v[144:159], v[172:175], a[84:87], v[144:159]
    ds_read_b128 v[216:219], v6 offset:14336
    ds_read_b128 v[220:223], v6 offset:15360
    s_add_u32 m0, s59, 114688
    v_mfma_f32_32x32x16_bf16 v[128:143], v[176:179], a[88:91], v[128:143]
    buffer_load_dwordx4 v36, s[40:43], s58 offen offset:1024 sc1 lds
    s_add_u32 m0, s59, 122880
    s_add_u32 s58, s9, 57344
    v_mfma_f32_32x32x16_bf16 v[144:159], v[180:183], a[88:91], v[144:159]
    buffer_load_dwordx4 v36, s[40:43], s58 offen offset:0 sc1 lds
    s_add_u32 m0, s62, 32768
    v_mfma_f32_32x32x16_bf16 v[128:143], v[184:187], a[92:95], v[128:143]
    buffer_load_dwordx4 v40, s[32:35], s94 offen offset:3072 lds
    v_mfma_f32_32x32x16_bf16 v[144:159], v[188:191], a[92:95], v[144:159]
    s_waitcnt vmcnt(9) lgkmcnt(0)
    s_barrier
    v_mfma_f32_32x32x16_bf16 v[128:143], v[192:195], a[96:99], v[128:143]
    ds_read_b128 v[160:163], v6 offset:16384
    ds_read_b128 v[164:167], v6 offset:17408
    v_mfma_f32_32x32x16_bf16 v[144:159], v[196:199], a[96:99], v[144:159]
    ds_read_b128 v[168:171], v6 offset:18432
    ds_read_b128 v[172:175], v6 offset:19456
    v_mfma_f32_32x32x16_bf16 v[128:143], v[200:203], a[100:103], v[128:143]
    ds_read_b128 v[176:179], v6 offset:20480
    ds_read_b128 v[180:183], v6 offset:21504
    v_mfma_f32_32x32x16_bf16 v[144:159], v[204:207], a[100:103], v[144:159]
    ds_read_b128 v[184:187], v6 offset:22528
    ds_read_b128 v[188:191], v6 offset:23552
    s_add_u32 m0, s59, 122880
    v_mfma_f32_32x32x16_bf16 v[128:143], v[208:211], a[104:107], v[128:143]
    buffer_load_dwordx4 v36, s[40:43], s58 offen offset:1024 sc1 lds
    s_add_u32 m0, s59, 81920
    s_add_u32 s58, s9, 65536
    v_mfma_f32_32x32x16_bf16 v[144:159], v[212:215], a[104:107], v[144:159]
    buffer_load_dwordx4 v36, s[40:43], s58 offen offset:0 sc1 lds
    v_add_u32 v40, 0x20000, v40
    s_add_u32 m0, s62, 49152
    v_mfma_f32_32x32x16_bf16 v[128:143], v[216:219], a[108:111], v[128:143]
    buffer_load_dwordx4 v40, s[32:35], 0 offen offset:0 lds
    v_mfma_f32_32x32x16_bf16 v[144:159], v[220:223], a[108:111], v[144:159]
    buffer_load_dwordx4 v40, s[32:35], s92 offen offset:1024 lds
    s_waitcnt vmcnt(10) lgkmcnt(0)
    s_barrier
    v_mfma_f32_32x32x16_bf16 v[128:143], v[160:163], a[112:115], v[128:143]
    ds_read_b128 v[192:195], v6 offset:24576
    ds_read_b128 v[196:199], v6 offset:25600
    v_mfma_f32_32x32x16_bf16 v[144:159], v[164:167], a[112:115], v[144:159]
    ds_read_b128 v[200:203], v6 offset:26624
    ds_read_b128 v[204:207], v6 offset:27648
    v_mfma_f32_32x32x16_bf16 v[128:143], v[168:171], a[116:119], v[128:143]
    ds_read_b128 v[208:211], v6 offset:28672
    ds_read_b128 v[212:215], v6 offset:29696
    v_mfma_f32_32x32x16_bf16 v[144:159], v[172:175], a[116:119], v[144:159]
    ds_read_b128 v[216:219], v6 offset:30720
    ds_read_b128 v[220:223], v6 offset:31744
    s_add_u32 m0, s59, 81920
    v_mfma_f32_32x32x16_bf16 v[128:143], v[176:179], a[120:123], v[128:143]
    buffer_load_dwordx4 v36, s[40:43], s58 offen offset:1024 sc1 lds
    s_add_u32 m0, s59, 90112
    s_add_u32 s58, s9, 73728
    v_mfma_f32_32x32x16_bf16 v[144:159], v[180:183], a[120:123], v[144:159]
    buffer_load_dwordx4 v36, s[40:43], s58 offen offset:0 sc1 lds
    s_add_u32 m0, s62, 49152
    v_mfma_f32_32x32x16_bf16 v[128:143], v[184:187], a[124:127], v[128:143]
    buffer_load_dwordx4 v40, s[32:35], s93 offen offset:2048 lds
    v_mfma_f32_32x32x16_bf16 v[144:159], v[188:191], a[124:127], v[144:159]
    s_waitcnt vmcnt(9) lgkmcnt(0)
    s_barrier
    v_mfma_f32_32x32x16_bf16 v[224:239], v[192:195], a[208:211], v[224:239]
    ds_read_b128 v[160:163], v6 offset:32768
    ds_read_b128 v[164:167], v6 offset:33792
    v_mfma_f32_32x32x16_bf16 v[240:255], v[196:199], a[208:211], v[240:255]
    ds_read_b128 v[168:171], v6 offset:34816
    ds_read_b128 v[172:175], v6 offset:35840
    s_nop 1
    v_cvt_pk_bf16_f32 v80, v128, v129
    v_cvt_pk_bf16_f32 v81, v130, v131
    v_mfma_f32_32x32x16_bf16 v[224:239], v[200:203], a[212:215], v[224:239]
    ds_read_b128 v[176:179], v6 offset:36864
    ds_read_b128 v[180:183], v6 offset:37888
    v_cvt_pk_bf16_f32 v82, v132, v133
    v_cvt_pk_bf16_f32 v83, v134, v135
    v_mfma_f32_32x32x16_bf16 v[240:255], v[204:207], a[212:215], v[240:255]
    ds_read_b128 v[184:187], v6 offset:38912
    ds_read_b128 v[188:191], v6 offset:39936
    s_add_u32 m0, s59, 90112
    v_cvt_pk_bf16_f32 v84, v136, v137
    v_mfma_f32_32x32x16_bf16 v[224:239], v[208:211], a[216:219], v[224:239]
    buffer_load_dwordx4 v36, s[40:43], s58 offen offset:1024 sc1 lds
    s_add_u32 m0, s59, 98304
    s_add_u32 s58, s9, 81920
    v_cvt_pk_bf16_f32 v85, v138, v139
    v_mfma_f32_32x32x16_bf16 v[240:255], v[212:215], a[216:219], v[240:255]
    buffer_load_dwordx4 v36, s[40:43], s58 offen offset:0 sc1 lds
    v_cvt_pk_bf16_f32 v86, v140, v141
    v_cvt_pk_bf16_f32 v87, v142, v143
    v_cvt_pk_bf16_f32 v88, v144, v145
    v_mfma_f32_32x32x16_bf16 v[224:239], v[216:219], a[220:223], v[224:239]
    buffer_store_dwordx4 v[80:83], v46, s[40:43], 0 offen offset:0 sc1
    v_mfma_f32_32x32x16_bf16 v[240:255], v[220:223], a[220:223], v[240:255]
    buffer_store_dwordx4 v[84:87], v46, s[40:43], 0 offen offset:512 sc1
    s_waitcnt vmcnt(10) lgkmcnt(0)
    s_barrier
    v_mfma_f32_32x32x16_bf16 v[224:239], v[160:163], a[224:227], v[224:239]
    ds_read_b128 v[192:195], v6 offset:40960
    ds_read_b128 v[196:199], v6 offset:41984
    v_cvt_pk_bf16_f32 v89, v146, v147
    v_cvt_pk_bf16_f32 v90, v148, v149
    v_mfma_f32_32x32x16_bf16 v[240:255], v[164:167], a[224:227], v[240:255]
    ds_read_b128 v[200:203], v6 offset:43008
    ds_read_b128 v[204:207], v6 offset:44032
    v_cvt_pk_bf16_f32 v91, v150, v151
    v_cvt_pk_bf16_f32 v92, v152, v153
    v_mfma_f32_32x32x16_bf16 v[224:239], v[168:171], a[228:231], v[224:239]
    ds_read_b128 v[208:211], v6 offset:45056
    ds_read_b128 v[212:215], v6 offset:46080
    v_cvt_pk_bf16_f32 v93, v154, v155
    v_cvt_pk_bf16_f32 v94, v156, v157
    v_mfma_f32_32x32x16_bf16 v[240:255], v[172:175], a[228:231], v[240:255]
    ds_read_b128 v[216:219], v6 offset:47104
    ds_read_b128 v[220:223], v6 offset:48128
    v_cvt_pk_bf16_f32 v95, v158, v159
    v_mfma_f32_32x32x16_bf16 v[224:239], v[176:179], a[232:235], v[224:239]
    buffer_load_dwordx4 v36, s[40:43], s58 offen offset:1024 sc1 lds
    s_add_u32 m0, s59, 106496
    s_add_u32 s58, s9, 90112
    v_mfma_f32_32x32x16_bf16 v[240:255], v[180:183], a[232:235], v[240:255]
    buffer_load_dwordx4 v36, s[40:43], s58 offen offset:0 sc1 lds
    v_mfma_f32_32x32x16_bf16 v[224:239], v[184:187], a[236:239], v[224:239]
    buffer_store_dwordx4 v[88:91], v46, s[40:43], 0 offen offset:1024 sc1
    v_mfma_f32_32x32x16_bf16 v[240:255], v[188:191], a[236:239], v[240:255]
    buffer_store_dwordx4 v[92:95], v46, s[40:43], 0 offen offset:1536 sc1
    s_waitcnt vmcnt(10) lgkmcnt(0)
    s_barrier
    v_mfma_f32_32x32x16_bf16 v[224:239], v[192:195], a[240:243], v[224:239]
    ds_read_b128 v[160:163], v6 offset:0
    ds_read_b128 v[164:167], v6 offset:1024
    v_mfma_f32_32x32x16_bf16 v[240:255], v[196:199], a[240:243], v[240:255]
    ds_read_b128 v[168:171], v6 offset:2048
    ds_read_b128 v[172:175], v6 offset:3072
    v_mfma_f32_32x32x16_bf16 v[224:239], v[200:203], a[244:247], v[224:239]
    ds_read_b128 v[176:179], v6 offset:4096
    ds_read_b128 v[180:183], v6 offset:5120
    v_mfma_f32_32x32x16_bf16 v[240:255], v[204:207], a[244:247], v[240:255]
    ds_read_b128 v[184:187], v6 offset:6144
    ds_read_b128 v[188:191], v6 offset:7168
    v_mfma_f32_32x32x16_bf16 v[224:239], v[208:211], a[248:251], v[224:239]
    buffer_load_dwordx4 v36, s[40:43], s58 offen offset:1024 sc1 lds
    s_add_u32 m0, s59, 114688
    s_add_u32 s58, s9, 98304
    v_mfma_f32_32x32x16_bf16 v[240:255], v[212:215], a[248:251], v[240:255]
    buffer_load_dwordx4 v36, s[40:43], s58 offen offset:0 sc1 lds
    v_mfma_f32_32x32x16_bf16 v[224:239], v[216:219], a[252:255], v[224:239]
    v_mfma_f32_32x32x16_bf16 v[240:255], v[220:223], a[252:255], v[240:255]
    s_waitcnt vmcnt(9) lgkmcnt(0)
    s_barrier
    v_mfma_f32_32x32x16_bf16 v[224:239], v[160:163], a[0:3], v[224:239]
    ds_read_b128 v[192:195], v6 offset:8192
    ds_read_b128 v[196:199], v6 offset:9216
    v_mfma_f32_32x32x16_bf16 v[240:255], v[164:167], a[0:3], v[240:255]
    ds_read_b128 v[200:203], v6 offset:10240
    ds_read_b128 v[204:207], v6 offset:11264
    v_mfma_f32_32x32x16_bf16 v[224:239], v[168:171], a[4:7], v[224:239]
    ds_read_b128 v[208:211], v6 offset:12288
    ds_read_b128 v[212:215], v6 offset:13312
    v_mfma_f32_32x32x16_bf16 v[240:255], v[172:175], a[4:7], v[240:255]
    ds_read_b128 v[216:219], v6 offset:14336
    ds_read_b128 v[220:223], v6 offset:15360
    v_mfma_f32_32x32x16_bf16 v[224:239], v[176:179], a[8:11], v[224:239]
    buffer_load_dwordx4 v36, s[40:43], s58 offen offset:1024 sc1 lds
    s_add_u32 m0, s59, 122880
    s_add_u32 s58, s9, 106496
    v_mfma_f32_32x32x16_bf16 v[240:255], v[180:183], a[8:11], v[240:255]
    buffer_load_dwordx4 v36, s[40:43], s58 offen offset:0 sc1 lds
    s_add_u32 m0, s62, 49152
    v_mfma_f32_32x32x16_bf16 v[224:239], v[184:187], a[12:15], v[224:239]
    buffer_load_dwordx4 v40, s[32:35], s94 offen offset:3072 lds
    v_mfma_f32_32x32x16_bf16 v[240:255], v[188:191], a[12:15], v[240:255]
    s_waitcnt vmcnt(8) lgkmcnt(0)
    s_barrier
    v_mfma_f32_32x32x16_bf16 v[224:239], v[192:195], a[16:19], v[224:239]
    ds_read_b128 v[160:163], v6 offset:16384
    ds_read_b128 v[164:167], v6 offset:17408
    v_mfma_f32_32x32x16_bf16 v[240:255], v[196:199], a[16:19], v[240:255]
    ds_read_b128 v[168:171], v6 offset:18432
    ds_read_b128 v[172:175], v6 offset:19456
    v_mfma_f32_32x32x16_bf16 v[224:239], v[200:203], a[20:23], v[224:239]
    ds_read_b128 v[176:179], v6 offset:20480
    ds_read_b128 v[180:183], v6 offset:21504
    v_mfma_f32_32x32x16_bf16 v[240:255], v[204:207], a[20:23], v[240:255]
    ds_read_b128 v[184:187], v6 offset:22528
    ds_read_b128 v[188:191], v6 offset:23552
    s_waitcnt vmcnt(5)
    buffer_store_dword v45, v37, s[40:43], 0 offen sc1
    s_add_u32 m0, s59, 122880
    v_mfma_f32_32x32x16_bf16 v[224:239], v[208:211], a[24:27], v[224:239]
    buffer_load_dwordx4 v36, s[40:43], s58 offen offset:1024 sc1 lds
    s_add_u32 m0, s59, 81920
    s_add_u32 s58, s9, 114688
    v_mfma_f32_32x32x16_bf16 v[240:255], v[212:215], a[24:27], v[240:255]
    buffer_load_dwordx4 v36, s[40:43], s58 offen offset:0 sc1 lds
    v_add_u32 v40, 0x20000, v40
    s_add_u32 m0, s62, 65536
    v_mfma_f32_32x32x16_bf16 v[224:239], v[216:219], a[28:31], v[224:239]
    buffer_load_dwordx4 v40, s[32:35], 0 offen offset:0 lds
    v_mfma_f32_32x32x16_bf16 v[240:255], v[220:223], a[28:31], v[240:255]
    s_waitcnt vmcnt(8) lgkmcnt(0)
    s_barrier
    v_mfma_f32_32x32x16_bf16 v[224:239], v[160:163], a[32:35], v[224:239]
    ds_read_b128 v[192:195], v6 offset:24576
    ds_read_b128 v[196:199], v6 offset:25600
    v_mfma_f32_32x32x16_bf16 v[240:255], v[164:167], a[32:35], v[240:255]
    ds_read_b128 v[200:203], v6 offset:26624
    ds_read_b128 v[204:207], v6 offset:27648
    v_mfma_f32_32x32x16_bf16 v[224:239], v[168:171], a[36:39], v[224:239]
    ds_read_b128 v[208:211], v6 offset:28672
    ds_read_b128 v[212:215], v6 offset:29696
    v_mfma_f32_32x32x16_bf16 v[240:255], v[172:175], a[36:39], v[240:255]
    ds_read_b128 v[216:219], v6 offset:30720
    ds_read_b128 v[220:223], v6 offset:31744
    buffer_load_dword v47, v49, s[40:43], 0 offen sc1
    s_add_u32 m0, s59, 81920
    v_mfma_f32_32x32x16_bf16 v[224:239], v[176:179], a[40:43], v[224:239]
    buffer_load_dwordx4 v36, s[40:43], s58 offen offset:1024 sc1 lds
    s_add_u32 m0, s59, 90112
    s_add_u32 s58, s9, 122880
    v_mfma_f32_32x32x16_bf16 v[240:255], v[180:183], a[40:43], v[240:255]
    buffer_load_dwordx4 v36, s[40:43], s58 offen offset:0 sc1 lds
    s_add_u32 m0, s62, 65536
    v_mfma_f32_32x32x16_bf16 v[224:239], v[184:187], a[44:47], v[224:239]
    buffer_load_dwordx4 v40, s[32:35], s92 offen offset:1024 lds
    v_mfma_f32_32x32x16_bf16 v[240:255], v[188:191], a[44:47], v[240:255]
    s_waitcnt vmcnt(10) lgkmcnt(0)
    s_barrier
    v_mfma_f32_32x32x16_bf16 v[224:239], v[192:195], a[48:51], v[224:239]
    ds_read_b128 v[160:163], v6 offset:32768
    ds_read_b128 v[164:167], v6 offset:33792
    v_mfma_f32_32x32x16_bf16 v[240:255], v[196:199], a[48:51], v[240:255]
    ds_read_b128 v[168:171], v6 offset:34816
    ds_read_b128 v[172:175], v6 offset:35840
    v_mfma_f32_32x32x16_bf16 v[224:239], v[200:203], a[52:55], v[224:239]
    ds_read_b128 v[176:179], v6 offset:36864
    ds_read_b128 v[180:183], v6 offset:37888
    v_mfma_f32_32x32x16_bf16 v[240:255], v[204:207], a[52:55], v[240:255]
    ds_read_b128 v[184:187], v6 offset:38912
    ds_read_b128 v[188:191], v6 offset:39936
    s_add_u32 m0, s59, 90112
    v_mfma_f32_32x32x16_bf16 v[224:239], v[208:211], a[56:59], v[224:239]
    buffer_load_dwordx4 v36, s[40:43], s58 offen offset:1024 sc1 lds
    s_add_u32 m0, s62, 65536
    v_mfma_f32_32x32x16_bf16 v[240:255], v[212:215], a[56:59], v[240:255]
    buffer_load_dwordx4 v40, s[32:35], s93 offen offset:2048 lds
    v_mfma_f32_32x32x16_bf16 v[224:239], v[216:219], a[60:63], v[224:239]
    v_mfma_f32_32x32x16_bf16 v[240:255], v[220:223], a[60:63], v[240:255]
    s_waitcnt vmcnt(8) lgkmcnt(0)
    s_barrier
    v_mfma_f32_32x32x16_bf16 v[224:239], v[160:163], a[64:67], v[224:239]
    ds_read_b128 v[192:195], v6 offset:40960
    ds_read_b128 v[196:199], v6 offset:41984
    v_mfma_f32_32x32x16_bf16 v[240:255], v[164:167], a[64:67], v[240:255]
    ds_read_b128 v[200:203], v6 offset:43008
    ds_read_b128 v[204:207], v6 offset:44032
    v_mfma_f32_32x32x16_bf16 v[224:239], v[168:171], a[68:71], v[224:239]
    ds_read_b128 v[208:211], v6 offset:45056
    ds_read_b128 v[212:215], v6 offset:46080
    v_mfma_f32_32x32x16_bf16 v[240:255], v[172:175], a[68:71], v[240:255]
    ds_read_b128 v[216:219], v6 offset:47104
    ds_read_b128 v[220:223], v6 offset:48128
    s_waitcnt vmcnt(5)
    v_cmp_ne_u32 vcc, s53, v47
    s_cbranch_vccnz L_retry_25_wt
L_got_26_wt:
    v_mfma_f32_32x32x16_bf16 v[224:239], v[176:179], a[72:75], v[224:239]
    buffer_load_dwordx4 v[80:83], v50, s[40:43], 0 offen offset:0 sc1
    v_mfma_f32_32x32x16_bf16 v[240:255], v[180:183], a[72:75], v[240:255]
    buffer_load_dwordx4 v[84:87], v50, s[40:43], 0 offen offset:512 sc1
    v_mfma_f32_32x32x16_bf16 v[224:239], v[184:187], a[76:79], v[224:239]
    buffer_load_dwordx4 v[88:91], v50, s[40:43], 0 offen offset:1024 sc1
    v_mfma_f32_32x32x16_bf16 v[240:255], v[188:191], a[76:79], v[240:255]
    buffer_load_dwordx4 v[92:95], v50, s[40:43], 0 offen offset:1536 sc1
    s_waitcnt vmcnt(8) lgkmcnt(0)
    s_barrier
    v_mfma_f32_32x32x16_bf16 v[224:239], v[192:195], a[80:83], v[224:239]
    ds_read_b128 v[160:163], v6 offset:0
    ds_read_b128 v[164:167], v6 offset:1024
    v_mfma_f32_32x32x16_bf16 v[240:255], v[196:199], a[80:83], v[240:255]
    ds_read_b128 v[168:171], v6 offset:2048
    ds_read_b128 v[172:175], v6 offset:3072
    v_mfma_f32_32x32x16_bf16 v[224:239], v[200:203], a[84:87], v[224:239]
    ds_read_b128 v[176:179], v6 offset:4096
    ds_read_b128 v[180:183], v6 offset:5120
    v_mfma_f32_32x32x16_bf16 v[240:255], v[204:207], a[84:87], v[240:255]
    ds_read_b128 v[184:187], v6 offset:6144
    ds_read_b128 v[188:191], v6 offset:7168
    v_mfma_f32_32x32x16_bf16 v[224:239], v[208:211], a[88:91], v[224:239]
    buffer_load_dwordx4 v40, s[32:35], s94 offen offset:3072 lds
    v_add_u32 v40, 0x20000, v40
    s_add_u32 m0, s62, 131072
    v_mfma_f32_32x32x16_bf16 v[240:255], v[212:215], a[88:91], v[240:255]
    buffer_load_dwordx4 v40, s[32:35], 0 offen offset:0 lds
    v_mfma_f32_32x32x16_bf16 v[224:239], v[216:219], a[92:95], v[224:239]
    buffer_load_dwordx4 v40, s[32:35], s92 offen offset:1024 lds
    v_mfma_f32_32x32x16_bf16 v[240:255], v[220:223], a[92:95], v[240:255]
    buffer_load_dwordx4 v40, s[32:35], s93 offen offset:2048 lds
    s_waitcnt vmcnt(9) lgkmcnt(0)
    s_barrier
    v_mfma_f32_32x32x16_bf16 v[224:239], v[160:163], a[96:99], v[224:239]
    ds_read_b128 v[192:195], v6 offset:8192
    ds_read_b128 v[196:199], v6 offset:9216
    v_mfma_f32_32x32x16_bf16 v[240:255], v[164:167], a[96:99], v[240:255]
    ds_read_b128 v[200:203], v6 offset:10240
    ds_read_b128 v[204:207], v6 offset:11264
    v_mfma_f32_32x32x16_bf16 v[224:239], v[168:171], a[100:103], v[224:239]
    ds_read_b128 v[208:211], v6 offset:12288
    ds_read_b128 v[212:215], v6 offset:13312
    v_mfma_f32_32x32x16_bf16 v[240:255], v[172:175], a[100:103], v[240:255]
    ds_read_b128 v[216:219], v6 offset:14336
    ds_read_b128 v[220:223], v6 offset:15360
    v_mfma_f32_32x32x16_bf16 v[224:239], v[176:179], a[104:107], v[224:239]
    buffer_load_dwordx4 v40, s[32:35], s94 offen offset:3072 lds
    v_add_u32 v40, 0x20000, v40
    s_add_u32 m0, s62, 147456
    v_mfma_f32_32x32x16_bf16 v[240:255], v[180:183], a[104:107], v[240:255]
    buffer_load_dwordx4 v40, s[32:35], 0 offen offset:0 lds
    v_mfma_f32_32x32x16_bf16 v[224:239], v[184:187], a[108:111], v[224:239]
    buffer_load_dwordx4 v40, s[32:35], s92 offen offset:1024 lds
    v_mfma_f32_32x32x16_bf16 v[240:255], v[188:191], a[108:111], v[240:255]
    buffer_load_dwordx4 v40, s[32:35], s93 offen offset:2048 lds
    s_waitcnt lgkmcnt(0)
    s_barrier
    v_mfma_f32_32x32x16_bf16 v[224:239], v[192:195], a[112:115], v[224:239]
    s_waitcnt vmcnt(8)
    v_lshlrev_b32 v128, 16, v80
    v_and_b32 v129, 0xffff0000, v80
    v_lshlrev_b32 v130, 16, v81
    v_mfma_f32_32x32x16_bf16 v[240:255], v[196:199], a[112:115], v[240:255]
    v_and_b32 v131, 0xffff0000, v81
    v_lshlrev_b32 v132, 16, v82
    v_and_b32 v133, 0xffff0000, v82
    v_lshlrev_b32 v134, 16, v83
    v_mfma_f32_32x32x16_bf16 v[224:239], v[200:203], a[116:119], v[224:239]
    v_and_b32 v135, 0xffff0000, v83
    v_lshlrev_b32 v136, 16, v84
    v_and_b32 v137, 0xffff0000, v84
    v_lshlrev_b32 v138, 16, v85
    v_mfma_f32_32x32x16_bf16 v[240:255], v[204:207], a[116:119], v[240:255]
    v_and_b32 v139, 0xffff0000, v85
    v_lshlrev_b32 v140, 16, v86
    v_and_b32 v141, 0xffff0000, v86
    v_lshlrev_b32 v142, 16, v87
    v_mfma_f32_32x32x16_bf16 v[224:239], v[208:211], a[120:123], v[224:239]
    buffer_load_dwordx4 v40, s[32:35], s94 offen offset:3072 lds
    v_and_b32 v143, 0xffff0000, v87
    v_lshlrev_b32 v144, 16, v88
    v_and_b32 v145, 0xffff0000, v88
    v_mfma_f32_32x32x16_bf16 v[240:255], v[212:215], a[120:123], v[240:255]
    v_lshlrev_b32 v146, 16, v89
    v_and_b32 v147, 0xffff0000, v89
    v_lshlrev_b32 v148, 16, v90
    v_and_b32 v149, 0xffff0000, v90
    v_mfma_f32_32x32x16_bf16 v[224:239], v[216:219], a[124:127], v[224:239]
    v_lshlrev_b32 v150, 16, v91
    v_and_b32 v151, 0xffff0000, v91
    v_lshlrev_b32 v152, 16, v92
    v_and_b32 v153, 0xffff0000, v92
    v_mfma_f32_32x32x16_bf16 v[240:255], v[220:223], a[124:127], v[240:255]
    v_lshlrev_b32 v154, 16, v93
    v_and_b32 v155, 0xffff0000, v93
    v_lshlrev_b32 v156, 16, v94
    v_and_b32 v157, 0xffff0000, v94
    v_lshlrev_b32 v158, 16, v95
    v_and_b32 v159, 0xffff0000, v95
    v_mul_f32 v128, v128, v96
    v_mul_f32 v129, v129, v97
    v_mul_f32 v130, v130, v98
    v_mul_f32 v131, v131, v99
    v_mul_f32 v132, v132, v100
    v_mul_f32 v133, v133, v101
    v_mul_f32 v134, v134, v102
    v_mul_f32 v135, v135, v103
    v_mul_f32 v136, v136, v104
    v_mul_f32 v137, v137, v105
    v_mul_f32 v138, v138, v106
    v_mul_f32 v139, v139, v107
    v_mul_f32 v140, v140, v108
    v_mul_f32 v141, v141, v109
    v_mul_f32 v142, v142, v110
    v_mul_f32 v143, v143, v111
    v_mul_f32 v144, v144, v112
    v_mul_f32 v145, v145, v113
    v_mul_f32 v146, v146, v114
    v_mul_f32 v147, v147, v115
    v_mul_f32 v148, v148, v116
    v_mul_f32 v149, v149, v117
    v_mul_f32 v150, v150, v118
    v_mul_f32 v151, v151, v119
    v_mul_f32 v152, v152, v120
    v_mul_f32 v153, v153, v121
    v_mul_f32 v154, v154, v122
    v_mul_f32 v155, v155, v123
    v_mul_f32 v156, v156, v124
    v_mul_f32 v157, v157, v125
    v_mul_f32 v158, v158, v126
    v_mul_f32 v159, v159, v127
    v_pk_fma_f32 v[128:129], v[224:225], v[96:97], v[128:129]
    v_pk_fma_f32 v[130:131], v[226:227], v[98:99], v[130:131]
    v_pk_fma_f32 v[132:133], v[228:229], v[100:101], v[132:133]
    v_pk_fma_f32 v[134:135], v[230:231], v[102:103], v[134:135]
    v_pk_fma_f32 v[136:137], v[232:233], v[104:105], v[136:137]
    v_pk_fma_f32 v[138:139], v[234:235], v[106:107], v[138:139]
    v_pk_fma_f32 v[140:141], v[236:237], v[108:109], v[140:141]
    v_pk_fma_f32 v[142:143], v[238:239], v[110:111], v[142:143]
    v_cvt_pk_bf16_f32 v80, v128, v129
    v_cvt_pk_bf16_f32 v81, v130, v131
    v_cvt_pk_bf16_f32 v82, v132, v133
    v_cvt_pk_bf16_f32 v83, v134, v135
    v_cvt_pk_bf16_f32 v84, v136, v137
    v_cvt_pk_bf16_f32 v85, v138, v139
    v_cvt_pk_bf16_f32 v86, v140, v141
    v_cvt_pk_bf16_f32 v87, v142, v143
    buffer_store_dwordx4 v[80:83], v50, s[40:43], 0 offen offset:0 sc1
    buffer_store_dwordx4 v[84:87], v50, s[40:43], 0 offen offset:512 sc1
    v_pk_fma_f32 v[144:145], v[240:241], v[112:113], v[144:145]
    v_pk_fma_f32 v[146:147], v[242:243], v[114:115], v[146:147]
    v_pk_fma_f32 v[148:149], v[244:245], v[116:117], v[148:149]
    v_pk_fma_f32 v[150:151], v[246:247], v[118:119], v[150:151]
    v_pk_fma_f32 v[152:153], v[248:249], v[120:121], v[152:153]
    v_pk_fma_f32 v[154:155], v[250:251], v[122:123], v[154:155]
    v_pk_fma_f32 v[156:157], v[252:253], v[124:125], v[156:157]
    v_pk_fma_f32 v[158:159], v[254:255], v[126:127], v[158:159]
    v_cvt_pk_bf16_f32 v88, v144, v145
    v_cvt_pk_bf16_f32 v89, v146, v147
    v_cvt_pk_bf16_f32 v90, v148, v149
    v_cvt_pk_bf16_f32 v91, v150, v151
    v_cvt_pk_bf16_f32 v92, v152, v153
    v_cvt_pk_bf16_f32 v93, v154, v155
    v_cvt_pk_bf16_f32 v94, v156, v157
    v_cvt_pk_bf16_f32 v95, v158, v159
    buffer_store_dwordx4 v[88:91], v50, s[40:43], 0 offen offset:1024 sc1
    buffer_store_dwordx4 v[92:95], v50, s[40:43], 0 offen offset:1536 sc1
    v_mov_b32 v1, v62
L_s7_wt:
    s_barrier
    ds_read_b64_tr_b16 a[0:1], v26 offset:0
    ds_read_b64_tr_b16 a[2:3], v26 offset:1024
    ds_read_b64_tr_b16 a[4:5], v27 offset:0
    ds_read_b64_tr_b16 a[6:7], v27 offset:1024
    ds_read_b64_tr_b16 a[8:9], v28 offset:0
    ds_read_b64_tr_b16 a[10:11], v28 offset:1024
    ds_read_b64_tr_b16 a[12:13], v29 offset:0
    ds_read_b64_tr_b16 a[14:15], v29 offset:1024
    ds_read_b64_tr_b16 a[16:17], v26 offset:4096
    ds_read_b64_tr_b16 a[18:19], v26 offset:5120
    ds_read_b64_tr_b16 a[20:21], v27 offset:4096
    ds_read_b64_tr_b16 a[22:23], v27 offset:5120
    ds_read_b64_tr_b16 a[24:25], v28 offset:4096
    ds_read_b64_tr_b16 a[26:27], v28 offset:5120
    ds_read_b64_tr_b16 a[28:29], v29 offset:4096
    ds_read_b64_tr_b16 a[30:31], v29 offset:5120
    ds_read_b64_tr_b16 a[32:33], v26 offset:8192
    ds_read_b64_tr_b16 a[34:35], v26 offset:9216
    ds_read_b64_tr_b16 a[36:37], v27 offset:8192
    ds_read_b64_tr_b16 a[38:39], v27 offset:9216
    ds_read_b64_tr_b16 a[40:41], v28 offset:8192
    ds_read_b64_tr_b16 a[42:43], v28 offset:9216
    ds_read_b64_tr_b16 a[44:45], v29 offset:8192
    ds_read_b64_tr_b16 a[46:47], v29 offset:9216
    s_waitcnt vmcnt(0)
    buffer_store_dword v45, v1, s[40:43], 0 offen sc1
    ds_read_b64_tr_b16 a[48:49], v26 offset:12288
    ds_read_b64_tr_b16 a[50:51], v26 offset:13312
    ds_read_b64_tr_b16 a[52:53], v27 offset:12288
    ds_read_b64_tr_b16 a[54:55], v27 offset:13312
    ds_read_b64_tr_b16 a[56:57], v28 offset:12288
    ds_read_b64_tr_b16 a[58:59], v28 offset:13312
    ds_read_b64_tr_b16 a[60:61], v29 offset:12288
    ds_read_b64_tr_b16 a[62:63], v29 offset:13312
    ds_read_b64_tr_b16 a[64:65], v26 offset:16384
    ds_read_b64_tr_b16 a[66:67], v26 offset:17408
    ds_read_b64_tr_b16 a[68:69], v27 offset:16384
    ds_read_b64_tr_b16 a[70:71], v27 offset:17408
    ds_read_b64_tr_b16 a[72:73], v28 offset:16384
    ds_read_b64_tr_b16 a[74:75], v28 offset:17408
    ds_read_b64_tr_b16 a[76:77], v29 offset:16384
    ds_read_b64_tr_b16 a[78:79], v29 offset:17408
    v_and_b32 v37, 15, v0
    v_min_u32 v37, 13, v37
    v_and_b32 v44, 0xffffff80, v44
    v_lshl_add_u32 v44, v37, 2, v44
    s_mov_b32 s58, 32768
    s_lshl_b32 s60, s49, 2
    s_add_u32 s60, s60, s44
    s_and_b32 s59, s60, 7
    s_mul_i32 s59, s59, 28672
    s_add_u32 s59, s59, s3
    buffer_load_dword v47, v44, s[40:43], s58 offen sc1
    ds_read_b64_tr_b16 a[80:81], v26 offset:20480
    ds_read_b64_tr_b16 a[82:83], v26 offset:21504
    ds_read_b64_tr_b16 a[84:85], v27 offset:20480
    ds_read_b64_tr_b16 a[86:87], v27 offset:21504
    ds_read_b64_tr_b16 a[88:89], v28 offset:20480
    ds_read_b64_tr_b16 a[90:91], v28 offset:21504
    ds_read_b64_tr_b16 a[92:93], v29 offset:20480
    ds_read_b64_tr_b16 a[94:95], v29 offset:21504
    ds_read_b64_tr_b16 a[96:97], v26 offset:24576
    ds_read_b64_tr_b16 a[98:99], v26 offset:25600
    ds_read_b64_tr_b16 a[100:101], v27 offset:24576
    ds_read_b64_tr_b16 a[102:103], v27 offset:25600
    ds_read_b64_tr_b16 a[104:105], v28 offset:24576
    ds_read_b64_tr_b16 a[106:107], v28 offset:25600
    ds_read_b64_tr_b16 a[108:109], v29 offset:24576
    ds_read_b64_tr_b16 a[110:111], v29 offset:25600
    ds_read_b64_tr_b16 a[112:113], v26 offset:28672
    ds_read_b64_tr_b16 a[114:115], v26 offset:29696
    ds_read_b64_tr_b16 a[116:117], v27 offset:28672
    ds_read_b64_tr_b16 a[118:119], v27 offset:29696
    v_lshlrev_b32 v128, 16, v18
    v_and_b32 v129, 0xffff0000, v18
    v_lshlrev_b32 v130, 16, v19
    v_and_b32 v131, 0xffff0000, v19
    v_lshlrev_b32 v132, 16, v20
    v_and_b32 v133, 0xffff0000, v20
    v_lshlrev_b32 v134, 16, v21
    v_and_b32 v135, 0xffff0000, v21
    v_lshlrev_b32 v136, 16, v22
    v_and_b32 v137, 0xffff0000, v22
    v_lshlrev_b32 v138, 16, v23
    v_and_b32 v139, 0xffff0000, v23
    v_lshlrev_b32 v140, 16, v24
    v_and_b32 v141, 0xffff0000, v24
    v_lshlrev_b32 v142, 16, v25
    v_and_b32 v143, 0xffff0000, v25
    s_mov_b32 s61, 0
    s_branch L_got_29_wt
L_again_30_wt:
    buffer_load_dword v47, v44, s[40:43], s58 offen sc1
    s_addk_i32 s61, 1
    s_cmp_gt_u32 s61, 0x80000
    s_cbranch_scc1 L_abort_wt
    s_waitcnt vmcnt(0)
L_got_29_wt:
    s_waitcnt vmcnt(0)
    v_cmp_ne_u32 vcc, s53, v47
    s_cbranch_vccnz L_again_30_wt
    s_barrier
    buffer_load_dwordx4 v[144:147], v36, s[40:43], s59 offen offset:0 sc1
    ds_read_b64_tr_b16 a[120:121], v28 offset:28672
    ds_read_b64_tr_b16 a[122:123], v28 offset:29696
    ds_read_b64_tr_b16 a[124:125], v29 offset:28672
    ds_read_b64_tr_b16 a[126:127], v29 offset:29696
    ds_read_b64_tr_b16 a[128:129], v26 offset:32768
    ds_read_b64_tr_b16 a[130:131], v26 offset:33792
    buffer_load_dwordx4 v[148:151], v36, s[40:43], s59 offen offset:1024 sc1
    ds_read_b64_tr_b16 a[132:133], v27 offset:32768
    ds_read_b64_tr_b16 a[134:135], v27 offset:33792
    ds_read_b64_tr_b16 a[136:137], v28 offset:32768
    ds_read_b64_tr_b16 a[138:139], v28 offset:33792
    ds_read_b64_tr_b16 a[140:141], v29 offset:32768
    ds_read_b64_tr_b16 a[142:143], v29 offset:33792
    buffer_load_dwordx4 v[152:155], v36, s[40:43], s59 offen offset:2048 sc1
    ds_read_b64_tr_b16 a[144:145], v26 offset:36864
    ds_read_b64_tr_b16 a[146:147], v26 offset:37888
    ds_read_b64_tr_b16 a[148:149], v27 offset:36864
    ds_read_b64_tr_b16 a[150:151], v27 offset:37888
    ds_read_b64_tr_b16 a[152:153], v28 offset:36864
    ds_read_b64_tr_b16 a[154:155], v28 offset:37888
    buffer_load_dwordx4 v[156:159], v36, s[40:43], s59 offen offset:3072 sc1
    ds_read_b64_tr_b16 a[156:157], v29 offset:36864
    ds_read_b64_tr_b16 a[158:159], v29 offset:37888
    ds_read_b64_tr_b16 a[160:161], v26 offset:40960
    ds_read_b64_tr_b16 a[162:163], v26 offset:41984
    ds_read_b64_tr_b16 a[164:165], v27 offset:40960
    ds_read_b64_tr_b16 a[166:167], v27 offset:41984
    s_add_u32 s59, s59, 4096
    buffer_load_dwordx4 v[160:163], v36, s[40:43], s59 offen offset:0 sc1
    ds_read_b64_tr_b16 a[168:169], v28 offset:40960
    ds_read_b64_tr_b16 a[170:171], v28 offset:41984
    ds_read_b64_tr_b16 a[172:173], v29 offset:40960
    ds_read_b64_tr_b16 a[174:175], v29 offset:41984
    ds_read_b64_tr_b16 a[176:177], v26 offset:45056
    ds_read_b64_tr_b16 a[178:179], v26 offset:46080
    buffer_load_dwordx4 v[164:167], v36, s[40:43], s59 offen offset:1024 sc1
    buffer_load_dwordx4 v[168:171], v36, s[40:43], s59 offen offset:2048 sc1
    buffer_load_dwordx4 v[172:175], v36, s[40:43], s59 offen offset:3072 sc1
    s_add_u32 s59, s59, 4096
    buffer_load_dwordx4 v[176:179], v36, s[40:43], s59 offen offset:0 sc1
    buffer_load_dwordx4 v[180:183], v36, s[40:43], s59 offen offset:1024 sc1
    buffer_load_dwordx4 v[184:187], v36, s[40:43], s59 offen offset:2048 sc1
    ds_read_b64_tr_b16 a[180:181], v27 offset:45056
    ds_read_b64_tr_b16 a[182:183], v27 offset:46080
    ds_read_b64_tr_b16 a[184:185], v28 offset:45056
    ds_read_b64_tr_b16 a[186:187], v28 offset:46080
    ds_read_b64_tr_b16 a[188:189], v29 offset:45056
    ds_read_b64_tr_b16 a[190:191], v29 offset:46080
    ds_read_b64_tr_b16 a[192:193], v26 offset:49152
    ds_read_b64_tr_b16 a[194:195], v26 offset:50176
    ds_read_b64_tr_b16 a[196:197], v27 offset:49152
    ds_read_b64_tr_b16 a[198:199], v27 offset:50176
    ds_read_b64_tr_b16 a[200:201], v28 offset:49152
    ds_read_b64_tr_b16 a[202:203], v28 offset:50176
    ds_read_b64_tr_b16 a[204:205], v29 offset:49152
    ds_read_b64_tr_b16 a[206:207], v29 offset:50176
    ds_read_b64_tr_b16 a[208:209], v26 offset:53248
    ds_read_b64_tr_b16 a[210:211], v26 offset:54272
    ds_read_b64_tr_b16 a[212:213], v27 offset:53248
    ds_read_b64_tr_b16 a[214:215], v27 offset:54272
    ds_read_b64_tr_b16 a[216:217], v28 offset:53248
    ds_read_b64_tr_b16 a[218:219], v28 offset:54272
    ds_read_b64_tr_b16 a[220:221], v29 offset:53248
    ds_read_b64_tr_b16 a[222:223], v29 offset:54272
    ds_read_b64_tr_b16 a[224:225], v26 offset:57344
    ds_read_b64_tr_b16 a[226:227], v26 offset:58368
    ds_read_b64_tr_b16 a[228:229], v27 offset:57344
    ds_read_b64_tr_b16 a[230:231], v27 offset:58368
    ds_read_b64_tr_b16 a[232:233], v28 offset:57344
    ds_read_b64_tr_b16 a[234:235], v28 offset:58368
    ds_read_b64_tr_b16 a[236:237], v29 offset:57344
    ds_read_b64_tr_b16 a[238:239], v29 offset:58368
    s_waitcnt vmcnt(10) lgkmcnt(15)
    v_mfma_f32_16x16x32_bf16 v[128:131], a[0:3], v[144:147], v[128:131]
    buffer_load_dwordx4 v[188:191], v36, s[40:43], s59 offen offset:3072 sc1
    ds_read_b64_tr_b16 a[240:241], v26 offset:61440
    v_mfma_f32_16x16x32_bf16 v[132:135], a[4:7], v[144:147], v[132:135]
    ds_read_b64_tr_b16 a[242:243], v26 offset:62464
    s_waitcnt lgkmcnt(15)
    v_mfma_f32_16x16x32_bf16 v[136:139], a[8:11], v[144:147], v[136:139]
    ds_read_b64_tr_b16 a[244:245], v27 offset:61440
    v_mfma_f32_16x16x32_bf16 v[140:143], a[12:15], v[144:147], v[140:143]
    ds_read_b64_tr_b16 a[246:247], v27 offset:62464
    s_waitcnt vmcnt(10) lgkmcnt(15)
    v_mfma_f32_16x16x32_bf16 v[128:131], a[16:19], v[148:151], v[128:131]
    ds_read_b64_tr_b16 a[248:249], v28 offset:61440
    s_add_u32 s59, s59, 4096
    buffer_load_dwordx4 v[192:195], v36, s[40:43], s59 offen offset:0 sc1
    v_mfma_f32_16x16x32_bf16 v[132:135], a[20:23], v[148:151], v[132:135]
    ds_read_b64_tr_b16 a[250:251], v28 offset:62464
    s_waitcnt lgkmcnt(15)
    v_mfma_f32_16x16x32_bf16 v[136:139], a[24:27], v[148:151], v[136:139]
    ds_read_b64_tr_b16 a[252:253], v29 offset:61440
    v_mfma_f32_16x16x32_bf16 v[140:143], a[28:31], v[148:151], v[140:143]
    ds_read_b64_tr_b16 a[254:255], v29 offset:62464
    s_waitcnt vmcnt(10) lgkmcnt(15)
    v_mfma_f32_16x16x32_bf16 v[128:131], a[32:35], v[152:155], v[128:131]
    v_add_u32 v26, 0x10000, v26
    v_add_u32 v27, 0x10000, v27
    v_add_u32 v28, 0x10000, v28
    v_add_u32 v29, 0x10000, v29
    ds_read_b64_tr_b16 a[0:1], v26 offset:0
    buffer_load_dwordx4 v[196:199], v36, s[40:43], s59 offen offset:1024 sc1
    v_mfma_f32_16x16x32_bf16 v[132:135], a[36:39], v[152:155], v[132:135]
    ds_read_b64_tr_b16 a[2:3], v26 offset:1024
    s_waitcnt lgkmcnt(15)
    v_mfma_f32_16x16x32_bf16 v[136:139], a[40:43], v[152:155], v[136:139]
    ds_read_b64_tr_b16 a[4:5], v27 offset:0
    v_mfma_f32_16x16x32_bf16 v[140:143], a[44:47], v[152:155], v[140:143]
    ds_read_b64_tr_b16 a[6:7], v27 offset:1024
    s_waitcnt vmcnt(10) lgkmcnt(15)
    v_mfma_f32_16x16x32_bf16 v[128:131], a[48:51], v[156:159], v[128:131]
    ds_read_b64_tr_b16 a[8:9], v28 offset:0
    buffer_load_dwordx4 v[200:203], v36, s[40:43], s59 offen offset:2048 sc1
    v_mfma_f32_16x16x32_bf16 v[132:135], a[52:55], v[156:159], v[132:135]
    ds_read_b64_tr_b16 a[10:11], v28 offset:1024
    s_waitcnt lgkmcnt(15)
    v_mfma_f32_16x16x32_bf16 v[136:139], a[56:59], v[156:159], v[136:139]
    ds_read_b64_tr_b16 a[12:13], v29 offset:0
    v_mfma_f32_16x16x32_bf16 v[140:143], a[60:63], v[156:159], v[140:143]
    ds_read_b64_tr_b16 a[14:15], v29 offset:1024
    s_waitcnt vmcnt(10) lgkmcnt(15)
    v_mfma_f32_16x16x32_bf16 v[128:131], a[64:67], v[160:163], v[128:131]
    ds_read_b64_tr_b16 a[16:17], v26 offset:4096
    buffer_load_dwordx4 v[204:207], v36, s[40:43], s59 offen offset:3072 sc1
    v_mfma_f32_16x16x32_bf16 v[132:135], a[68:71], v[160:163], v[132:135]
    ds_read_b64_tr_b16 a[18:19], v26 offset:5120
    s_waitcnt lgkmcnt(15)
    v_mfma_f32_16x16x32_bf16 v[136:139], a[72:75], v[160:163], v[136:139]
    ds_read_b64_tr_b16 a[20:21], v27 offset:4096
    v_mfma_f32_16x16x32_bf16 v[140:143], a[76:79], v[160:163], v[140:143]
    ds_read_b64_tr_b16 a[22:23], v27 offset:5120
    s_waitcnt vmcnt(10) lgkmcnt(15)
    v_mfma_f32_16x16x32_bf16 v[128:131], a[80:83], v[164:167], v[128:131]
    ds_read_b64_tr_b16 a[24:25], v28 offset:4096
    s_add_u32 s59, s59, 4096
    buffer_load_dwordx4 v[208:211], v36, s[40:43], s59 offen offset:0 sc1
    v_mfma_f32_16x16x32_bf16 v[132:135], a[84:87], v[164:167], v[132:135]
    ds_read_b64_tr_b16 a[26:27], v28 offset:5120
    s_waitcnt lgkmcnt(15)
    v_mfma_f32_16x16x32_bf16 v[136:139], a[88:91], v[164:167], v[136:139]
    ds_read_b64_tr_b16 a[28:29], v29 offset:4096
    v_mfma_f32_16x16x32_bf16 v[140:143], a[92:95], v[164:167], v[140:143]
    ds_read_b64_tr_b16 a[30:31], v29 offset:5120
    s_waitcnt vmcnt(10) lgkmcnt(15)
    v_mfma_f32_16x16x32_bf16 v[128:131], a[96:99], v[168:171], v[128:131]
    ds_read_b64_tr_b16 a[32:33], v26 offset:8192
    buffer_load_dwordx4 v[212:215], v36, s[40:43], s59 offen offset:1024 sc1
    v_mfma_f32_16x16x32_bf16 v[132:135], a[100:103], v[168:171], v[132:135]
    ds_read_b64_tr_b16 a[34:35], v26 offset:9216
    s_waitcnt lgkmcnt(15)
    v_mfma_f32_16x16x32_bf16 v[136:139], a[104:107], v[168:171], v[136:139]
    ds_read_b64_tr_b16 a[36:37], v27 offset:8192
    v_mfma_f32_16x16x32_bf16 v[140:143], a[108:111], v[168:171], v[140:143]
    ds_read_b64_tr_b16 a[38:39], v27 offset:9216
    s_waitcnt vmcnt(10) lgkmcnt(15)
    v_mfma_f32_16x16x32_bf16 v[128:131], a[112:115], v[172:175], v[128:131]
    ds_read_b64_tr_b16 a[40:41], v28 offset:8192
    buffer_load_dwordx4 v[216:219], v36, s[40:43], s59 offen offset:2048 sc1
    v_mfma_f32_16x16x32_bf16 v[132:135], a[116:119], v[172:175], v[132:135]
    ds_read_b64_tr_b16 a[42:43], v28 offset:9216
    s_waitcnt lgkmcnt(15)
    v_mfma_f32_16x16x32_bf16 v[136:139], a[120:123], v[172:175], v[136:139]
    ds_read_b64_tr_b16 a[44:45], v29 offset:8192
    v_mfma_f32_16x16x32_bf16 v[140:143], a[124:127], v[172:175], v[140:143]
    ds_read_b64_tr_b16 a[46:47], v29 offset:9216
    s_waitcnt vmcnt(10) lgkmcnt(15)
    v_mfma_f32_16x16x32_bf16 v[128:131], a[128:131], v[176:179], v[128:131]
    ds_read_b64_tr_b16 a[48:49], v26 offset:12288
    buffer_load_dwordx4 v[220:223], v36, s[40:43], s59 offen offset:3072 sc1
    v_mfma_f32_16x16x32_bf16 v[132:135], a[132:135], v[176:179], v[132:135]
    ds_read_b64_tr_b16 a[50:51], v26 offset:13312
    s_waitcnt lgkmcnt(15)
    v_mfma_f32_16x16x32_bf16 v[136:139], a[136:139], v[176:179], v[136:139]
    ds_read_b64_tr_b16 a[52:53], v27 offset:12288
    v_mfma_f32_16x16x32_bf16 v[140:143], a[140:143], v[176:179], v[140:143]
    ds_read_b64_tr_b16 a[54:55], v27 offset:13312
    s_waitcnt vmcnt(10) lgkmcnt(15)
    v_mfma_f32_16x16x32_bf16 v[128:131], a[144:147], v[180:183], v[128:131]
    ds_read_b64_tr_b16 a[56:57], v28 offset:12288
    s_add_u32 s59, s59, 4096
    buffer_load_dwordx4 v[224:227], v36, s[40:43], s59 offen offset:0 sc1
    v_mfma_f32_16x16x32_bf16 v[132:135], a[148:151], v[180:183], v[132:135]
    ds_read_b64_tr_b16 a[58:59], v28 offset:13312
    s_waitcnt lgkmcnt(15)
    v_mfma_f32_16x16x32_bf16 v[136:139], a[152:155], v[180:183], v[136:139]
    ds_read_b64_tr_b16 a[60:61], v29 offset:12288
    v_mfma_f32_16x16x32_bf16 v[140:143], a[156:159], v[180:183], v[140:143]
    ds_read_b64_tr_b16 a[62:63], v29 offset:13312
    s_waitcnt vmcnt(10) lgkmcnt(15)
    v_mfma_f32_16x16x32_bf16 v[128:131], a[160:163], v[184:187], v[128:131]
    v_add_u32 v26, 0x8000, v26
    v_add_u32 v27, 0x8000, v27
    v_add_u32 v28, 0x8000, v28
    v_add_u32 v29, 0x8000, v29
    ds_read_b64_tr_b16 a[64:65], v26 offset:32768
    buffer_load_dwordx4 v[228:231], v36, s[40:43], s59 offen offset:1024 sc1
    v_mfma_f32_16x16x32_bf16 v[132:135], a[164:167], v[184:187], v[132:135]
    ds_read_b64_tr_b16 a[66:67], v26 offset:33792
    s_waitcnt lgkmcnt(15)
    v_mfma_f32_16x16x32_bf16 v[136:139], a[168:171], v[184:187], v[136:139]
    ds_read_b64_tr_b16 a[68:69], v27 offset:32768
    v_mfma_f32_16x16x32_bf16 v[140:143], a[172:175], v[184:187], v[140:143]
    ds_read_b64_tr_b16 a[70:71], v27 offset:33792
    s_waitcnt vmcnt(10) lgkmcnt(15)
    v_mfma_f32_16x16x32_bf16 v[128:131], a[176:179], v[188:191], v[128:131]
    ds_read_b64_tr_b16 a[72:73], v28 offset:32768
    buffer_load_dwordx4 v[232:235], v36, s[40:43], s59 offen offset:2048 sc1
    v_mfma_f32_16x16x32_bf16 v[132:135], a[180:183], v[188:191], v[132:135]
    ds_read_b64_tr_b16 a[74:75], v28 offset:33792
    s_waitcnt lgkmcnt(15)
    v_mfma_f32_16x16x32_bf16 v[136:139], a[184:187], v[188:191], v[136:139]
    ds_read_b64_tr_b16 a[76:77], v29 offset:32768
    v_mfma_f32_16x16x32_bf16 v[140:143], a[188:191], v[188:191], v[140:143]
    ds_read_b64_tr_b16 a[78:79], v29 offset:33792
    s_waitcnt vmcnt(10) lgkmcnt(15)
    v_mfma_f32_16x16x32_bf16 v[128:131], a[192:195], v[192:195], v[128:131]
    ds_read_b64_tr_b16 a[80:81], v26 offset:36864
    buffer_load_dwordx4 v[236:239], v36, s[40:43], s59 offen offset:3072 sc1
    v_mfma_f32_16x16x32_bf16 v[132:135], a[196:199], v[192:195], v[132:135]
    ds_read_b64_tr_b16 a[82:83], v26 offset:37888
    s_waitcnt lgkmcnt(15)
    v_mfma_f32_16x16x32_bf16 v[136:139], a[200:203], v[192:195], v[136:139]
    ds_read_b64_tr_b16 a[84:85], v27 offset:36864
    v_mfma_f32_16x16x32_bf16 v[140:143], a[204:207], v[192:195], v[140:143]
    ds_read_b64_tr_b16 a[86:87], v27 offset:37888
    s_waitcnt vmcnt(10) lgkmcnt(15)
    v_mfma_f32_16x16x32_bf16 v[128:131], a[208:211], v[196:199], v[128:131]
    ds_read_b64_tr_b16 a[88:89], v28 offset:36864
    s_add_u32 s59, s59, 4096
    buffer_load_dwordx4 v[240:243], v36, s[40:43], s59 offen offset:0 sc1
    v_mfma_f32_16x16x32_bf16 v[132:135], a[212:215], v[196:199], v[132:135]
    ds_read_b64_tr_b16 a[90:91], v28 offset:37888
    s_waitcnt lgkmcnt(15)
    v_mfma_f32_16x16x32_bf16 v[136:139], a[216:219], v[196:199], v[136:139]
    ds_read_b64_tr_b16 a[92:93], v29 offset:36864
    v_mfma_f32_16x16x32_bf16 v[140:143], a[220:223], v[196:199], v[140:143]
    ds_read_b64_tr_b16 a[94:95], v29 offset:37888
    s_waitcnt vmcnt(10) lgkmcnt(15)
    v_mfma_f32_16x16x32_bf16 v[128:131], a[224:227], v[200:203], v[128:131]
    ds_read_b64_tr_b16 a[96:97], v26 offset:40960
    buffer_load_dwordx4 v[244:247], v36, s[40:43], s59 offen offset:1024 sc1
    v_mfma_f32_16x16x32_bf16 v[132:135], a[228:231], v[200:203], v[132:135]
    ds_read_b64_tr_b16 a[98:99], v26 offset:41984
    s_waitcnt lgkmcnt(15)
    v_mfma_f32_16x16x32_bf16 v[136:139], a[232:235], v[200:203], v[136:139]
    ds_read_b64_tr_b16 a[100:101], v27 offset:40960
    v_mfma_f32_16x16x32_bf16 v[140:143], a[236:239], v[200:203], v[140:143]
    ds_read_b64_tr_b16 a[102:103], v27 offset:41984
    s_waitcnt vmcnt(10) lgkmcnt(15)
    v_mfma_f32_16x16x32_bf16 v[128:131], a[240:243], v[204:207], v[128:131]
    ds_read_b64_tr_b16 a[104:105], v28 offset:40960
    buffer_load_dwordx4 v[248:251], v36, s[40:43], s59 offen offset:2048 sc1
    v_mfma_f32_16x16x32_bf16 v[132:135], a[244:247], v[204:207], v[132:135]
    ds_read_b64_tr_b16 a[106:107], v28 offset:41984
    s_waitcnt lgkmcnt(15)
    v_mfma_f32_16x16x32_bf16 v[136:139], a[248:251], v[204:207], v[136:139]
    ds_read_b64_tr_b16 a[108:109], v29 offset:40960
    v_mfma_f32_16x16x32_bf16 v[140:143], a[252:255], v[204:207], v[140:143]
    ds_read_b64_tr_b16 a[110:111], v29 offset:41984
    s_waitcnt vmcnt(10) lgkmcnt(15)
    v_mfma_f32_16x16x32_bf16 v[128:131], a[0:3], v[208:211], v[128:131]
    ds_read_b64_tr_b16 a[112:113], v26 offset:45056
    buffer_load_dwordx4 v[252:255], v36, s[40:43], s59 offen offset:3072 sc1
    v_mfma_f32_16x16x32_bf16 v[132:135], a[4:7], v[208:211], v[132:135]
    ds_read_b64_tr_b16 a[114:115], v26 offset:46080
    s_waitcnt lgkmcnt(15)
    v_mfma_f32_16x16x32_bf16 v[136:139], a[8:11], v[208:211], v[136:139]
    ds_read_b64_tr_b16 a[116:117], v27 offset:45056
    v_mfma_f32_16x16x32_bf16 v[140:143], a[12:15], v[208:211], v[140:143]
    ds_read_b64_tr_b16 a[118:119], v27 offset:46080
    s_waitcnt vmcnt(10) lgkmcnt(15)
    v_mfma_f32_16x16x32_bf16 v[128:131], a[16:19], v[212:215], v[128:131]
    ds_read_b64_tr_b16 a[120:121], v28 offset:45056
    s_mul_i32 s58, s44, 2304
    s_add_u32 s58, s58, 81920
    v_lshrrev_b32 v1, 4, v0
    v_mfma_f32_16x16x32_bf16 v[132:135], a[20:23], v[212:215], v[132:135]
    ds_read_b64_tr_b16 a[122:123], v28 offset:46080
    s_waitcnt lgkmcnt(15)
    v_mfma_f32_16x16x32_bf16 v[136:139], a[24:27], v[212:215], v[136:139]
    ds_read_b64_tr_b16 a[124:125], v29 offset:45056
    v_mfma_f32_16x16x32_bf16 v[140:143], a[28:31], v[212:215], v[140:143]
    ds_read_b64_tr_b16 a[126:127], v29 offset:46080
    s_waitcnt vmcnt(9) lgkmcnt(15)
    v_mfma_f32_16x16x32_bf16 v[128:131], a[32:35], v[216:219], v[128:131]
    ds_read_b64_tr_b16 a[128:129], v26 offset:49152
    v_lshl_add_u32 v54, v1, 3, s58
    v_and_b32 v1, 15, v0
    v_mul_u32_u24 v1, 144, v1
    v_mfma_f32_16x16x32_bf16 v[132:135], a[36:39], v[216:219], v[132:135]
    ds_read_b64_tr_b16 a[130:131], v26 offset:50176
    s_waitcnt lgkmcnt(15)
    v_mfma_f32_16x16x32_bf16 v[136:139], a[40:43], v[216:219], v[136:139]
    ds_read_b64_tr_b16 a[132:133], v27 offset:49152
    v_mfma_f32_16x16x32_bf16 v[140:143], a[44:47], v[216:219], v[140:143]
    ds_read_b64_tr_b16 a[134:135], v27 offset:50176
    s_waitcnt vmcnt(8) lgkmcnt(15)
    v_mfma_f32_16x16x32_bf16 v[128:131], a[48:51], v[220:223], v[128:131]
    ds_read_b64_tr_b16 a[136:137], v28 offset:49152
    v_add_u32 v54, v54, v1
    v_and_b32 v1, 7, v0
    v_lshlrev_b32 v37, 4, v1
    v_mfma_f32_16x16x32_bf16 v[132:135], a[52:55], v[220:223], v[132:135]
    ds_read_b64_tr_b16 a[138:139], v28 offset:50176
    s_waitcnt lgkmcnt(15)
    v_mfma_f32_16x16x32_bf16 v[136:139], a[56:59], v[220:223], v[136:139]
    ds_read_b64_tr_b16 a[140:141], v29 offset:49152
    v_mfma_f32_16x16x32_bf16 v[140:143], a[60:63], v[220:223], v[140:143]
    ds_read_b64_tr_b16 a[142:143], v29 offset:50176
    s_waitcnt vmcnt(7) lgkmcnt(15)
    v_mfma_f32_16x16x32_bf16 v[128:131], a[64:67], v[224:227], v[128:131]
    ds_read_b64_tr_b16 a[144:145], v26 offset:53248
    v_lshl_add_u32 v55, v37, 0, s58
    v_lshrrev_b32 v1, 3, v0
    v_mul_u32_u24 v1, 144, v1
    v_mfma_f32_16x16x32_bf16 v[132:135], a[68:71], v[224:227], v[132:135]
    ds_read_b64_tr_b16 a[146:147], v26 offset:54272
    s_waitcnt lgkmcnt(15)
    v_mfma_f32_16x16x32_bf16 v[136:139], a[72:75], v[224:227], v[136:139]
    ds_read_b64_tr_b16 a[148:149], v27 offset:53248
    v_mfma_f32_16x16x32_bf16 v[140:143], a[76:79], v[224:227], v[140:143]
    ds_read_b64_tr_b16 a[150:151], v27 offset:54272
    s_waitcnt vmcnt(6) lgkmcnt(15)
    v_mfma_f32_16x16x32_bf16 v[128:131], a[80:83], v[228:231], v[128:131]
    ds_read_b64_tr_b16 a[152:153], v28 offset:53248
    v_add_u32 v55, v55, v1
    v_lshlrev_b32 v56, 0, v37
    v_lshrrev_b32 v1, 3, v0
    v_mfma_f32_16x16x32_bf16 v[132:135], a[84:87], v[228:231], v[132:135]
    ds_read_b64_tr_b16 a[154:155], v28 offset:54272
    s_waitcnt lgkmcnt(15)
    v_mfma_f32_16x16x32_bf16 v[136:139], a[88:91], v[228:231], v[136:139]
    ds_read_b64_tr_b16 a[156:157], v29 offset:53248
    v_mfma_f32_16x16x32_bf16 v[140:143], a[92:95], v[228:231], v[140:143]
    ds_read_b64_tr_b16 a[158:159], v29 offset:54272
    s_waitcnt vmcnt(5) lgkmcnt(15)
    v_mfma_f32_16x16x32_bf16 v[128:131], a[96:99], v[232:235], v[128:131]
    ds_read_b64_tr_b16 a[160:161], v26 offset:57344
    v_lshl_add_u32 v56, v1, 10, v56
    s_lshl_b32 s58, s60, 14
    s_lshl_b32 s91, s63, 7
    v_mfma_f32_16x16x32_bf16 v[132:135], a[100:103], v[232:235], v[132:135]
    ds_read_b64_tr_b16 a[162:163], v26 offset:58368
    s_waitcnt lgkmcnt(15)
    v_mfma_f32_16x16x32_bf16 v[136:139], a[104:107], v[232:235], v[136:139]
    ds_read_b64_tr_b16 a[164:165], v27 offset:57344
    v_mfma_f32_16x16x32_bf16 v[140:143], a[108:111], v[232:235], v[140:143]
    ds_read_b64_tr_b16 a[166:167], v27 offset:58368
    s_waitcnt vmcnt(4) lgkmcnt(15)
    v_mfma_f32_16x16x32_bf16 v[128:131], a[112:115], v[236:239], v[128:131]
    ds_read_b64_tr_b16 a[168:169], v28 offset:57344
    s_add_u32 s58, s58, s91
    s_add_u32 s60, s58, 8192
    v_mfma_f32_16x16x32_bf16 v[132:135], a[116:119], v[236:239], v[132:135]
    ds_read_b64_tr_b16 a[170:171], v28 offset:58368
    s_waitcnt lgkmcnt(15)
    v_mfma_f32_16x16x32_bf16 v[136:139], a[120:123], v[236:239], v[136:139]
    ds_read_b64_tr_b16 a[172:173], v29 offset:57344
    v_mfma_f32_16x16x32_bf16 v[140:143], a[124:127], v[236:239], v[140:143]
    ds_read_b64_tr_b16 a[174:175], v29 offset:58368
    s_waitcnt vmcnt(3) lgkmcnt(15)
    v_mfma_f32_16x16x32_bf16 v[128:131], a[128:131], v[240:243], v[128:131]
    ds_read_b64_tr_b16 a[176:177], v26 offset:61440
    v_mfma_f32_16x16x32_bf16 v[132:135], a[132:135], v[240:243], v[132:135]
    ds_read_b64_tr_b16 a[178:179], v26 offset:62464
    s_waitcnt lgkmcnt(15)
    v_mfma_f32_16x16x32_bf16 v[136:139], a[136:139], v[240:243], v[136:139]
    ds_read_b64_tr_b16 a[180:181], v27 offset:61440
    v_mfma_f32_16x16x32_bf16 v[140:143], a[140:143], v[240:243], v[140:143]
    ds_read_b64_tr_b16 a[182:183], v27 offset:62464
    s_waitcnt vmcnt(2) lgkmcnt(15)
    v_mfma_f32_16x16x32_bf16 v[128:131], a[144:147], v[244:247], v[128:131]
    ds_read_b64_tr_b16 a[184:185], v28 offset:61440
    v_mfma_f32_16x16x32_bf16 v[132:135], a[148:151], v[244:247], v[132:135]
    ds_read_b64_tr_b16 a[186:187], v28 offset:62464
    s_waitcnt lgkmcnt(14)
    v_mfma_f32_16x16x32_bf16 v[136:139], a[152:155], v[244:247], v[136:139]
    ds_read_b64_tr_b16 a[188:189], v29 offset:61440
    v_mfma_f32_16x16x32_bf16 v[140:143], a[156:159], v[244:247], v[140:143]
    ds_read_b64_tr_b16 a[190:191], v29 offset:62464
    s_waitcnt vmcnt(1) lgkmcnt(12)
    v_mfma_f32_16x16x32_bf16 v[128:131], a[160:163], v[248:251], v[128:131]
    v_mfma_f32_16x16x32_bf16 v[132:135], a[164:167], v[248:251], v[132:135]
    s_waitcnt lgkmcnt(8)
    v_mfma_f32_16x16x32_bf16 v[136:139], a[168:171], v[248:251], v[136:139]
    v_mfma_f32_16x16x32_bf16 v[140:143], a[172:175], v[248:251], v[140:143]
    s_waitcnt vmcnt(0) lgkmcnt(4)
    v_mfma_f32_16x16x32_bf16 v[128:131], a[176:179], v[252:255], v[128:131]
    v_mfma_f32_16x16x32_bf16 v[132:135], a[180:183], v[252:255], v[132:135]
    s_waitcnt lgkmcnt(0)
    v_mfma_f32_16x16x32_bf16 v[136:139], a[184:187], v[252:255], v[136:139]
    v_mfma_f32_16x16x32_bf16 v[140:143], a[188:191], v[252:255], v[140:143]
    s_nop 3
    v_cvt_pk_bf16_f32 v18, v128, v129
    v_cvt_pk_bf16_f32 v19, v130, v131
    v_cvt_pk_bf16_f32 v20, v132, v133
    v_cvt_pk_bf16_f32 v21, v134, v135
    v_cvt_pk_bf16_f32 v22, v136, v137
    v_cvt_pk_bf16_f32 v23, v138, v139
    v_cvt_pk_bf16_f32 v24, v140, v141
    v_cvt_pk_bf16_f32 v25, v142, v143
    ds_write_b64 v54, v[18:19] offset:0
    ds_write_b64 v54, v[20:21] offset:32
    ds_write_b64 v54, v[22:23] offset:64
    ds_write_b64 v54, v[24:25] offset:96
    ds_read_b128 v[128:131], v55 offset:0
    ds_read_b128 v[132:135], v55 offset:1152
    s_waitcnt lgkmcnt(1)
    buffer_store_dwordx4 v[128:131], v56, s[36:39], s58 offen sc1 nt
    s_waitcnt lgkmcnt(0)
    buffer_store_dwordx4 v[132:135], v56, s[36:39], s60 offen sc1 nt
L_abort_wt:
L_end_wt:
    s_endpgm
L_retry_4_wt:
    s_mov_b32 s61, 0
L_again_6_wt:
    buffer_load_dwordx2 v[248:249], v57, s[40:43], 0 offen offset:0 sc1
    buffer_load_dwordx2 v[250:251], v57, s[40:43], 0 offen offset:272 sc1
    buffer_load_dwordx2 v[252:253], v59, s[40:43], 0 offen offset:0 sc1
    buffer_load_dwordx2 v[254:255], v59, s[40:43], 0 offen offset:272 sc1
    v_mov_b32 v52, 0
    v_mov_b32 v53, 0
    v_mov_b32 v54, 0
    v_mov_b32 v55, 0
    s_addk_i32 s61, 1
    s_cmp_gt_u32 s61, 0x80000
    s_cbranch_scc1 L_abort_wt
    s_waitcnt vmcnt(0)
    v_dot2c_f32_bf16 v52, s55, v248
    v_dot2c_f32_bf16 v53, s56, v248
    v_dot2c_f32_bf16 v54, s55, v249
    v_dot2c_f32_bf16 v55, s56, v249
    v_dot2c_f32_bf16 v52, s55, v250
    v_dot2c_f32_bf16 v53, s56, v250
    v_dot2c_f32_bf16 v54, s55, v251
    v_dot2c_f32_bf16 v55, s56, v251
    v_dot2c_f32_bf16 v52, s55, v252
    v_dot2c_f32_bf16 v53, s56, v252
    v_dot2c_f32_bf16 v54, s55, v253
    v_dot2c_f32_bf16 v55, s56, v253
    v_dot2c_f32_bf16 v52, s55, v254
    v_dot2c_f32_bf16 v53, s56, v254
    v_dot2c_f32_bf16 v54, s55, v255
    v_dot2c_f32_bf16 v55, s56, v255
    v_cmp_u_f32 vcc, v52, v52
    v_cvt_pk_bf16_f32 v248, v52, v53
    s_nop 0
    v_cvt_pk_bf16_f32 v249, v54, v55
    s_cbranch_vccnz L_again_6_wt
    s_branch L_got_5_wt
L_retry_16_wt:
    s_mov_b32 s61, 0
L_again_18_wt:
    buffer_load_dwordx2 v[54:55], v48, s[40:43], 0 offen offset:0 sc1
    buffer_load_dwordx2 v[56:57], v48, s[40:43], 0 offen offset:256 sc1
    buffer_load_dwordx2 v[58:59], v48, s[40:43], 0 offen offset:512 sc1
    buffer_load_dwordx2 v[60:61], v48, s[40:43], 0 offen offset:768 sc1
    s_addk_i32 s61, 1
    s_cmp_gt_u32 s61, 0x80000
    s_cbranch_scc1 L_abort_wt
    s_waitcnt vmcnt(0)
    v_add_f32 v54, v54, v56
    v_add_f32 v58, v58, v60
    v_add_f32 v4, v54, v58
    v_add_f32 v55, v55, v57
    v_add_f32 v59, v59, v61
    v_add_f32 v5, v55, v59
    v_cmp_u_f32 vcc, v4, v5
    s_cbranch_vccnz L_again_18_wt
    s_branch L_got_17_wt
L_retry_22_wt:
    s_mov_b32 s61, 0
L_again_24_wt:
    buffer_load_dword v47, v62, s[40:43], 0 offen sc1
    s_addk_i32 s61, 1
    s_cmp_gt_u32 s61, 0x80000
    s_cbranch_scc1 L_abort_wt
    s_waitcnt vmcnt(0)
    v_cmp_ne_u32 vcc, s53, v47
    s_cbranch_vccnz L_again_24_wt
    s_branch L_got_23_wt
L_retry_25_wt:
    s_mov_b32 s61, 0
L_again_27_wt:
    buffer_load_dword v47, v49, s[40:43], 0 offen sc1
    s_addk_i32 s61, 1
    s_cmp_gt_u32 s61, 0x80000
    s_cbranch_scc1 L_abort_wt
    s_waitcnt vmcnt(0)
    v_cmp_ne_u32 vcc, s53, v47
    s_cbranch_vccnz L_again_27_wt
    s_branch L_got_26_wt
L_spare_wt:
    s_lshl_b32 s59, s99, 2
    s_add_u32 s59, s59, s44
    s_and_b32 s58, s50, 1
    s_lshl_b32 s58, s58, 3
    s_add_u32 s58, s58, s59
    s_barrier
    v_and_b32 v1, 3, v0
    v_lshlrev_b32 v46, 0, v1
    v_min_u32 v46, 2, v46
    v_lshlrev_b32 v46, 9, v46
    v_lshrrev_b32 v1, 2, v0
    v_mul_u32_u24 v1, 3584, v1
    v_add_u32 v46, v46, v1
    v_add_u32 v46, 384, v46
    s_mul_i32 s88, s58, 114688
    s_add_u32 s97, s88, 0
    buffer_load_dword v2, v46, s[4:7], s97 offen sc1
    s_barrier
    v_and_b32 v1, 1, v0
    v_lshlrev_b32 v46, 7, v1
    v_lshrrev_b32 v1, 1, v0
    v_lshl_add_u32 v46, v1, 12, v46
    s_lshl_b32 s88, s95, 17
    s_lshl_b32 s91, s99, 11
    s_add_u32 s88, s88, s91
    s_add_u32 s97, s88, 0
    buffer_load_dword v2, v46, s[24:27], s97 offen sc1
    s_barrier
    v_and_b32 v1, 3, v0
    v_lshlrev_b32 v46, 0, v1
    v_min_u32 v46, 2, v46
    v_lshlrev_b32 v46, 9, v46
    v_lshrrev_b32 v1, 2, v0
    v_mul_u32_u24 v1, 3584, v1
    v_add_u32 v46, v46, v1
    v_add_u32 v46, 384, v46
    s_mul_i32 s88, s58, 114688
    s_add_u32 s97, s88, 57344
    buffer_load_dword v2, v46, s[4:7], s97 offen sc1
    s_barrier
    v_and_b32 v1, 1, v0
    v_lshlrev_b32 v46, 7, v1
    v_lshrrev_b32 v1, 1, v0
    v_lshl_add_u32 v46, v1, 12, v46
    s_lshl_b32 s88, s95, 17
    s_lshl_b32 s91, s99, 11
    s_add_u32 s88, s88, s91
    s_add_u32 s97, s88, 256
    buffer_load_dword v2, v46, s[24:27], s97 offen sc1
    s_barrier
    s_add_u32 s97, s88, 512
    buffer_load_dword v2, v46, s[24:27], s97 offen sc1
    s_barrier
    s_add_u32 s97, s88, 768
    buffer_load_dword v2, v46, s[24:27], s97 offen sc1
    s_barrier
    s_add_u32 s97, s88, 1024
    buffer_load_dword v2, v46, s[24:27], s97 offen sc1
    s_barrier
    s_add_u32 s97, s88, 1280
    buffer_load_dword v2, v46, s[24:27], s97 offen sc1
    s_barrier
    s_add_u32 s97, s88, 1536
    buffer_load_dword v2, v46, s[24:27], s97 offen sc1
    s_barrier
    s_add_u32 s97, s88, 1792
    buffer_load_dword v2, v46, s[24:27], s97 offen sc1
    s_barrier
    s_barrier
    v_and_b32 v1, 3, v0
    v_lshlrev_b32 v46, 7, v1
    s_lshl_b32 s88, s50, 9
    s_add_u32 s88, s88, 32768
    s_add_u32 s97, s88, 0
    buffer_load_dword v2, v46, s[40:43], s97 offen sc1
    v_lshlrev_b32 v46, 0, v0
    v_min_u32 v46, 13, v46
    v_lshlrev_b32 v46, 7, v46
    s_lshl_b32 s88, s50, 11
    s_add_u32 s88, s88, 40960
    s_add_u32 s97, s88, 0
    buffer_load_dword v2, v46, s[40:43], s97 offen sc1
    s_barrier
    v_lshlrev_b32 v46, 0, v0
    v_min_u32 v46, 55, v46
    v_lshlrev_b32 v46, 7, v46
    s_mul_i32 s88, s50, 57344
    s_mul_i32 s91, s59, 7168
    s_add_u32 s88, s88, s91
    s_add_u32 s97, s88, 0
    buffer_load_dword v2, v46, s[32:35], s97 offen sc1
    s_add_u32 m0, s62, 0
    s_mov_b32 s92, 3072
    s_mov_b32 s93, 14336
    s_mov_b32 s94, 17408
    buffer_load_dwordx4 v40, s[32:35], 0 offen offset:0 lds
    buffer_load_dwordx4 v40, s[32:35], s92 offen offset:1024 lds
    buffer_load_dwordx4 v40, s[32:35], s93 offen offset:2048 lds
    buffer_load_dwordx4 v40, s[32:35], s94 offen offset:3072 lds
    v_add_u32 v40, 0x20000, v40
    s_add_u32 m0, s62, 16384
    s_nop 0
    buffer_load_dwordx4 v40, s[32:35], 0 offen offset:0 lds
    buffer_load_dwordx4 v40, s[32:35], s92 offen offset:1024 lds
    buffer_load_dwordx4 v40, s[32:35], s93 offen offset:2048 lds
    buffer_load_dwordx4 v40, s[32:35], s94 offen offset:3072 lds
    v_add_u32 v40, 0x20000, v40
    s_add_u32 m0, s62, 32768
    s_nop 0
    buffer_load_dwordx4 v40, s[32:35], 0 offen offset:0 lds
    buffer_load_dwordx4 v40, s[32:35], s92 offen offset:1024 lds
    buffer_load_dwordx4 v40, s[32:35], s93 offen offset:2048 lds
    buffer_load_dwordx4 v40, s[32:35], s94 offen offset:3072 lds
    v_add_u32 v40, 0x20000, v40
    s_add_u32 m0, s62, 49152
    s_nop 0
    buffer_load_dwordx4 v40, s[32:35], 0 offen offset:0 lds
    buffer_load_dwordx4 v40, s[32:35], s92 offen offset:1024 lds
    buffer_load_dwordx4 v40, s[32:35], s93 offen offset:2048 lds
    buffer_load_dwordx4 v40, s[32:35], s94 offen offset:3072 lds
    v_add_u32 v40, 0x20000, v40
    s_add_u32 m0, s62, 65536
    s_nop 0
    buffer_load_dwordx4 v40, s[32:35], 0 offen offset:0 lds
    buffer_load_dwordx4 v40, s[32:35], s92 offen offset:1024 lds
    buffer_load_dwordx4 v40, s[32:35], s93 offen offset:2048 lds
    buffer_load_dwordx4 v40, s[32:35], s94 offen offset:3072 lds
    v_add_u32 v40, 0x20000, v40
    s_add_u32 m0, s62, 131072
    s_nop 0
    buffer_load_dwordx4 v40, s[32:35], 0 offen offset:0 lds
    buffer_load_dwordx4 v40, s[32:35], s92 offen offset:1024 lds
    buffer_load_dwordx4 v40, s[32:35], s93 offen offset:2048 lds
    buffer_load_dwordx4 v40, s[32:35], s94 offen offset:3072 lds
    v_add_u32 v40, 0x20000, v40
    s_add_u32 m0, s62, 147456
    s_nop 0
    buffer_load_dwordx4 v40, s[32:35], 0 offen offset:0 lds
    buffer_load_dwordx4 v40, s[32:35], s92 offen offset:1024 lds
    buffer_load_dwordx4 v40, s[32:35], s93 offen offset:2048 lds
    buffer_load_dwordx4 v40, s[32:35], s94 offen offset:3072 lds
    s_waitcnt vmcnt(0)
    v_mov_b32 v1, v39
    s_branch L_s7_wt

.section .rodata,"a"
.p2align 6
.amdhsa_kernel sequential_preLN__linear_kernel_hedgehog__mixer_gmlp__prompt_kernel
  .amdhsa_next_free_vgpr 512
  .amdhsa_next_free_sgpr 102
  .amdhsa_accum_offset 256
  .amdhsa_group_segment_fixed_size 0
  .amdhsa_kernarg_size 96
  .amdhsa_user_sgpr_count 2
  .amdhsa_user_sgpr_kernarg_segment_ptr 1
  .amdhsa_system_sgpr_workgroup_id_x 1
  .amdhsa_float_denorm_mode_32 3
.end_amdhsa_kernel
```
